```python
import torch

def _softmax(x, axis=-1):
    return torch.softmax(x, dim=axis)
def _gelu(x):
    return torch.nn.functional.gelu(x, approximate="tanh")
def _silu(x):
    return torch.nn.functional.silu(x)
def _sigmoid(x):
    return torch.sigmoid(x)
def _layernorm(x, axis=-1, eps=1e-5):
    m = x.mean(dim=axis, keepdim=True)
    v = x.var(dim=axis, keepdim=True, unbiased=False)
    return (x - m) / torch.sqrt(v + eps)
def _scatter_add(tgt, idx, src, axis=0):
    return tgt.clone().index_add_(axis, idx, src)
def _segment_sum(src, seg, n):
    out = torch.zeros((n,) + src.shape[1:], dtype=src.dtype)
    return out.index_add_(0, seg, src)
def _pad(x, pw):
    flat = tuple(v for pair in reversed(pw) for v in pair)
    return torch.nn.functional.pad(x, flat)

kernel_name = 'sequential_preLN__grouped_kv_mqa__glu_gated_swiglu__prompt'

def setup_inputs():

    _w = (lambda a: (lambda t: t.to(torch.bfloat16) if t.is_floating_point() else t)(torch.as_tensor(a)))
    def _A_setup():
        B, S, D, H = 1, 2048, 640, 32
        Dh = D // H
        return {
            "x": _w((lambda *s: torch.randn(*s, dtype=torch.bfloat16) * 0.05)(B, S, D)),
            "wq": _w((lambda *s: torch.randn(*s, dtype=torch.bfloat16) * 0.05)(D, H * Dh)),
            "wk": _w((lambda *s: torch.randn(*s, dtype=torch.bfloat16) * 0.05)(D, Dh)),
            "wv": _w((lambda *s: torch.randn(*s, dtype=torch.bfloat16) * 0.05)(D, Dh)),
            "wo": _w((lambda *s: torch.randn(*s, dtype=torch.bfloat16) * 0.05)(H * Dh, D)),
        }
    _A_in = _A_setup()

    def _B_setup():
        B, S, D, F = 1, 2048, 640, 1536
        return {
            "x": _w((lambda *s: torch.randn(*s, dtype=torch.bfloat16) * 0.05)(B, S, D)),
            "w1": _w((lambda *s: torch.randn(*s, dtype=torch.bfloat16) * 0.4)(D, F) * (2.0 / D) ** 0.5),
            "w3": _w((lambda *s: torch.randn(*s, dtype=torch.bfloat16) * 0.4)(D, F) * (2.0 / D) ** 0.5),
            "w2": _w((lambda *s: torch.randn(*s, dtype=torch.bfloat16) * 0.4)(F, D) * (2.0 / F) ** 0.5),
        }
    _B_in = _B_setup()

    return {
        "A_x": _A_in["x"],
        "A_wq": _A_in["wq"],
        "A_wk": _A_in["wk"],
        "A_wv": _A_in["wv"],
        "A_wo": _A_in["wo"],
        "B_x": _B_in["x"],
        "B_w1": _B_in["w1"],
        "B_w3": _B_in["w3"],
        "B_w2": _B_in["w2"],
    }

def reference(A_x, A_wq, A_wk, A_wv, A_wo, B_x, B_w1, B_w3, B_w2):
    def _A_ref(x, wq, wk, wv, wo):
        B, S, D = x.shape
        H = 32
        Dh = D // H
        q = (lambda x, *d: x.permute(*d))((x @ wq).reshape(B, S, H, Dh), 0, 2, 1, 3)
        k = x @ wk
        v = x @ wv
        scores = torch.einsum("bhqd,bkd->bhqk", q, k) * (Dh ** -0.5)
        p = _softmax(scores, axis=-1)
        o = torch.einsum("bhqk,bkd->bhqd", p, v)
        return (lambda x, *d: x.permute(*d))(o, 0, 2, 1, 3).reshape(B, S, H * Dh) @ wo

    def _B_ref(x, w1, w3, w2):
        gate = torch.einsum("bsd,df->bsf", x, w1)
        up = torch.einsum("bsd,df->bsf", x, w3)
        h = _silu(gate) * up
        out = torch.einsum("bsf,fd->bsd", h, w2)
        return out

    x = A_x
    h = x + _A_ref(_layernorm(x, axis=-1), A_wq, A_wk, A_wv, A_wo)
    h2 = h + _B_ref(_layernorm(h, axis=-1), B_w1, B_w3, B_w2)
    return h2
```

```asm
; @launch grid=(256,1,1) block=(512,1,1) lds=163840
.amdgcn_target "amdgcn-amd-amdhsa--gfx950"
.text
.globl sequential_preLN__grouped_kv_mqa__glu_gated_swiglu__prompt_kernel
.p2align 8
.type sequential_preLN__grouped_kv_mqa__glu_gated_swiglu__prompt_kernel,@function
sequential_preLN__grouped_kv_mqa__glu_gated_swiglu__prompt_kernel:
    s_cmp_ge_u32 s2, 256
    s_cbranch_scc1 L_end
    s_load_dwordx8 s[36:43], s[0:1], 0
    s_load_dwordx4 s[56:59], s[0:1], 80
    s_load_dwordx2 s[44:45], s[0:1], 32
    s_load_dwordx8 s[48:55], s[0:1], 48
    v_lshrrev_b32 v1, 6, v0
    v_and_b32 v2, 63, v0
    v_readfirstlane_b32 s24, v1
    s_getpc_b64 s[72:73]
L_pc:
    s_sub_u32 s72, s72, L_pc-sequential_preLN__grouped_kv_mqa__glu_gated_swiglu__prompt_kernel
    s_subb_u32 s73, s73, 0
    s_lshr_b32 s60, s2, 3
    s_lshl_b32 s60, s60, 3
    s_add_u32 s60, s60, s24
    s_lshl_b32 s60, s60, 7
    v_lshlrev_b32 v4, 15, v2
    v_add_u32 v4, s60, v4
    v_min_u32 v4, L_code_end-sequential_preLN__grouped_kv_mqa__glu_gated_swiglu__prompt_kernel-4, v4
    s_mov_b64 exec, 7
    global_load_dword v253, v4, s[72:73]
    s_mov_b64 exec, -1
    s_and_b32 s60, s2, 7
    s_lshr_b32 s61, s2, 3
    s_lshl_b32 s25, s60, 2
    s_and_b32 s62, s61, 3
    s_add_u32 s25, s25, s62
    s_lshr_b32 s26, s61, 2
    s_lshl_b32 s27, s60, 5
    s_add_u32 s27, s27, s61
    s_lshr_b32 s28, s24, 2
    s_and_b32 s29, s24, 3
    s_lshl_b32 s30, s26, 2
    s_add_u32 s30, s30, s29
    s_and_b32 s62, s60, 1
    s_lshl_b32 s62, s62, 3
    s_and_b32 s63, s61, 7
    s_add_u32 s70, s62, s63
    s_lshr_b32 s62, s60, 1
    s_lshl_b32 s62, s62, 2
    s_lshr_b32 s63, s61, 3
    s_add_u32 s71, s62, s63
    v_lshlrev_b32 v3, 4, v2
    s_mul_i32 s32, s26, 160
    v_mov_b32 v4, 163584
    v_mov_b32 v6, 0
    v_mov_b32 v7, 0
    v_mov_b32 v8, 0
    v_mov_b32 v9, 0
    ds_write_b128 v4, v[6:9]
    ds_write_b128 v4, v[6:9] offset:16
    ds_write_b128 v4, v[6:9] offset:32
    s_and_b32 s60, s26, 6
    s_add_u32 s60, s60, s24
    s_and_b32 s31, s60, 7
    s_lshl_b32 s60, s25, 6
    s_lshl_b32 s61, s31, 3
    s_add_u32 s60, s60, s61
    v_lshrrev_b32 v62, 3, v2
    v_and_b32 v63, 7, v2
    v_add_u32 v5, s60, v62
    v_mul_u32_u24 v5, 1280, v5
    v_lshl_add_u32 v5, v63, 4, v5
    s_waitcnt lgkmcnt(0)
    s_barrier
    s_mov_b32 s8, s36
    s_mov_b32 s9, s37
    s_mov_b32 s10, 2621440
    s_mov_b32 s11, 0x00020000
    s_mov_b32 s4, s58
    s_mov_b32 s5, s59
    s_mov_b32 s6, 22020096
    s_mov_b32 s7, 0x00020000
    s_and_b32 s60, s27, 31
    s_lshl_b32 s60, s60, 3
    s_add_u32 s35, s60, s24
    s_cmp_lg_u32 s35, 251
    s_cbranch_scc1 L_p1_noclear
    s_lshr_b32 s61, s27, 5
    s_mul_i32 s60, s61, 10240
    s_add_u32 s60, s60, 327680
    v_mov_b32 v180, 0
    v_mov_b32 v181, 0
    v_mov_b32 v182, 0
    v_mov_b32 v183, 0
    buffer_store_dwordx4 v[180:183], v3, s[4:7], s60 offen offset:0 sc1
    buffer_store_dwordx4 v[180:183], v3, s[4:7], s60 offen offset:1024 sc1
    buffer_store_dwordx4 v[180:183], v3, s[4:7], s60 offen offset:2048 sc1
    buffer_store_dwordx4 v[180:183], v3, s[4:7], s60 offen offset:3072 sc1
    s_add_u32 s60, s60, 4096
    buffer_store_dwordx4 v[180:183], v3, s[4:7], s60 offen offset:0 sc1
    buffer_store_dwordx4 v[180:183], v3, s[4:7], s60 offen offset:1024 sc1
    buffer_store_dwordx4 v[180:183], v3, s[4:7], s60 offen offset:2048 sc1
    buffer_store_dwordx4 v[180:183], v3, s[4:7], s60 offen offset:3072 sc1
    s_add_u32 s60, s60, 4096
    buffer_store_dwordx4 v[180:183], v3, s[4:7], s60 offen offset:0 sc1
    buffer_store_dwordx4 v[180:183], v3, s[4:7], s60 offen offset:1024 sc1
L_p1_noclear:
    buffer_load_dwordx4 v[16:19], v5, s[8:11], 0 offen offset:0 nt
    buffer_load_dwordx4 v[20:23], v5, s[8:11], 0 offen offset:128 nt
    buffer_load_dwordx4 v[24:27], v5, s[8:11], 0 offen offset:256 nt
    buffer_load_dwordx4 v[28:31], v5, s[8:11], 0 offen offset:384 nt
    buffer_load_dwordx4 v[32:35], v5, s[8:11], 0 offen offset:512 nt
    buffer_load_dwordx4 v[36:39], v5, s[8:11], 0 offen offset:640 nt
    buffer_load_dwordx4 v[40:43], v5, s[8:11], 0 offen offset:768 nt
    buffer_load_dwordx4 v[44:47], v5, s[8:11], 0 offen offset:896 nt
    buffer_load_dwordx4 v[48:51], v5, s[8:11], 0 offen offset:1024 nt
    buffer_load_dwordx4 v[52:55], v5, s[8:11], 0 offen offset:1152 nt
    s_bitcmp1_b32 s26, 0
    s_cselect_b32 s40, s42, s40
    s_cselect_b32 s41, s43, s41
    s_mov_b32 s16, s40
    s_mov_b32 s17, s41
    s_mov_b32 s18, 25600
    s_mov_b32 s19, 0x00020000
    s_mul_i32 s66, s29, 7168
    s_add_u32 s65, s66, 131072
    s_cmp_ge_u32 s24, 4
    s_cbranch_scc1 L_p1_nokvw
    s_mov_b32 m0, s65
    s_nop 0
    buffer_load_dwordx4 v3, s[16:19], s66 offen lds
    buffer_load_dwordx4 v3, s[16:19], s66 offen offset:1024 lds
    buffer_load_dwordx4 v3, s[16:19], s66 offen offset:2048 lds
    buffer_load_dwordx4 v3, s[16:19], s66 offen offset:3072 lds
    s_add_u32 s65, s65, 4096
    s_add_u32 s66, s66, 4096
    s_mov_b32 m0, s65
    s_nop 0
    buffer_load_dwordx4 v3, s[16:19], s66 offen lds
    buffer_load_dwordx4 v3, s[16:19], s66 offen offset:1024 lds
    buffer_load_dwordx4 v3, s[16:19], s66 offen offset:2048 lds
L_p1_nokvw:
    s_mov_b32 s12, s38
    s_mov_b32 s13, s39
    s_mov_b32 s14, 819200
    s_mov_b32 s15, 0x00020000
    s_mov_b32 s20, s56
    s_mov_b32 s21, s57
    s_mov_b32 s22, 256
    s_mov_b32 s23, 0x00020000
    s_mul_i32 s61, s29, 192
    v_add_u32 v6, s61, v2
    v_add_u32 v6, 0, v6
    v_mul_u32_u24 v7, 43691, v6
    v_lshrrev_b32 v7, 19, v7
    v_mul_u32_u24 v8, 12, v7
    v_sub_u32 v8, v6, v8
    v_mul_u32_u24 v7, 1280, v7
    v_lshl_add_u32 v9, v8, 4, v7
    v_add_u32 v6, s61, v2
    v_add_u32 v6, 64, v6
    v_mul_u32_u24 v7, 43691, v6
    v_lshrrev_b32 v7, 19, v7
    v_mul_u32_u24 v8, 12, v7
    v_sub_u32 v8, v6, v8
    v_mul_u32_u24 v7, 1280, v7
    v_lshl_add_u32 v10, v8, 4, v7
    v_add_u32 v6, s61, v2
    v_add_u32 v6, 128, v6
    v_mul_u32_u24 v7, 43691, v6
    v_lshrrev_b32 v7, 19, v7
    v_mul_u32_u24 v8, 12, v7
    v_sub_u32 v8, v6, v8
    v_mul_u32_u24 v7, 1280, v7
    v_lshl_add_u32 v11, v8, 4, v7
    v_mov_b32 v56, 0
    v_mov_b32 v57, 0
    v_mov_b32 v58, 0
    v_mov_b32 v59, 0
    s_mov_b32 s67, 0x3f803f80
    s_lshr_b32 s60, s31, 2
    s_mul_i32 s60, s60, 40960
    s_and_b32 s61, s31, 3
    s_lshl_b32 s61, s61, 7
    s_add_u32 s60, s60, s61
    v_xor_b32 v6, v62, v63
    v_lshlrev_b32 v6, 4, v6
    v_lshlrev_b32 v7, 9, v63
    v_add3_u32 v13, v6, v7, s60
    s_cmp_ge_u32 s24, 4
    s_cbranch_scc1 L_p1_stat_y
    s_waitcnt vmcnt(16)
    v_dot2_f32_bf16 v56, v16, s67, v56
    v_dot2_f32_bf16 v58, v16, v16, v58
    v_dot2_f32_bf16 v57, v17, s67, v57
    v_dot2_f32_bf16 v59, v17, v17, v59
    v_dot2_f32_bf16 v56, v18, s67, v56
    v_dot2_f32_bf16 v58, v18, v18, v58
    v_dot2_f32_bf16 v57, v19, s67, v57
    v_dot2_f32_bf16 v59, v19, v19, v59
    s_waitcnt vmcnt(15)
    v_dot2_f32_bf16 v56, v20, s67, v56
    v_dot2_f32_bf16 v58, v20, v20, v58
    v_dot2_f32_bf16 v57, v21, s67, v57
    v_dot2_f32_bf16 v59, v21, v21, v59
    v_dot2_f32_bf16 v56, v22, s67, v56
    v_dot2_f32_bf16 v58, v22, v22, v58
    v_dot2_f32_bf16 v57, v23, s67, v57
    v_dot2_f32_bf16 v59, v23, v23, v59
    s_waitcnt vmcnt(14)
    v_dot2_f32_bf16 v56, v24, s67, v56
    v_dot2_f32_bf16 v58, v24, v24, v58
    v_dot2_f32_bf16 v57, v25, s67, v57
    v_dot2_f32_bf16 v59, v25, v25, v59
    v_dot2_f32_bf16 v56, v26, s67, v56
    v_dot2_f32_bf16 v58, v26, v26, v58
    v_dot2_f32_bf16 v57, v27, s67, v57
    v_dot2_f32_bf16 v59, v27, v27, v59
    s_waitcnt vmcnt(13)
    v_dot2_f32_bf16 v56, v28, s67, v56
    v_dot2_f32_bf16 v58, v28, v28, v58
    v_dot2_f32_bf16 v57, v29, s67, v57
    v_dot2_f32_bf16 v59, v29, v29, v59
    v_dot2_f32_bf16 v56, v30, s67, v56
    v_dot2_f32_bf16 v58, v30, v30, v58
    v_dot2_f32_bf16 v57, v31, s67, v57
    v_dot2_f32_bf16 v59, v31, v31, v59
    s_waitcnt vmcnt(12)
    v_dot2_f32_bf16 v56, v32, s67, v56
    v_dot2_f32_bf16 v58, v32, v32, v58
    v_dot2_f32_bf16 v57, v33, s67, v57
    v_dot2_f32_bf16 v59, v33, v33, v59
    v_dot2_f32_bf16 v56, v34, s67, v56
    v_dot2_f32_bf16 v58, v34, v34, v58
    v_dot2_f32_bf16 v57, v35, s67, v57
    v_dot2_f32_bf16 v59, v35, v35, v59
    s_waitcnt vmcnt(11)
    v_dot2_f32_bf16 v56, v36, s67, v56
    v_dot2_f32_bf16 v58, v36, v36, v58
    v_dot2_f32_bf16 v57, v37, s67, v57
    v_dot2_f32_bf16 v59, v37, v37, v59
    v_dot2_f32_bf16 v56, v38, s67, v56
    v_dot2_f32_bf16 v58, v38, v38, v58
    v_dot2_f32_bf16 v57, v39, s67, v57
    v_dot2_f32_bf16 v59, v39, v39, v59
    s_waitcnt vmcnt(10)
    v_dot2_f32_bf16 v56, v40, s67, v56
    v_dot2_f32_bf16 v58, v40, v40, v58
    v_dot2_f32_bf16 v57, v41, s67, v57
    v_dot2_f32_bf16 v59, v41, v41, v59
    v_dot2_f32_bf16 v56, v42, s67, v56
    v_dot2_f32_bf16 v58, v42, v42, v58
    v_dot2_f32_bf16 v57, v43, s67, v57
    v_dot2_f32_bf16 v59, v43, v43, v59
    s_waitcnt vmcnt(9)
    v_dot2_f32_bf16 v56, v44, s67, v56
    v_dot2_f32_bf16 v58, v44, v44, v58
    v_dot2_f32_bf16 v57, v45, s67, v57
    v_dot2_f32_bf16 v59, v45, v45, v59
    v_dot2_f32_bf16 v56, v46, s67, v56
    v_dot2_f32_bf16 v58, v46, v46, v58
    v_dot2_f32_bf16 v57, v47, s67, v57
    v_dot2_f32_bf16 v59, v47, v47, v59
    s_waitcnt vmcnt(8)
    v_dot2_f32_bf16 v56, v48, s67, v56
    v_dot2_f32_bf16 v58, v48, v48, v58
    v_dot2_f32_bf16 v57, v49, s67, v57
    v_dot2_f32_bf16 v59, v49, v49, v59
    v_dot2_f32_bf16 v56, v50, s67, v56
    v_dot2_f32_bf16 v58, v50, v50, v58
    v_dot2_f32_bf16 v57, v51, s67, v57
    v_dot2_f32_bf16 v59, v51, v51, v59
    s_waitcnt vmcnt(7)
    v_dot2_f32_bf16 v56, v52, s67, v56
    v_dot2_f32_bf16 v58, v52, v52, v58
    v_dot2_f32_bf16 v57, v53, s67, v57
    v_dot2_f32_bf16 v59, v53, v53, v59
    v_dot2_f32_bf16 v56, v54, s67, v56
    v_dot2_f32_bf16 v58, v54, v54, v58
    v_dot2_f32_bf16 v57, v55, s67, v57
    v_dot2_f32_bf16 v59, v55, v55, v59
    v_lshlrev_b32 v7, 2, v2
    buffer_load_dword v82, v7, s[20:23], 0 offen sc1
    s_branch L_p1_stat_done
L_p1_stat_y:
    s_mul_i32 s63, s29, 3072
    s_add_u32 s63, s63, 81920
    s_add_u32 s64, s32, 0
    s_add_u32 m0, s63, 0
    s_nop 0
    buffer_load_dwordx4 v9, s[12:15], s64 offen lds
    s_add_u32 m0, s63, 1024
    s_nop 0
    buffer_load_dwordx4 v10, s[12:15], s64 offen lds
    s_add_u32 m0, s63, 2048
    s_nop 0
    buffer_load_dwordx4 v11, s[12:15], s64 offen lds
    s_add_u32 s64, s32, 81920
    s_add_u32 m0, s63, 12288
    s_nop 0
    buffer_load_dwordx4 v9, s[12:15], s64 offen lds
    s_add_u32 m0, s63, 13312
    s_nop 0
    buffer_load_dwordx4 v10, s[12:15], s64 offen lds
    s_add_u32 m0, s63, 14336
    s_nop 0
    buffer_load_dwordx4 v11, s[12:15], s64 offen lds
    s_add_u32 s64, s32, 163840
    s_add_u32 m0, s63, 24576
    s_nop 0
    buffer_load_dwordx4 v9, s[12:15], s64 offen lds
    s_add_u32 m0, s63, 25600
    s_nop 0
    buffer_load_dwordx4 v10, s[12:15], s64 offen lds
    s_add_u32 m0, s63, 26624
    s_nop 0
    buffer_load_dwordx4 v11, s[12:15], s64 offen lds
    s_add_u32 s64, s32, 245760
    s_add_u32 m0, s63, 36864
    s_nop 0
    buffer_load_dwordx4 v9, s[12:15], s64 offen lds
    s_add_u32 m0, s63, 37888
    s_nop 0
    buffer_load_dwordx4 v10, s[12:15], s64 offen lds
    s_add_u32 m0, s63, 38912
    s_nop 0
    buffer_load_dwordx4 v11, s[12:15], s64 offen lds
    s_waitcnt vmcnt(21)
    v_dot2_f32_bf16 v56, v16, s67, v56
    v_dot2_f32_bf16 v58, v16, v16, v58
    v_dot2_f32_bf16 v57, v17, s67, v57
    v_dot2_f32_bf16 v59, v17, v17, v59
    v_dot2_f32_bf16 v56, v18, s67, v56
    v_dot2_f32_bf16 v58, v18, v18, v58
    v_dot2_f32_bf16 v57, v19, s67, v57
    v_dot2_f32_bf16 v59, v19, v19, v59
    s_waitcnt vmcnt(20)
    v_dot2_f32_bf16 v56, v20, s67, v56
    v_dot2_f32_bf16 v58, v20, v20, v58
    v_dot2_f32_bf16 v57, v21, s67, v57
    v_dot2_f32_bf16 v59, v21, v21, v59
    v_dot2_f32_bf16 v56, v22, s67, v56
    v_dot2_f32_bf16 v58, v22, v22, v58
    v_dot2_f32_bf16 v57, v23, s67, v57
    v_dot2_f32_bf16 v59, v23, v23, v59
    s_waitcnt vmcnt(19)
    v_dot2_f32_bf16 v56, v24, s67, v56
    v_dot2_f32_bf16 v58, v24, v24, v58
    v_dot2_f32_bf16 v57, v25, s67, v57
    v_dot2_f32_bf16 v59, v25, v25, v59
    v_dot2_f32_bf16 v56, v26, s67, v56
    v_dot2_f32_bf16 v58, v26, v26, v58
    v_dot2_f32_bf16 v57, v27, s67, v57
    v_dot2_f32_bf16 v59, v27, v27, v59
    s_waitcnt vmcnt(18)
    v_dot2_f32_bf16 v56, v28, s67, v56
    v_dot2_f32_bf16 v58, v28, v28, v58
    v_dot2_f32_bf16 v57, v29, s67, v57
    v_dot2_f32_bf16 v59, v29, v29, v59
    v_dot2_f32_bf16 v56, v30, s67, v56
    v_dot2_f32_bf16 v58, v30, v30, v58
    v_dot2_f32_bf16 v57, v31, s67, v57
    v_dot2_f32_bf16 v59, v31, v31, v59
    s_waitcnt vmcnt(17)
    v_dot2_f32_bf16 v56, v32, s67, v56
    v_dot2_f32_bf16 v58, v32, v32, v58
    v_dot2_f32_bf16 v57, v33, s67, v57
    v_dot2_f32_bf16 v59, v33, v33, v59
    v_dot2_f32_bf16 v56, v34, s67, v56
    v_dot2_f32_bf16 v58, v34, v34, v58
    v_dot2_f32_bf16 v57, v35, s67, v57
    v_dot2_f32_bf16 v59, v35, v35, v59
    s_waitcnt vmcnt(16)
    v_dot2_f32_bf16 v56, v36, s67, v56
    v_dot2_f32_bf16 v58, v36, v36, v58
    v_dot2_f32_bf16 v57, v37, s67, v57
    v_dot2_f32_bf16 v59, v37, v37, v59
    v_dot2_f32_bf16 v56, v38, s67, v56
    v_dot2_f32_bf16 v58, v38, v38, v58
    v_dot2_f32_bf16 v57, v39, s67, v57
    v_dot2_f32_bf16 v59, v39, v39, v59
    s_waitcnt vmcnt(15)
    v_dot2_f32_bf16 v56, v40, s67, v56
    v_dot2_f32_bf16 v58, v40, v40, v58
    v_dot2_f32_bf16 v57, v41, s67, v57
    v_dot2_f32_bf16 v59, v41, v41, v59
    v_dot2_f32_bf16 v56, v42, s67, v56
    v_dot2_f32_bf16 v58, v42, v42, v58
    v_dot2_f32_bf16 v57, v43, s67, v57
    v_dot2_f32_bf16 v59, v43, v43, v59
    s_waitcnt vmcnt(14)
    v_dot2_f32_bf16 v56, v44, s67, v56
    v_dot2_f32_bf16 v58, v44, v44, v58
    v_dot2_f32_bf16 v57, v45, s67, v57
    v_dot2_f32_bf16 v59, v45, v45, v59
    v_dot2_f32_bf16 v56, v46, s67, v56
    v_dot2_f32_bf16 v58, v46, v46, v58
    v_dot2_f32_bf16 v57, v47, s67, v57
    v_dot2_f32_bf16 v59, v47, v47, v59
    s_waitcnt vmcnt(13)
    v_dot2_f32_bf16 v56, v48, s67, v56
    v_dot2_f32_bf16 v58, v48, v48, v58
    v_dot2_f32_bf16 v57, v49, s67, v57
    v_dot2_f32_bf16 v59, v49, v49, v59
    v_dot2_f32_bf16 v56, v50, s67, v56
    v_dot2_f32_bf16 v58, v50, v50, v58
    v_dot2_f32_bf16 v57, v51, s67, v57
    v_dot2_f32_bf16 v59, v51, v51, v59
    s_waitcnt vmcnt(12)
    v_dot2_f32_bf16 v56, v52, s67, v56
    v_dot2_f32_bf16 v58, v52, v52, v58
    v_dot2_f32_bf16 v57, v53, s67, v57
    v_dot2_f32_bf16 v59, v53, v53, v59
    v_dot2_f32_bf16 v56, v54, s67, v56
    v_dot2_f32_bf16 v58, v54, v54, v58
    v_dot2_f32_bf16 v57, v55, s67, v57
    v_dot2_f32_bf16 v59, v55, v55, v59
L_p1_stat_done:
    s_cmp_lg_u32 s35, 251
    s_cbranch_scc1 L_p1_noreport
    s_lshr_b32 s61, s27, 5
    s_lshl_b32 s61, s61, 2
    v_mov_b32 v180, 0
    v_mov_b32 v181, 1
    s_mov_b64 exec, 1
    buffer_store_dword v181, v180, s[20:23], s61 offen sc1
    s_mov_b64 exec, -1
L_p1_noreport:
    s_nop 2
    v_add_f32 v56, v56, v57
    v_add_f32 v58, v58, v59
    s_nop 1
    v_add_f32_dpp v56, v56, v56 quad_perm:[1,0,3,2] row_mask:0xf bank_mask:0xf
    v_add_f32_dpp v58, v58, v58 quad_perm:[1,0,3,2] row_mask:0xf bank_mask:0xf
    s_nop 1
    v_add_f32_dpp v56, v56, v56 quad_perm:[2,3,0,1] row_mask:0xf bank_mask:0xf
    v_add_f32_dpp v58, v58, v58 quad_perm:[2,3,0,1] row_mask:0xf bank_mask:0xf
    s_nop 1
    v_add_f32_dpp v56, v56, v56 row_half_mirror row_mask:0xf bank_mask:0xf
    v_add_f32_dpp v58, v58, v58 row_half_mirror row_mask:0xf bank_mask:0xf
    s_nop 0
    v_mul_f32 v56, 0x3acccccd, v56
    v_mul_f32 v58, 0x3acccccd, v58
    v_fma_f32 v58, -v56, v56, v58
    v_max_f32 v58, 0, v58
    v_add_f32 v58, 0x3727c5ac, v58
    v_rsq_f32 v60, v58
    s_nop 0
    v_mul_f32 v61, v56, v60
    v_sub_f32 v61, 0, v61
    v_lshlrev_b32 v64, 16, v16
    v_and_b32 v65, 0xffff0000, v16
    v_lshlrev_b32 v66, 16, v17
    v_and_b32 v67, 0xffff0000, v17
    v_lshlrev_b32 v68, 16, v18
    v_and_b32 v69, 0xffff0000, v18
    v_lshlrev_b32 v70, 16, v19
    v_and_b32 v71, 0xffff0000, v19
    v_pk_fma_f32 v[64:65], v[64:65], v[60:61], v[60:61] op_sel:[0,0,1] op_sel_hi:[1,0,1]
    v_pk_fma_f32 v[66:67], v[66:67], v[60:61], v[60:61] op_sel:[0,0,1] op_sel_hi:[1,0,1]
    v_pk_fma_f32 v[68:69], v[68:69], v[60:61], v[60:61] op_sel:[0,0,1] op_sel_hi:[1,0,1]
    v_pk_fma_f32 v[70:71], v[70:71], v[60:61], v[60:61] op_sel:[0,0,1] op_sel_hi:[1,0,1]
    v_lshlrev_b32 v72, 16, v20
    v_and_b32 v73, 0xffff0000, v20
    v_lshlrev_b32 v74, 16, v21
    v_and_b32 v75, 0xffff0000, v21
    v_lshlrev_b32 v76, 16, v22
    v_and_b32 v77, 0xffff0000, v22
    v_lshlrev_b32 v78, 16, v23
    v_and_b32 v79, 0xffff0000, v23
    v_cvt_pk_bf16_f32 v16, v64, v65
    v_cvt_pk_bf16_f32 v17, v66, v67
    v_cvt_pk_bf16_f32 v18, v68, v69
    v_cvt_pk_bf16_f32 v19, v70, v71
    ds_write_b128 v13, v[16:19] offset:0
    v_pk_fma_f32 v[72:73], v[72:73], v[60:61], v[60:61] op_sel:[0,0,1] op_sel_hi:[1,0,1]
    v_pk_fma_f32 v[74:75], v[74:75], v[60:61], v[60:61] op_sel:[0,0,1] op_sel_hi:[1,0,1]
    v_pk_fma_f32 v[76:77], v[76:77], v[60:61], v[60:61] op_sel:[0,0,1] op_sel_hi:[1,0,1]
    v_pk_fma_f32 v[78:79], v[78:79], v[60:61], v[60:61] op_sel:[0,0,1] op_sel_hi:[1,0,1]
    v_lshlrev_b32 v64, 16, v24
    v_and_b32 v65, 0xffff0000, v24
    v_lshlrev_b32 v66, 16, v25
    v_and_b32 v67, 0xffff0000, v25
    v_lshlrev_b32 v68, 16, v26
    v_and_b32 v69, 0xffff0000, v26
    v_lshlrev_b32 v70, 16, v27
    v_and_b32 v71, 0xffff0000, v27
    v_cvt_pk_bf16_f32 v20, v72, v73
    v_cvt_pk_bf16_f32 v21, v74, v75
    v_cvt_pk_bf16_f32 v22, v76, v77
    v_cvt_pk_bf16_f32 v23, v78, v79
    ds_write_b128 v13, v[20:23] offset:4096
    v_pk_fma_f32 v[64:65], v[64:65], v[60:61], v[60:61] op_sel:[0,0,1] op_sel_hi:[1,0,1]
    v_pk_fma_f32 v[66:67], v[66:67], v[60:61], v[60:61] op_sel:[0,0,1] op_sel_hi:[1,0,1]
    v_pk_fma_f32 v[68:69], v[68:69], v[60:61], v[60:61] op_sel:[0,0,1] op_sel_hi:[1,0,1]
    v_pk_fma_f32 v[70:71], v[70:71], v[60:61], v[60:61] op_sel:[0,0,1] op_sel_hi:[1,0,1]
    v_lshlrev_b32 v72, 16, v28
    v_and_b32 v73, 0xffff0000, v28
    v_lshlrev_b32 v74, 16, v29
    v_and_b32 v75, 0xffff0000, v29
    v_lshlrev_b32 v76, 16, v30
    v_and_b32 v77, 0xffff0000, v30
    v_lshlrev_b32 v78, 16, v31
    v_and_b32 v79, 0xffff0000, v31
    v_cvt_pk_bf16_f32 v24, v64, v65
    v_cvt_pk_bf16_f32 v25, v66, v67
    v_cvt_pk_bf16_f32 v26, v68, v69
    v_cvt_pk_bf16_f32 v27, v70, v71
    ds_write_b128 v13, v[24:27] offset:8192
    v_pk_fma_f32 v[72:73], v[72:73], v[60:61], v[60:61] op_sel:[0,0,1] op_sel_hi:[1,0,1]
    v_pk_fma_f32 v[74:75], v[74:75], v[60:61], v[60:61] op_sel:[0,0,1] op_sel_hi:[1,0,1]
    v_pk_fma_f32 v[76:77], v[76:77], v[60:61], v[60:61] op_sel:[0,0,1] op_sel_hi:[1,0,1]
    v_pk_fma_f32 v[78:79], v[78:79], v[60:61], v[60:61] op_sel:[0,0,1] op_sel_hi:[1,0,1]
    v_lshlrev_b32 v64, 16, v32
    v_and_b32 v65, 0xffff0000, v32
    v_lshlrev_b32 v66, 16, v33
    v_and_b32 v67, 0xffff0000, v33
    v_lshlrev_b32 v68, 16, v34
    v_and_b32 v69, 0xffff0000, v34
    v_lshlrev_b32 v70, 16, v35
    v_and_b32 v71, 0xffff0000, v35
    v_cvt_pk_bf16_f32 v28, v72, v73
    v_cvt_pk_bf16_f32 v29, v74, v75
    v_cvt_pk_bf16_f32 v30, v76, v77
    v_cvt_pk_bf16_f32 v31, v78, v79
    ds_write_b128 v13, v[28:31] offset:12288
    v_pk_fma_f32 v[64:65], v[64:65], v[60:61], v[60:61] op_sel:[0,0,1] op_sel_hi:[1,0,1]
    v_pk_fma_f32 v[66:67], v[66:67], v[60:61], v[60:61] op_sel:[0,0,1] op_sel_hi:[1,0,1]
    v_pk_fma_f32 v[68:69], v[68:69], v[60:61], v[60:61] op_sel:[0,0,1] op_sel_hi:[1,0,1]
    v_pk_fma_f32 v[70:71], v[70:71], v[60:61], v[60:61] op_sel:[0,0,1] op_sel_hi:[1,0,1]
    v_lshlrev_b32 v72, 16, v36
    v_and_b32 v73, 0xffff0000, v36
    v_lshlrev_b32 v74, 16, v37
    v_and_b32 v75, 0xffff0000, v37
    v_lshlrev_b32 v76, 16, v38
    v_and_b32 v77, 0xffff0000, v38
    v_lshlrev_b32 v78, 16, v39
    v_and_b32 v79, 0xffff0000, v39
    v_cvt_pk_bf16_f32 v32, v64, v65
    v_cvt_pk_bf16_f32 v33, v66, v67
    v_cvt_pk_bf16_f32 v34, v68, v69
    v_cvt_pk_bf16_f32 v35, v70, v71
    ds_write_b128 v13, v[32:35] offset:16384
    v_pk_fma_f32 v[72:73], v[72:73], v[60:61], v[60:61] op_sel:[0,0,1] op_sel_hi:[1,0,1]
    v_pk_fma_f32 v[74:75], v[74:75], v[60:61], v[60:61] op_sel:[0,0,1] op_sel_hi:[1,0,1]
    v_pk_fma_f32 v[76:77], v[76:77], v[60:61], v[60:61] op_sel:[0,0,1] op_sel_hi:[1,0,1]
    v_pk_fma_f32 v[78:79], v[78:79], v[60:61], v[60:61] op_sel:[0,0,1] op_sel_hi:[1,0,1]
    v_lshlrev_b32 v64, 16, v40
    v_and_b32 v65, 0xffff0000, v40
    v_lshlrev_b32 v66, 16, v41
    v_and_b32 v67, 0xffff0000, v41
    v_lshlrev_b32 v68, 16, v42
    v_and_b32 v69, 0xffff0000, v42
    v_lshlrev_b32 v70, 16, v43
    v_and_b32 v71, 0xffff0000, v43
    v_cvt_pk_bf16_f32 v36, v72, v73
    v_cvt_pk_bf16_f32 v37, v74, v75
    v_cvt_pk_bf16_f32 v38, v76, v77
    v_cvt_pk_bf16_f32 v39, v78, v79
    ds_write_b128 v13, v[36:39] offset:20480
    v_pk_fma_f32 v[64:65], v[64:65], v[60:61], v[60:61] op_sel:[0,0,1] op_sel_hi:[1,0,1]
    v_pk_fma_f32 v[66:67], v[66:67], v[60:61], v[60:61] op_sel:[0,0,1] op_sel_hi:[1,0,1]
    v_pk_fma_f32 v[68:69], v[68:69], v[60:61], v[60:61] op_sel:[0,0,1] op_sel_hi:[1,0,1]
    v_pk_fma_f32 v[70:71], v[70:71], v[60:61], v[60:61] op_sel:[0,0,1] op_sel_hi:[1,0,1]
    v_lshlrev_b32 v72, 16, v44
    v_and_b32 v73, 0xffff0000, v44
    v_lshlrev_b32 v74, 16, v45
    v_and_b32 v75, 0xffff0000, v45
    v_lshlrev_b32 v76, 16, v46
    v_and_b32 v77, 0xffff0000, v46
    v_lshlrev_b32 v78, 16, v47
    v_and_b32 v79, 0xffff0000, v47
    v_cvt_pk_bf16_f32 v40, v64, v65
    v_cvt_pk_bf16_f32 v41, v66, v67
    v_cvt_pk_bf16_f32 v42, v68, v69
    v_cvt_pk_bf16_f32 v43, v70, v71
    ds_write_b128 v13, v[40:43] offset:24576
    v_pk_fma_f32 v[72:73], v[72:73], v[60:61], v[60:61] op_sel:[0,0,1] op_sel_hi:[1,0,1]
    v_pk_fma_f32 v[74:75], v[74:75], v[60:61], v[60:61] op_sel:[0,0,1] op_sel_hi:[1,0,1]
    v_pk_fma_f32 v[76:77], v[76:77], v[60:61], v[60:61] op_sel:[0,0,1] op_sel_hi:[1,0,1]
    v_pk_fma_f32 v[78:79], v[78:79], v[60:61], v[60:61] op_sel:[0,0,1] op_sel_hi:[1,0,1]
    v_lshlrev_b32 v64, 16, v48
    v_and_b32 v65, 0xffff0000, v48
    v_lshlrev_b32 v66, 16, v49
    v_and_b32 v67, 0xffff0000, v49
    v_lshlrev_b32 v68, 16, v50
    v_and_b32 v69, 0xffff0000, v50
    v_lshlrev_b32 v70, 16, v51
    v_and_b32 v71, 0xffff0000, v51
    v_cvt_pk_bf16_f32 v44, v72, v73
    v_cvt_pk_bf16_f32 v45, v74, v75
    v_cvt_pk_bf16_f32 v46, v76, v77
    v_cvt_pk_bf16_f32 v47, v78, v79
    ds_write_b128 v13, v[44:47] offset:28672
    v_pk_fma_f32 v[64:65], v[64:65], v[60:61], v[60:61] op_sel:[0,0,1] op_sel_hi:[1,0,1]
    v_pk_fma_f32 v[66:67], v[66:67], v[60:61], v[60:61] op_sel:[0,0,1] op_sel_hi:[1,0,1]
    v_pk_fma_f32 v[68:69], v[68:69], v[60:61], v[60:61] op_sel:[0,0,1] op_sel_hi:[1,0,1]
    v_pk_fma_f32 v[70:71], v[70:71], v[60:61], v[60:61] op_sel:[0,0,1] op_sel_hi:[1,0,1]
    v_lshlrev_b32 v72, 16, v52
    v_and_b32 v73, 0xffff0000, v52
    v_lshlrev_b32 v74, 16, v53
    v_and_b32 v75, 0xffff0000, v53
    v_lshlrev_b32 v76, 16, v54
    v_and_b32 v77, 0xffff0000, v54
    v_lshlrev_b32 v78, 16, v55
    v_and_b32 v79, 0xffff0000, v55
    v_cvt_pk_bf16_f32 v48, v64, v65
    v_cvt_pk_bf16_f32 v49, v66, v67
    v_cvt_pk_bf16_f32 v50, v68, v69
    v_cvt_pk_bf16_f32 v51, v70, v71
    ds_write_b128 v13, v[48:51] offset:32768
    v_pk_fma_f32 v[72:73], v[72:73], v[60:61], v[60:61] op_sel:[0,0,1] op_sel_hi:[1,0,1]
    v_pk_fma_f32 v[74:75], v[74:75], v[60:61], v[60:61] op_sel:[0,0,1] op_sel_hi:[1,0,1]
    v_pk_fma_f32 v[76:77], v[76:77], v[60:61], v[60:61] op_sel:[0,0,1] op_sel_hi:[1,0,1]
    v_pk_fma_f32 v[78:79], v[78:79], v[60:61], v[60:61] op_sel:[0,0,1] op_sel_hi:[1,0,1]
    v_cvt_pk_bf16_f32 v52, v72, v73
    v_cvt_pk_bf16_f32 v53, v74, v75
    v_cvt_pk_bf16_f32 v54, v76, v77
    v_cvt_pk_bf16_f32 v55, v78, v79
    ds_write_b128 v13, v[52:55] offset:36864
    s_and_b32 s33, s24, 1
    s_bfe_u32 s34, s24, 0x10001
    v_lshrrev_b32 v80, 5, v2
    v_and_b32 v81, 31, v2
    s_mul_i32 s60, s33, 40960
    v_and_b32 v12, 24, v81
    v_and_b32 v13, 7, v81
    v_lshlrev_b32 v93, 9, v80
    v_or_b32 v15, 0, v80
    v_xor_b32 v15, v15, v13
    v_or_b32 v15, v15, v12
    v_lshl_add_u32 v15, v15, 4, v93
    v_add_u32 v15, s60, v15
    v_add_u32 v84, 0, v15
    v_or_b32 v15, 2, v80
    v_xor_b32 v15, v15, v13
    v_or_b32 v15, v15, v12
    v_lshl_add_u32 v15, v15, 4, v93
    v_add_u32 v15, s60, v15
    v_add_u32 v85, 1024, v15
    v_or_b32 v15, 4, v80
    v_xor_b32 v15, v15, v13
    v_or_b32 v15, v15, v12
    v_lshl_add_u32 v15, v15, 4, v93
    v_add_u32 v15, s60, v15
    v_add_u32 v86, 2048, v15
    v_or_b32 v15, 6, v80
    v_xor_b32 v15, v15, v13
    v_or_b32 v15, v15, v12
    v_lshl_add_u32 v15, v15, 4, v93
    v_add_u32 v15, s60, v15
    v_add_u32 v87, 3072, v15
    v_bfe_u32 v12, v2, 2, 2
    v_lshl_add_u32 v12, v80, 3, v12
    v_bfe_u32 v13, v2, 4, 1
    v_lshlrev_b32 v13, 5, v13
    v_and_b32 v15, 3, v2
    v_lshl_add_u32 v13, v15, 3, v13
    v_mul_u32_u24 v15, 192, v12
    v_add_u32 v15, v15, v13
    s_lshl_b32 s60, s34, 7
    v_add_u32 v94, s60, v15
    v_add_u32 v8, 81920, v94
    v_add_u32 v95, 131072, v94
    v_mul_u32_u24 v15, 40, v12
    v_add_u32 v15, v15, v13
    v_add_u32 v14, 131072, v15
    s_cmp_lt_u32 s24, 4
    s_cbranch_scc1 L_p1_compute
    v_lshlrev_b32 v7, 2, v2
    s_waitcnt vmcnt(0) lgkmcnt(0)
    s_barrier
    s_mul_i32 s31, s29, 3072
    v_mov_b32 v96, v9
    v_mov_b32 v97, v10
    v_mov_b32 v98, v11
    buffer_load_dword v8, v7, s[20:23], 0 offen sc1
    s_add_u32 s64, s32, 327680
    s_add_u32 m0, s31, 131072
    s_nop 0
    buffer_load_dwordx4 v96, s[12:15], s64 offen lds
    s_add_u32 m0, s31, 132096
    s_nop 0
    buffer_load_dwordx4 v97, s[12:15], s64 offen lds
    s_add_u32 m0, s31, 133120
    s_nop 0
    buffer_load_dwordx4 v98, s[12:15], s64 offen lds
    s_add_u32 s64, s32, 409600
    s_add_u32 m0, s31, 143360
    s_nop 0
    buffer_load_dwordx4 v96, s[12:15], s64 offen lds
    s_add_u32 m0, s31, 144384
    s_nop 0
    buffer_load_dwordx4 v97, s[12:15], s64 offen lds
    s_add_u32 m0, s31, 145408
    s_nop 0
    buffer_load_dwordx4 v98, s[12:15], s64 offen lds
    s_and_b32 s60, s2, 7
    s_lshr_b32 s61, s2, 3
    s_mul_i32 s62, s60, 12
    s_mul_i32 s63, s60, 17
    s_add_u32 s63, s63, 96
    s_add_u32 s62, s62, s61
    s_sub_u32 s62, s62, 8
    s_add_u32 s64, s63, s61
    s_sub_u32 s65, s64, 20
    s_add_u32 s64, s64, 12
    s_cmp_lt_u32 s61, 20
    s_cselect_b32 s47, s62, s65
    s_cmp_lt_u32 s61, 8
    s_cselect_b32 s47, s64, s47
    s_sub_u32 s61, s61, 5
    s_cmp_lt_u32 s61, 3
    s_cselect_b32 s47, 255, s47
    s_mul_i32 s34, s29, 10240
    s_add_u32 s34, s34, 106496
    v_lshrrev_b32 v12, 2, v2
    v_and_b32 v15, 3, v2
    v_lshlrev_b32 v13, 6, v12
    v_lshl_add_u32 v13, v15, 3, v13
    v_add_u32 v13, s34, v13
    s_cmp_ge_u32 s47, 96
    s_cbranch_scc1 L_ps_b
    s_cmp_ge_u32 s47, 48
    s_cselect_b32 s60, s50, s48
    s_cselect_b32 s61, s51, s49
    s_cselect_b32 s62, 48, 0
    s_cselect_b32 s66, 1024, 0
    s_mov_b32 s18, 1966080
    s_mov_b32 s87, 49152
    s_sub_u32 s62, s47, s62
    s_lshl_b32 s63, s62, 6
    s_mul_i32 s64, s29, 98304
    s_add_u32 s63, s63, s64
    v_mul_u32_u24 v12, 3072, v12
    s_add_u32 s66, s66, 9437184
    s_add_u32 s82, s63, 0
    s_add_u32 s83, s63, 393216
    s_add_u32 s84, s63, 786432
    s_add_u32 s85, s63, 1179648
    s_add_u32 s86, s63, 1572864
    s_lshl_b32 s63, s62, 1
    s_add_u32 s63, s63, 0
    s_mul_i32 s64, s63, 43691
    s_lshr_b32 s64, s64, 18
    s_mul_i32 s65, s64, 6
    s_sub_u32 s65, s63, s65
    s_mul_i32 s64, s64, 258048
    s_lshl_b32 s65, s65, 11
    s_add_u32 s64, s64, s65
    s_add_u32 s64, s64, s66
    s_add_u32 s88, s64, 245760
    s_mul_i32 s65, s29, 12288
    s_add_u32 s64, s64, s65
    s_add_u32 s72, s64, 0
    s_add_u32 s74, s64, 49152
    s_add_u32 s76, s64, 98304
    s_add_u32 s78, s64, 147456
    s_add_u32 s80, s64, 196608
    s_lshl_b32 s63, s62, 1
    s_add_u32 s63, s63, 1
    s_mul_i32 s64, s63, 43691
    s_lshr_b32 s64, s64, 18
    s_mul_i32 s65, s64, 6
    s_sub_u32 s65, s63, s65
    s_mul_i32 s64, s64, 258048
    s_lshl_b32 s65, s65, 11
    s_add_u32 s64, s64, s65
    s_add_u32 s64, s64, s66
    s_add_u32 s89, s64, 245760
    s_mul_i32 s65, s29, 12288
    s_add_u32 s64, s64, s65
    s_add_u32 s73, s64, 0
    s_add_u32 s75, s64, 49152
    s_add_u32 s77, s64, 98304
    s_add_u32 s79, s64, 147456
    s_add_u32 s81, s64, 196608
    s_branch L_ps_go
L_ps_b:
    s_mov_b32 s88, 1073741824
    s_mov_b32 s89, 1073741824
    s_sub_u32 s62, s47, 96
    s_and_b32 s63, s62, 1
    s_lshr_b32 s62, s62, 1
    s_mul_i32 s63, s63, 10
    s_add_u32 s63, s63, s29
    s_cmp_lt_u32 s29, 2
    s_cselect_b32 s67, 3, 2
    s_cmp_ge_u32 s47, 232
    s_cselect_b32 s67, 0, s67
    s_cmp_ge_u32 s62, 20
    s_cbranch_scc1 L_ps_w2
    s_mov_b32 s60, s44
    s_mov_b32 s61, s45
    s_mov_b32 s18, 819200
    s_mul_i32 s66, s62, 5120
    s_add_u32 s66, s66, 8388608
    s_mov_b32 s68, 102400
    v_lshrrev_b32 v14, 2, v12
    v_and_b32 v12, 3, v12
    s_cmp_ge_u32 s62, 16
    s_cbranch_scc1 L_ps_rem
    s_mul_i32 s64, s62, 40
    s_mov_b32 s87, 10240
    v_lshrrev_b32 v10, 1, v14
    v_mul_u32_u24 v10, 20, v10
    v_and_b32 v14, 1, v14
    v_lshl_add_u32 v14, v14, 2, v10
    v_add3_u32 v12, v14, v12, s64
    s_branch L_ps_rows
L_ps_rem:
    s_sub_u32 s64, s62, 16
    s_mul_i32 s64, s64, 160
    s_add_u32 s64, s64, 16
    s_mov_b32 s87, 25600
    v_mul_u32_u24 v14, 40, v14
    v_add3_u32 v12, v14, v12, s64
    s_branch L_ps_rows
L_ps_w2:
    s_mov_b32 s60, s52
    s_mov_b32 s61, s53
    s_mov_b32 s18, 1966080
    s_sub_u32 s62, s62, 20
    s_lshl_b32 s64, s62, 5
    s_mov_b32 s87, 20480
    v_add_u32 v12, s64, v12
    s_mul_i32 s64, s62, 43691
    s_lshr_b32 s64, s64, 17
    s_mul_i32 s65, s64, 3
    s_sub_u32 s65, s62, s65
    s_lshl_b32 s65, s65, 4
    s_add_u32 s64, s64, s65
    s_mul_i32 s66, s64, 5120
    s_add_u32 s66, s66, 13631488
    s_mov_b32 s68, 245760
L_ps_rows:
    v_mul_u32_u24 v12, 1280, v12
    s_add_u32 s62, s63, 0
    s_lshl_b32 s64, s62, 6
    s_cmp_gt_u32 s67, 0
    s_cselect_b32 s82, s64, 1073741824
    s_lshl_b32 s64, s62, 1
    s_add_u32 s64, s64, 0
    s_mul_i32 s65, s64, 52429
    s_lshr_b32 s65, s65, 18
    s_mul_i32 s69, s65, 5
    s_sub_u32 s64, s64, s69
    s_mul_i32 s65, s65, s68
    s_lshl_b32 s64, s64, 10
    s_add_u32 s64, s64, s65
    s_add_u32 s64, s64, s66
    s_cmp_gt_u32 s67, 0
    s_cselect_b32 s72, s64, 1073741824
    s_lshl_b32 s64, s62, 1
    s_add_u32 s64, s64, 1
    s_mul_i32 s65, s64, 52429
    s_lshr_b32 s65, s65, 18
    s_mul_i32 s69, s65, 5
    s_sub_u32 s64, s64, s69
    s_mul_i32 s65, s65, s68
    s_lshl_b32 s64, s64, 10
    s_add_u32 s64, s64, s65
    s_add_u32 s64, s64, s66
    s_cmp_gt_u32 s67, 0
    s_cselect_b32 s73, s64, 1073741824
    s_add_u32 s62, s63, 4
    s_lshl_b32 s64, s62, 6
    s_cmp_gt_u32 s67, 1
    s_cselect_b32 s83, s64, 1073741824
    s_lshl_b32 s64, s62, 1
    s_add_u32 s64, s64, 0
    s_mul_i32 s65, s64, 52429
    s_lshr_b32 s65, s65, 18
    s_mul_i32 s69, s65, 5
    s_sub_u32 s64, s64, s69
    s_mul_i32 s65, s65, s68
    s_lshl_b32 s64, s64, 10
    s_add_u32 s64, s64, s65
    s_add_u32 s64, s64, s66
    s_cmp_gt_u32 s67, 1
    s_cselect_b32 s74, s64, 1073741824
    s_lshl_b32 s64, s62, 1
    s_add_u32 s64, s64, 1
    s_mul_i32 s65, s64, 52429
    s_lshr_b32 s65, s65, 18
    s_mul_i32 s69, s65, 5
    s_sub_u32 s64, s64, s69
    s_mul_i32 s65, s65, s68
    s_lshl_b32 s64, s64, 10
    s_add_u32 s64, s64, s65
    s_add_u32 s64, s64, s66
    s_cmp_gt_u32 s67, 1
    s_cselect_b32 s75, s64, 1073741824
    s_add_u32 s62, s63, 8
    s_lshl_b32 s64, s62, 6
    s_cmp_gt_u32 s67, 2
    s_cselect_b32 s84, s64, 1073741824
    s_lshl_b32 s64, s62, 1
    s_add_u32 s64, s64, 0
    s_mul_i32 s65, s64, 52429
    s_lshr_b32 s65, s65, 18
    s_mul_i32 s69, s65, 5
    s_sub_u32 s64, s64, s69
    s_mul_i32 s65, s65, s68
    s_lshl_b32 s64, s64, 10
    s_add_u32 s64, s64, s65
    s_add_u32 s64, s64, s66
    s_cmp_gt_u32 s67, 2
    s_cselect_b32 s76, s64, 1073741824
    s_lshl_b32 s64, s62, 1
    s_add_u32 s64, s64, 1
    s_mul_i32 s65, s64, 52429
    s_lshr_b32 s65, s65, 18
    s_mul_i32 s69, s65, 5
    s_sub_u32 s64, s64, s69
    s_mul_i32 s65, s65, s68
    s_lshl_b32 s64, s64, 10
    s_add_u32 s64, s64, s65
    s_add_u32 s64, s64, s66
    s_cmp_gt_u32 s67, 2
    s_cselect_b32 s77, s64, 1073741824
    s_add_u32 s62, s63, 12
    s_lshl_b32 s64, s62, 6
    s_cmp_gt_u32 s67, 3
    s_cselect_b32 s85, s64, 1073741824
    s_lshl_b32 s64, s62, 1
    s_add_u32 s64, s64, 0
    s_mul_i32 s65, s64, 52429
    s_lshr_b32 s65, s65, 18
    s_mul_i32 s69, s65, 5
    s_sub_u32 s64, s64, s69
    s_mul_i32 s65, s65, s68
    s_lshl_b32 s64, s64, 10
    s_add_u32 s64, s64, s65
    s_add_u32 s64, s64, s66
    s_cmp_gt_u32 s67, 3
    s_cselect_b32 s78, s64, 1073741824
    s_lshl_b32 s64, s62, 1
    s_add_u32 s64, s64, 1
    s_mul_i32 s65, s64, 52429
    s_lshr_b32 s65, s65, 18
    s_mul_i32 s69, s65, 5
    s_sub_u32 s64, s64, s69
    s_mul_i32 s65, s65, s68
    s_lshl_b32 s64, s64, 10
    s_add_u32 s64, s64, s65
    s_add_u32 s64, s64, s66
    s_cmp_gt_u32 s67, 3
    s_cselect_b32 s79, s64, 1073741824
    s_add_u32 s62, s63, 16
    s_lshl_b32 s64, s62, 6
    s_cmp_gt_u32 s67, 4
    s_cselect_b32 s86, s64, 1073741824
    s_lshl_b32 s64, s62, 1
    s_add_u32 s64, s64, 0
    s_mul_i32 s65, s64, 52429
    s_lshr_b32 s65, s65, 18
    s_mul_i32 s69, s65, 5
    s_sub_u32 s64, s64, s69
    s_mul_i32 s65, s65, s68
    s_lshl_b32 s64, s64, 10
    s_add_u32 s64, s64, s65
    s_add_u32 s64, s64, s66
    s_cmp_gt_u32 s67, 4
    s_cselect_b32 s80, s64, 1073741824
    s_lshl_b32 s64, s62, 1
    s_add_u32 s64, s64, 1
    s_mul_i32 s65, s64, 52429
    s_lshr_b32 s65, s65, 18
    s_mul_i32 s69, s65, 5
    s_sub_u32 s64, s64, s69
    s_mul_i32 s65, s65, s68
    s_lshl_b32 s64, s64, 10
    s_add_u32 s64, s64, s65
    s_add_u32 s64, s64, s66
    s_cmp_gt_u32 s67, 4
    s_cselect_b32 s81, s64, 1073741824
L_ps_go:
    s_mov_b32 s16, s60
    s_mov_b32 s17, s61
    s_mov_b32 s19, 0x00020000
    v_lshl_add_u32 v12, v15, 4, v12
    s_barrier
    s_add_u32 s64, s32, 491520
    s_add_u32 m0, s31, 0
    s_nop 0
    buffer_load_dwordx4 v96, s[12:15], s64 offen lds
    s_add_u32 m0, s31, 1024
    s_nop 0
    buffer_load_dwordx4 v97, s[12:15], s64 offen lds
    s_add_u32 m0, s31, 2048
    s_nop 0
    buffer_load_dwordx4 v98, s[12:15], s64 offen lds
    s_add_u32 s64, s32, 573440
    s_add_u32 m0, s31, 12288
    s_nop 0
    buffer_load_dwordx4 v96, s[12:15], s64 offen lds
    s_add_u32 m0, s31, 13312
    s_nop 0
    buffer_load_dwordx4 v97, s[12:15], s64 offen lds
    s_add_u32 m0, s31, 14336
    s_nop 0
    buffer_load_dwordx4 v98, s[12:15], s64 offen lds
    s_add_u32 s64, s32, 655360
    s_add_u32 m0, s31, 24576
    s_nop 0
    buffer_load_dwordx4 v96, s[12:15], s64 offen lds
    s_add_u32 m0, s31, 25600
    s_nop 0
    buffer_load_dwordx4 v97, s[12:15], s64 offen lds
    s_add_u32 m0, s31, 26624
    s_nop 0
    buffer_load_dwordx4 v98, s[12:15], s64 offen lds
    s_add_u32 s64, s32, 737280
    s_add_u32 m0, s31, 36864
    s_nop 0
    buffer_load_dwordx4 v96, s[12:15], s64 offen lds
    s_add_u32 m0, s31, 37888
    s_nop 0
    buffer_load_dwordx4 v97, s[12:15], s64 offen lds
    s_add_u32 m0, s31, 38912
    s_nop 0
    buffer_load_dwordx4 v98, s[12:15], s64 offen lds
    s_waitcnt vmcnt(12)
    s_barrier
    v_cmp_gt_u32 s[60:61], 8, v2
    v_cmp_ne_u32 vcc, 1, v8
    s_nop 4
    s_and_b64 s[60:61], vcc, s[60:61]
    s_cbranch_scc0 L_clr_ok
    s_mov_b32 exec_lo, 0xff
    s_mov_b32 exec_hi, 0x0
    s_mov_b32 s60, 0
L_poll_1:
    buffer_load_dword v8, v7, s[20:23], 0 offen sc1
    s_add_u32 s60, s60, 1
    s_waitcnt vmcnt(0)
    v_cmp_ne_u32 vcc, 1, v8
    s_nop 4
    s_cbranch_vccz L_polled_2
    s_cmp_lt_u32 s60, 262144
    s_cbranch_scc1 L_poll_1
L_polled_2:
    s_mov_b64 exec, -1
L_clr_ok:
    v_lshrrev_b32 v8, 5, v2
    v_and_b32 v9, 31, v2
    s_mul_i32 s60, s28, 12288
    v_add_u32 v4, s60, v3
    v_cmp_lt_u32 s[62:63], 20, v9
    v_add_u32 v14, 1024, v4
    s_add_u32 s61, s60, 1360
    v_cndmask_b32 v5, v4, v14, s[62:63]
    v_lshrrev_b32 v14, 4, v9
    v_lshlrev_b32 v14, 9, v14
    v_and_b32 v15, 15, v9
    v_lshl_add_u32 v14, v15, 3, v14
    v_add_u32 v6, s61, v14
    v_add_u32 v28, 81920, v4
    v_add_u32 v29, 81920, v5
    v_add_u32 v30, 81920, v6
    s_mul_i32 s33, s29, 3072
    s_add_u32 s32, s33, 0
    s_mul_i32 s61, s28, 1536
    s_add_u32 s62, s33, s61
    s_add_u32 s62, s62, 106496
    s_sub_u32 s63, s33, s61
    s_add_u32 s63, s63, 108032
    v_add_u32 v209, s62, v3
    v_add_u32 v210, s63, v3
    v_lshlrev_b32 v14, 4, v9
    v_add_u32 v211, s62, v14
    v_add_u32 v212, s63, v14
    v_mov_b32 v7, 155648
    v_mov_b32 v104, 0
    v_mov_b32 v105, 0
    v_mov_b32 v106, 0
    v_mov_b32 v107, 0
    v_mov_b32 v108, 0
    v_mov_b32 v109, 0
    v_mov_b32 v110, 0
    v_mov_b32 v111, 0
    v_mov_b32 v112, 0
    v_mov_b32 v113, 0
    v_mov_b32 v114, 0
    v_mov_b32 v115, 0
    v_mov_b32 v116, 0
    v_mov_b32 v117, 0
    v_mov_b32 v118, 0
    v_mov_b32 v119, 0
    v_mov_b32 v120, 0
    v_mov_b32 v121, 0
    v_mov_b32 v122, 0
    v_mov_b32 v123, 0
    v_mov_b32 v124, 0
    v_mov_b32 v125, 0
    v_mov_b32 v126, 0
    v_mov_b32 v127, 0
    v_mov_b32 v128, 0
    v_mov_b32 v129, 0
    v_mov_b32 v130, 0
    v_mov_b32 v131, 0
    v_mov_b32 v132, 0
    v_mov_b32 v133, 0
    v_mov_b32 v134, 0
    v_mov_b32 v135, 0
    s_waitcnt vmcnt(6)
    s_barrier
    v_lshlrev_b32 v11, 7, v2
    s_mov_b32 s61, 327680
    s_cmp_eq_u32 s24, 7
    s_cselect_b32 exec_lo, -1, 0
    s_mov_b32 exec_hi, 0
    buffer_load_dword v174, v11, s[4:7], s61 offen sc1
    s_mov_b64 exec, -1
    s_waitcnt vmcnt(0)
    s_barrier
    s_cmp_lg_u32 s24, 7
    s_cbranch_scc1 L_kv_noearly
    s_mov_b32 exec_hi, 0
    s_waitcnt vmcnt(0)
    v_cmp_ne_u32 vcc, 8, v174
    v_mov_b32 v14, 1
    v_mov_b32 v15, 163584
    s_nop 2
    s_cbranch_vccnz L_kv_notyet
    ds_write_b32 v15, v14
L_kv_notyet:
    s_mov_b64 exec, -1
L_kv_noearly:
L_p1_ring_done:
    v_lshlrev_b32 v14, 7, v2
    v_lshlrev_b32 v11, 3, v2
    s_mov_b32 s61, 327680
    v_mov_b32 v15, 163584
    s_cmp_lg_u32 s24, 7
    s_cbranch_scc1 L_kv_lds
    ds_read_b32 v10, v15
    s_waitcnt lgkmcnt(0)
    v_readfirstlane_b32 s62, v10
    s_nop 3
    s_cmp_lg_u32 s62, 0
    s_cbranch_scc1 L_kv_seen
    s_mov_b32 exec_lo, 0xffffffff
    s_mov_b32 exec_hi, 0x0
    s_mov_b32 s60, 0
L_poll_3:
    buffer_load_dword v164, v14, s[4:7], s61 offen sc1
    s_add_u32 s60, s60, 1
    s_waitcnt vmcnt(0)
    v_cmp_ne_u32 vcc, 8, v164
    s_nop 4
    s_cbranch_vccz L_polled_4
    s_cmp_lt_u32 s60, 262144
    s_cbranch_scc1 L_poll_3
L_polled_4:
    s_mov_b64 exec, -1
    v_mov_b32 v14, 1
    ds_write_b32 v15, v14
    s_branch L_kv_seen
L_kv_lds:
    s_mov_b32 s60, 0
L_kv_spin:
    ds_read_b32 v14, v15
    s_add_u32 s60, s60, 1
    s_waitcnt lgkmcnt(0)
    v_readfirstlane_b32 s62, v14
    s_cmp_ge_u32 s60, 4194304
    s_cbranch_scc1 L_kv_seen
    s_nop 1
    s_cmp_eq_u32 s62, 0
    s_cbranch_scc1 L_kv_spin
L_kv_seen:
    s_mov_b32 s62, 262144
    buffer_load_dwordx2 v[168:169], v11, s[4:7], s62 offen sc1
    buffer_load_dwordx2 v[170:171], v11, s[4:7], s62 offen offset:512 sc1
    s_add_u32 m0, s33, 81920
    s_add_u32 s61, s32, 0
    buffer_load_dwordx4 v3, s[4:7], s61 offen sc1 lds
    buffer_load_dwordx4 v3, s[4:7], s61 offen offset:1024 sc1 lds
    buffer_load_dwordx4 v3, s[4:7], s61 offen offset:2048 sc1 lds
    s_add_u32 m0, s33, 94208
    s_add_u32 s61, s32, 98304
    buffer_load_dwordx4 v3, s[4:7], s61 offen sc1 lds
    buffer_load_dwordx4 v3, s[4:7], s61 offen offset:1024 sc1 lds
    buffer_load_dwordx4 v3, s[4:7], s61 offen offset:2048 sc1 lds
    v_mov_b32 v167, 0x4e800000
    s_waitcnt vmcnt(6)
    v_max_f32 v14, v168, v169
    v_cmp_nle_f32 s[66:67], v170, v167
    v_cmp_nle_f32 s[64:65], v171, v167
    s_nop 1
    v_max_f32_dpp v14, v14, v14 row_shr:1 row_mask:0xf bank_mask:0xf
    s_nop 1
    v_max_f32_dpp v14, v14, v14 row_shr:2 row_mask:0xf bank_mask:0xf
    s_nop 1
    v_max_f32_dpp v14, v14, v14 row_shr:4 row_mask:0xf bank_mask:0xf
    s_nop 1
    v_max_f32_dpp v14, v14, v14 row_shr:8 row_mask:0xf bank_mask:0xf
    s_nop 1
    v_max_f32_dpp v14, v14, v14 row_bcast:15 row_mask:0xa bank_mask:0xf
    s_nop 1
    v_max_f32_dpp v14, v14, v14 row_bcast:31 row_mask:0xc bank_mask:0xf
    s_or_b64 s[66:67], s[66:67], s[64:65]
    s_cselect_b32 s62, 0x7f800000, 0
    s_nop 0
    v_readlane_b32 s63, v14, 63
    s_nop 3
    s_or_b32 s62, s62, s63
    v_mov_b32 v14, s62
    ds_write_b32 v7, v14
    s_waitcnt vmcnt(0)
    s_branch L_p1_x2
L_p1_compute:
    s_waitcnt vmcnt(1) lgkmcnt(0)
    s_lshl_b32 s60, s29, 2
    s_add_u32 s60, s60, 163600
    v_mov_b32 v76, s60
    v_mov_b32 v77, 1
    ds_write_b32 v76, v77
    v_mov_b32 v12, 163600
    s_mov_b32 s60, 0
L_lw_a:
    ds_read_b128 v[76:79], v12 offset:0
    s_add_u32 s60, s60, 1
    s_waitcnt lgkmcnt(0)
    v_and_b32 v76, v76, v77
    v_and_b32 v76, v76, v78
    v_and_b32 v76, v76, v79
    s_cmp_ge_u32 s60, 4194304
    s_cbranch_scc1 L_lw_done_a
    v_readfirstlane_b32 s61, v76
    s_nop 3
    s_cmp_eq_u32 s61, 0
    s_cbranch_scc1 L_lw_a
L_lw_done_a:
    v_lshrrev_b32 v91, 4, v2
    v_and_b32 v92, 15, v2
    s_lshr_b32 s63, s26, 1
    s_and_b32 s60, s63, 1
    s_lshr_b32 s61, s63, 1
    s_mul_i32 s62, s61, 40960
    s_lshl_b32 s64, s60, 8
    s_add_u32 s62, s62, s64
    s_mul_i32 s64, s29, 10240
    s_add_u32 s62, s62, s64
    s_and_b32 s64, s29, 1
    s_lshl_b32 s64, s64, 2
    v_and_b32 v12, 8, v92
    v_and_b32 v13, 7, v92
    v_lshlrev_b32 v15, 9, v91
    v_add_u32 v15, s62, v15
    v_xor_b32 v13, v13, v91
    v_or_b32 v14, v12, v13
    v_xor_b32 v14, s64, v14
    v_lshl_add_u32 v88, v14, 4, v15
    v_xor_b32 v14, 4, v14
    v_lshl_add_u32 v89, v14, 4, v15
    v_bfe_u32 v12, v2, 2, 2
    v_lshl_add_u32 v12, v91, 3, v12
    v_mul_u32_u24 v12, 40, v12
    v_and_b32 v13, 3, v2
    v_lshl_add_u32 v12, v13, 3, v12
    s_mul_i32 s64, s29, 6400
    s_add_u32 s64, s64, 131072
    v_add_u32 v90, s64, v12
    ds_read_b128 v[96:99], v88 offset:0
    ds_read_b64_tr_b16 v[24:25], v90 offset:0
    ds_read_b64_tr_b16 v[26:27], v90 offset:160
    ds_read_b64_tr_b16 v[28:29], v90 offset:32
    ds_read_b64_tr_b16 v[30:31], v90 offset:192
    ds_read_b128 v[100:103], v89 offset:2048
    ds_read_b64_tr_b16 v[32:33], v90 offset:1280
    ds_read_b64_tr_b16 v[34:35], v90 offset:1440
    ds_read_b64_tr_b16 v[36:37], v90 offset:1312
    ds_read_b64_tr_b16 v[38:39], v90 offset:1472
    ds_read_b128 v[104:107], v88 offset:4096
    ds_read_b64_tr_b16 v[40:41], v90 offset:2560
    ds_read_b64_tr_b16 v[42:43], v90 offset:2720
    ds_read_b64_tr_b16 v[44:45], v90 offset:2592
    ds_read_b64_tr_b16 v[46:47], v90 offset:2752
    s_lshl_b32 s64, s25, 1
    s_add_u32 s64, s64, s61
    s_mul_i32 s65, s64, 3072
    s_add_u32 s65, s65, 0
    s_lshl_b32 s64, s25, 2
    s_add_u32 s64, s64, s63
    s_lshl_b32 s64, s64, 2
    s_add_u32 s64, s64, 262144
    s_mov_b32 s35, s60
    s_lshl_b32 s61, s29, 11
    s_add_u32 s61, s61, 155392
    v_add_u32 v12, s61, v3
    s_bitcmp1_b32 s26, 0
    s_cbranch_scc1 L_kv_v
    s_waitcnt lgkmcnt(10)
    v_mfma_f32_16x16x32_bf16 v[16:19], v[24:27], v[96:99], 0
    v_mfma_f32_16x16x32_bf16 v[20:23], v[28:31], v[96:99], 0
    ds_read_b128 v[108:111], v89 offset:6144
    ds_read_b64_tr_b16 v[48:49], v90 offset:3840
    ds_read_b64_tr_b16 v[50:51], v90 offset:4000
    ds_read_b64_tr_b16 v[52:53], v90 offset:3872
    ds_read_b64_tr_b16 v[54:55], v90 offset:4032
    s_waitcnt lgkmcnt(10)
    v_mfma_f32_16x16x32_bf16 v[16:19], v[32:35], v[100:103], v[16:19]
    v_mfma_f32_16x16x32_bf16 v[20:23], v[36:39], v[100:103], v[20:23]
    ds_read_b128 v[112:115], v88 offset:8192
    ds_read_b64_tr_b16 v[56:57], v90 offset:5120
    ds_read_b64_tr_b16 v[58:59], v90 offset:5280
    ds_read_b64_tr_b16 v[60:61], v90 offset:5152
    ds_read_b64_tr_b16 v[62:63], v90 offset:5312
    s_waitcnt lgkmcnt(10)
    v_mfma_f32_16x16x32_bf16 v[16:19], v[40:43], v[104:107], v[16:19]
    v_mfma_f32_16x16x32_bf16 v[20:23], v[44:47], v[104:107], v[20:23]
    s_waitcnt lgkmcnt(5)
    v_mfma_f32_16x16x32_bf16 v[16:19], v[48:51], v[108:111], v[16:19]
    v_mfma_f32_16x16x32_bf16 v[20:23], v[52:55], v[108:111], v[20:23]
    s_waitcnt lgkmcnt(0)
    v_mfma_f32_16x16x32_bf16 v[16:19], v[56:59], v[112:115], v[16:19]
    v_mfma_f32_16x16x32_bf16 v[20:23], v[60:63], v[112:115], v[20:23]
    s_branch L_kv_part
L_kv_v:
    s_waitcnt lgkmcnt(10)
    v_mfma_f32_16x16x32_bf16 v[16:19], v[96:99], v[24:27], 0
    v_mfma_f32_16x16x32_bf16 v[20:23], v[96:99], v[28:31], 0
    ds_read_b128 v[108:111], v89 offset:6144
    ds_read_b64_tr_b16 v[48:49], v90 offset:3840
    ds_read_b64_tr_b16 v[50:51], v90 offset:4000
    ds_read_b64_tr_b16 v[52:53], v90 offset:3872
    ds_read_b64_tr_b16 v[54:55], v90 offset:4032
    s_waitcnt lgkmcnt(10)
    v_mfma_f32_16x16x32_bf16 v[16:19], v[100:103], v[32:35], v[16:19]
    v_mfma_f32_16x16x32_bf16 v[20:23], v[100:103], v[36:39], v[20:23]
    ds_read_b128 v[112:115], v88 offset:8192
    ds_read_b64_tr_b16 v[56:57], v90 offset:5120
    ds_read_b64_tr_b16 v[58:59], v90 offset:5280
    ds_read_b64_tr_b16 v[60:61], v90 offset:5152
    ds_read_b64_tr_b16 v[62:63], v90 offset:5312
    s_waitcnt lgkmcnt(10)
    v_mfma_f32_16x16x32_bf16 v[16:19], v[104:107], v[40:43], v[16:19]
    v_mfma_f32_16x16x32_bf16 v[20:23], v[104:107], v[44:47], v[20:23]
    s_waitcnt lgkmcnt(5)
    v_mfma_f32_16x16x32_bf16 v[16:19], v[108:111], v[48:51], v[16:19]
    v_mfma_f32_16x16x32_bf16 v[20:23], v[108:111], v[52:55], v[20:23]
    s_waitcnt lgkmcnt(0)
    v_mfma_f32_16x16x32_bf16 v[16:19], v[112:115], v[56:59], v[16:19]
    v_mfma_f32_16x16x32_bf16 v[20:23], v[112:115], v[60:63], v[20:23]
L_kv_part:
    s_cmp_eq_u32 s29, 0
    s_nop 7
    s_cbranch_scc1 L_kv_kept
    ds_write_b128 v12, v[16:19]
    ds_write_b128 v12, v[20:23] offset:1024
    s_waitcnt lgkmcnt(0)
    s_lshl_b32 s60, s29, 2
    s_add_u32 s60, s60, 163616
    v_mov_b32 v76, s60
    v_mov_b32 v77, 1
    ds_write_b32 v76, v77
    s_and_b32 s60, s25, 3
    s_mul_i32 s60, s60, 3
    s_add_u32 s60, s60, s29
    s_sub_u32 s60, s60, 1
    s_mul_i32 s60, s60, 40960
    s_add_u32 s60, s60, 327680
    s_add_u32 s60, s60, s32
    v_lshrrev_b32 v12, 1, v2
    v_mul_u32_u24 v12, 1280, v12
    v_and_b32 v13, 1, v2
    v_mul_u32_u24 v13, 156, v13
    v_add_u32 v12, v12, v13
    buffer_load_dword v83, v12, s[12:15], s60 offen
    s_branch L_kv_done
L_kv_kept:
    v_mov_b32 v12, 163600
    s_mov_b32 s60, 0
L_lw_b:
    ds_read_b128 v[76:79], v12 offset:16
    s_add_u32 s60, s60, 1
    s_waitcnt lgkmcnt(0)
    v_and_b32 v76, v77, v78
    v_and_b32 v76, v76, v79
    s_cmp_ge_u32 s60, 4194304
    s_cbranch_scc1 L_lw_done_b
    v_readfirstlane_b32 s61, v76
    s_nop 3
    s_cmp_eq_u32 s61, 0
    s_cbranch_scc1 L_lw_b
L_lw_done_b:
    v_add_u32 v12, 157440, v3
    ds_read_b128 v[32:35], v12 offset:0
    ds_read_b128 v[36:39], v12 offset:1024
    ds_read_b128 v[40:43], v12 offset:2048
    ds_read_b128 v[44:47], v12 offset:3072
    ds_read_b128 v[48:51], v12 offset:4096
    ds_read_b128 v[52:55], v12 offset:5120
    s_waitcnt lgkmcnt(4)
    v_add_f32 v16, v16, v32
    v_add_f32 v17, v17, v33
    v_add_f32 v18, v18, v34
    v_add_f32 v19, v19, v35
    v_add_f32 v20, v20, v36
    v_add_f32 v21, v21, v37
    v_add_f32 v22, v22, v38
    v_add_f32 v23, v23, v39
    s_waitcnt lgkmcnt(2)
    v_add_f32 v16, v16, v40
    v_add_f32 v17, v17, v41
    v_add_f32 v18, v18, v42
    v_add_f32 v19, v19, v43
    v_add_f32 v20, v20, v44
    v_add_f32 v21, v21, v45
    v_add_f32 v22, v22, v46
    v_add_f32 v23, v23, v47
    s_waitcnt lgkmcnt(0)
    v_add_f32 v16, v16, v48
    v_add_f32 v17, v17, v49
    v_add_f32 v18, v18, v50
    v_add_f32 v19, v19, v51
    v_add_f32 v20, v20, v52
    v_add_f32 v21, v21, v53
    v_add_f32 v22, v22, v54
    v_add_f32 v23, v23, v55
    s_bitcmp1_b32 s26, 0
    s_cbranch_scc1 L_kv_fin_v
    v_and_b32 v12, 1, v91
    v_lshlrev_b32 v12, 9, v12
    v_lshrrev_b32 v13, 1, v91
    v_lshl_add_u32 v12, v13, 3, v12
    v_lshl_add_u32 v12, v92, 4, v12
    s_mov_b32 s60, s35
    v_cvt_pk_bf16_f32 v24, v16, v17
    v_cvt_pk_bf16_f32 v25, v18, v19
    v_cvt_pk_bf16_f32 v26, v20, v21
    v_cvt_pk_bf16_f32 v27, v22, v23
    s_lshl_b32 s61, s60, 8
    s_add_u32 s61, s61, s65
    buffer_store_dwordx2 v[24:25], v12, s[4:7], s61 offen sc1
    v_lshlrev_b32 v13, 3, v92
    v_lshl_add_u32 v13, v91, 28, v13
    s_lshl_b32 s61, s60, 9
    s_add_u32 s61, s61, s65
    v_cmp_eq_u32 s[66:67], 0, v91
    v_mul_f32 v28, v20, v20
    buffer_store_dwordx2 v[26:27], v13, s[4:7], s61 offen offset:1360 sc1
    v_fmac_f32 v28, v21, v21
    v_fmac_f32 v28, v22, v22
    v_fmac_f32 v28, v23, v23
    v_cndmask_b32 v28, 0, v28, s[66:67]
    v_fmac_f32 v28, v16, v16
    v_fmac_f32 v28, v17, v17
    v_fmac_f32 v28, v18, v18
    v_fmac_f32 v28, v19, v19
    v_mov_b32 v29, v28
    s_nop 1
    v_permlane32_swap_b32 v28, v29
    s_nop 1
    v_add_f32 v28, v28, v29
    v_mov_b32 v29, v28
    s_nop 1
    v_permlane16_swap_b32 v28, v29
    s_nop 1
    v_add_f32 v28, v28, v29
    s_nop 1
    v_max_f32_dpp v28, v28, v28 row_shr:1 row_mask:0xf bank_mask:0xf
    s_nop 1
    v_max_f32_dpp v28, v28, v28 row_shr:2 row_mask:0xf bank_mask:0xf
    s_nop 1
    v_max_f32_dpp v28, v28, v28 row_shr:4 row_mask:0xf bank_mask:0xf
    s_nop 1
    v_max_f32_dpp v28, v28, v28 row_shr:8 row_mask:0xf bank_mask:0xf
    s_nop 1
    v_max_f32_dpp v28, v28, v28 row_bcast:15 row_mask:0xa bank_mask:0xf
    s_nop 1
    v_max_f32_dpp v28, v28, v28 row_bcast:31 row_mask:0xc bank_mask:0xf
    v_mov_b32 v12, 0
    s_mov_b32 exec_lo, 0
    s_mov_b32 exec_hi, 0x80000000
    buffer_store_dword v28, v12, s[4:7], s64 offen sc1
    s_mov_b64 exec, -1
    s_branch L_kv_pub
L_kv_fin_v:
    v_and_b32 v12, 1, v91
    v_lshlrev_b32 v12, 9, v12
    v_lshrrev_b32 v13, 1, v91
    v_lshl_add_u32 v12, v13, 3, v12
    v_lshl_add_u32 v12, v92, 4, v12
    s_mov_b32 s60, s35
    v_cvt_pk_bf16_f32 v24, v16, v17
    v_cvt_pk_bf16_f32 v25, v18, v19
    v_cvt_pk_bf16_f32 v26, v20, v21
    v_cvt_pk_bf16_f32 v27, v22, v23
    s_lshl_b32 s61, s60, 10
    s_add_u32 s61, s61, s65
    buffer_store_dwordx2 v[24:25], v12, s[4:7], s61 offen offset:1024 sc1
    v_cmp_gt_u32 s[66:67], 4, v92
    v_cmp_eq_u32 s[68:69], 4, v92
    v_mov_b32 v29, 0x3f803f80
    s_cmp_eq_u32 s60, 0
    s_cselect_b32 s62, 0x001f001f, -1
    v_cndmask_b32 v29, 0, v29, s[68:69]
    v_cndmask_b32 v26, v29, v26, s[66:67]
    v_cndmask_b32 v27, v29, v27, s[66:67]
    v_max3_f32 v28, |v20|, |v21|, |v22|
    v_max_f32 v28, |v23|, v28
    s_mov_b32 exec_lo, s62
    s_mov_b32 exec_hi, s62
    buffer_store_dwordx2 v[26:27], v12, s[4:7], s61 offen offset:1280 sc1
    s_mov_b64 exec, -1
    v_cndmask_b32 v28, 0, v28, s[66:67]
    v_max3_f32 v28, |v16|, |v17|, v28
    v_max3_f32 v28, |v18|, |v19|, v28
    s_nop 1
    v_max_f32_dpp v28, v28, v28 row_shr:1 row_mask:0xf bank_mask:0xf
    s_nop 1
    v_max_f32_dpp v28, v28, v28 row_shr:2 row_mask:0xf bank_mask:0xf
    s_nop 1
    v_max_f32_dpp v28, v28, v28 row_shr:4 row_mask:0xf bank_mask:0xf
    s_nop 1
    v_max_f32_dpp v28, v28, v28 row_shr:8 row_mask:0xf bank_mask:0xf
    s_nop 1
    v_max_f32_dpp v28, v28, v28 row_bcast:15 row_mask:0xa bank_mask:0xf
    s_nop 1
    v_max_f32_dpp v28, v28, v28 row_bcast:31 row_mask:0xc bank_mask:0xf
    v_mov_b32 v12, 0
    s_mov_b32 exec_lo, 0
    s_mov_b32 exec_hi, 0x80000000
    buffer_store_dword v28, v12, s[4:7], s64 offen offset:512 sc1
    s_mov_b64 exec, -1
L_kv_pub:
L_kv_done:
    s_min_u32 s35, s24, 1
    s_waitcnt lgkmcnt(0)
    s_barrier
    s_cmp_eq_u32 s34, 0
    s_cbranch_scc0 L_p1_mq
    ds_read_b128 v[96:99], v84 offset:0
    ds_read_b64_tr_b16 v[48:49], v8 offset:0
    ds_read_b64_tr_b16 v[50:51], v8 offset:768
    ds_read_b64_tr_b16 v[52:53], v8 offset:64
    ds_read_b64_tr_b16 v[54:55], v8 offset:832
    ds_read_b128 v[100:103], v85 offset:0
    ds_read_b64_tr_b16 v[56:57], v8 offset:3072
    ds_read_b64_tr_b16 v[58:59], v8 offset:3840
    ds_read_b64_tr_b16 v[60:61], v8 offset:3136
    ds_read_b64_tr_b16 v[62:63], v8 offset:3904
    s_waitcnt lgkmcnt(5)
    v_mfma_f32_32x32x16_bf16 v[32:47], v[52:55], v[96:99], 0
    ds_read_b64_tr_b16 v[64:65], v8 offset:6144
    ds_read_b64_tr_b16 v[66:67], v8 offset:6912
    ds_read_b64_tr_b16 v[68:69], v8 offset:6208
    ds_read_b64_tr_b16 v[70:71], v8 offset:6976
    ds_read_b128 v[104:107], v86 offset:0
    v_mfma_f32_32x32x16_bf16 v[16:31], v[48:51], v[96:99], 0
    ds_read_b128 v[108:111], v87 offset:0
    ds_read_b128 v[112:115], v84 offset:4096
    ds_read_b128 v[116:119], v85 offset:4096
    ds_read_b128 v[120:123], v86 offset:4096
    s_waitcnt lgkmcnt(9)
    v_mfma_f32_32x32x16_bf16 v[32:47], v[60:63], v[100:103], v[32:47]
    ds_read_b64_tr_b16 v[72:73], v8 offset:9216
    ds_read_b64_tr_b16 v[74:75], v8 offset:9984
    ds_read_b64_tr_b16 v[76:77], v8 offset:9280
    ds_read_b64_tr_b16 v[78:79], v8 offset:10048
    ds_read_b128 v[124:127], v87 offset:4096
    v_mfma_f32_32x32x16_bf16 v[16:31], v[56:59], v[100:103], v[16:31]
    ds_read_b128 v[128:131], v84 offset:8192
    ds_read_b128 v[132:135], v85 offset:8192
    ds_read_b128 v[136:139], v86 offset:8192
    ds_read_b128 v[140:143], v87 offset:8192
    s_waitcnt lgkmcnt(13)
    v_mfma_f32_32x32x16_bf16 v[32:47], v[68:71], v[104:107], v[32:47]
    ds_read_b64_tr_b16 v[48:49], v8 offset:12288
    ds_read_b64_tr_b16 v[50:51], v8 offset:13056
    ds_read_b64_tr_b16 v[52:53], v8 offset:12352
    ds_read_b64_tr_b16 v[54:55], v8 offset:13120
    ds_read_b128 v[144:147], v84 offset:12288
    v_mfma_f32_32x32x16_bf16 v[16:31], v[64:67], v[104:107], v[16:31]
    ds_read_b128 v[148:151], v85 offset:12288
    ds_read_b128 v[152:155], v86 offset:12288
    ds_read_b128 v[156:159], v87 offset:12288
    ds_read_b128 v[160:163], v84 offset:16384
    s_getreg_b32 s60, hwreg(HW_REG_IB_STS, 0, 4)
    s_or_b32 s60, s60, s35
    s_cmp_eq_u32 s60, 0
    s_cbranch_scc1 L_kv_publish2
L_kv_published2:
    s_waitcnt lgkmcnt(14)
    v_mfma_f32_32x32x16_bf16 v[32:47], v[76:79], v[108:111], v[32:47]
    ds_read_b64_tr_b16 v[56:57], v8 offset:15360
    ds_read_b64_tr_b16 v[58:59], v8 offset:16128
    ds_read_b64_tr_b16 v[60:61], v8 offset:15424
    ds_read_b64_tr_b16 v[62:63], v8 offset:16192
    ds_read_b128 v[164:167], v85 offset:16384
    v_mfma_f32_32x32x16_bf16 v[16:31], v[72:75], v[108:111], v[16:31]
    ds_read_b128 v[168:171], v86 offset:16384
    ds_read_b128 v[172:175], v87 offset:16384
    ds_read_b128 v[176:179], v84 offset:20480
    ds_read_b128 v[180:183], v85 offset:20480
    s_waitcnt lgkmcnt(14)
    v_mfma_f32_32x32x16_bf16 v[32:47], v[52:55], v[112:115], v[32:47]
    ds_read_b64_tr_b16 v[64:65], v8 offset:18432
    ds_read_b64_tr_b16 v[66:67], v8 offset:19200
    ds_read_b64_tr_b16 v[68:69], v8 offset:18496
    ds_read_b64_tr_b16 v[70:71], v8 offset:19264
    ds_read_b128 v[184:187], v86 offset:20480
    v_mfma_f32_32x32x16_bf16 v[16:31], v[48:51], v[112:115], v[16:31]
    ds_read_b128 v[188:191], v87 offset:20480
    ds_read_b128 v[192:195], v84 offset:24576
    ds_read_b128 v[196:199], v85 offset:24576
    ds_read_b128 v[200:203], v86 offset:24576
    s_getreg_b32 s60, hwreg(HW_REG_IB_STS, 0, 4)
    s_or_b32 s60, s60, s35
    s_cmp_eq_u32 s60, 0
    s_cbranch_scc1 L_kv_publish4
L_kv_published4:
    s_waitcnt lgkmcnt(14)
    v_mfma_f32_32x32x16_bf16 v[32:47], v[60:63], v[116:119], v[32:47]
    ds_read_b64_tr_b16 v[72:73], v8 offset:21504
    ds_read_b64_tr_b16 v[74:75], v8 offset:22272
    ds_read_b64_tr_b16 v[76:77], v8 offset:21568
    ds_read_b64_tr_b16 v[78:79], v8 offset:22336
    ds_read_b128 v[204:207], v87 offset:24576
    v_mfma_f32_32x32x16_bf16 v[16:31], v[56:59], v[116:119], v[16:31]
    ds_read_b128 v[208:211], v84 offset:28672
    ds_read_b128 v[212:215], v85 offset:28672
    ds_read_b128 v[216:219], v86 offset:28672
    ds_read_b128 v[220:223], v87 offset:28672
    s_waitcnt lgkmcnt(14)
    v_mfma_f32_32x32x16_bf16 v[32:47], v[68:71], v[120:123], v[32:47]
    ds_read_b64_tr_b16 v[48:49], v8 offset:24576
    ds_read_b64_tr_b16 v[50:51], v8 offset:25344
    ds_read_b64_tr_b16 v[52:53], v8 offset:24640
    ds_read_b64_tr_b16 v[54:55], v8 offset:25408
    ds_read_b128 v[224:227], v84 offset:32768
    v_mfma_f32_32x32x16_bf16 v[16:31], v[64:67], v[120:123], v[16:31]
    ds_read_b128 v[228:231], v85 offset:32768
    ds_read_b128 v[232:235], v86 offset:32768
    ds_read_b128 v[236:239], v87 offset:32768
    ds_read_b128 v[240:243], v84 offset:36864
    s_getreg_b32 s60, hwreg(HW_REG_IB_STS, 0, 4)
    s_or_b32 s60, s60, s35
    s_cmp_eq_u32 s60, 0
    s_cbranch_scc1 L_kv_publish6
L_kv_published6:
    s_waitcnt lgkmcnt(14)
    v_mfma_f32_32x32x16_bf16 v[32:47], v[76:79], v[124:127], v[32:47]
    ds_read_b64_tr_b16 v[56:57], v8 offset:27648
    ds_read_b64_tr_b16 v[58:59], v8 offset:28416
    ds_read_b64_tr_b16 v[60:61], v8 offset:27712
    ds_read_b64_tr_b16 v[62:63], v8 offset:28480
    v_mfma_f32_32x32x16_bf16 v[16:31], v[72:75], v[124:127], v[16:31]
    ds_read_b128 v[244:247], v85 offset:36864
    ds_read_b128 v[248:251], v86 offset:36864
    ds_read_b128 v[96:99], v87 offset:36864
    s_waitcnt lgkmcnt(12)
    v_mfma_f32_32x32x16_bf16 v[32:47], v[52:55], v[128:131], v[32:47]
    ds_read_b64_tr_b16 v[64:65], v8 offset:30720
    ds_read_b64_tr_b16 v[66:67], v8 offset:31488
    v_mfma_f32_32x32x16_bf16 v[16:31], v[48:51], v[128:131], v[16:31]
    ds_read_b64_tr_b16 v[68:69], v8 offset:30784
    ds_read_b64_tr_b16 v[70:71], v8 offset:31552
    s_waitcnt lgkmcnt(0)
    s_barrier
    s_getreg_b32 s60, hwreg(HW_REG_IB_STS, 0, 4)
    s_or_b32 s60, s60, s35
    s_cmp_eq_u32 s60, 0
    s_cbranch_scc1 L_kv_publish8
L_kv_published8:
    s_waitcnt lgkmcnt(7)
    v_mfma_f32_32x32x16_bf16 v[32:47], v[60:63], v[132:135], v[32:47]
    ds_read_b64_tr_b16 v[72:73], v8 offset:33792
    ds_read_b64_tr_b16 v[74:75], v8 offset:34560
    v_mfma_f32_32x32x16_bf16 v[16:31], v[56:59], v[132:135], v[16:31]
    ds_read_b64_tr_b16 v[76:77], v8 offset:33856
    ds_read_b64_tr_b16 v[78:79], v8 offset:34624
    s_waitcnt lgkmcnt(4)
    v_mfma_f32_32x32x16_bf16 v[32:47], v[68:71], v[136:139], v[32:47]
    ds_read_b64_tr_b16 v[48:49], v8 offset:36864
    ds_read_b64_tr_b16 v[50:51], v8 offset:37632
    v_mfma_f32_32x32x16_bf16 v[16:31], v[64:67], v[136:139], v[16:31]
    ds_read_b64_tr_b16 v[52:53], v8 offset:36928
    ds_read_b64_tr_b16 v[54:55], v8 offset:37696
    s_getreg_b32 s60, hwreg(HW_REG_IB_STS, 0, 4)
    s_or_b32 s60, s60, s35
    s_cmp_eq_u32 s60, 0
    s_cbranch_scc1 L_kv_publish10
L_kv_published10:
    s_waitcnt lgkmcnt(4)
    v_mfma_f32_32x32x16_bf16 v[32:47], v[76:79], v[140:143], v[32:47]
    ds_read_b64_tr_b16 v[56:57], v8 offset:39936
    ds_read_b64_tr_b16 v[58:59], v8 offset:40704
    v_mfma_f32_32x32x16_bf16 v[16:31], v[72:75], v[140:143], v[16:31]
    ds_read_b64_tr_b16 v[60:61], v8 offset:40000
    ds_read_b64_tr_b16 v[62:63], v8 offset:40768
    s_waitcnt lgkmcnt(4)
    v_mfma_f32_32x32x16_bf16 v[32:47], v[52:55], v[144:147], v[32:47]
    ds_read_b64_tr_b16 v[64:65], v8 offset:43008
    ds_read_b64_tr_b16 v[66:67], v8 offset:43776
    v_mfma_f32_32x32x16_bf16 v[16:31], v[48:51], v[144:147], v[16:31]
    ds_read_b64_tr_b16 v[68:69], v8 offset:43072
    ds_read_b64_tr_b16 v[70:71], v8 offset:43840
    s_getreg_b32 s60, hwreg(HW_REG_IB_STS, 0, 4)
    s_or_b32 s60, s60, s35
    s_cmp_eq_u32 s60, 0
    s_cbranch_scc1 L_kv_publish12
L_kv_published12:
    s_waitcnt lgkmcnt(4)
    v_mfma_f32_32x32x16_bf16 v[32:47], v[60:63], v[148:151], v[32:47]
    ds_read_b64_tr_b16 v[72:73], v8 offset:46080
    ds_read_b64_tr_b16 v[74:75], v8 offset:46848
    v_mfma_f32_32x32x16_bf16 v[16:31], v[56:59], v[148:151], v[16:31]
    ds_read_b64_tr_b16 v[76:77], v8 offset:46144
    ds_read_b64_tr_b16 v[78:79], v8 offset:46912
    s_waitcnt lgkmcnt(4)
    v_mfma_f32_32x32x16_bf16 v[32:47], v[68:71], v[152:155], v[32:47]
    s_barrier
    ds_read_b64_tr_b16 v[48:49], v95 offset:0
    ds_read_b64_tr_b16 v[50:51], v95 offset:768
    v_mfma_f32_32x32x16_bf16 v[16:31], v[64:67], v[152:155], v[16:31]
    ds_read_b64_tr_b16 v[52:53], v95 offset:64
    ds_read_b64_tr_b16 v[54:55], v95 offset:832
    s_getreg_b32 s60, hwreg(HW_REG_IB_STS, 0, 4)
    s_or_b32 s60, s60, s35
    s_cmp_eq_u32 s60, 0
    s_cbranch_scc1 L_kv_publish14
L_kv_published14:
    s_waitcnt lgkmcnt(4)
    v_mfma_f32_32x32x16_bf16 v[32:47], v[76:79], v[156:159], v[32:47]
    ds_read_b64_tr_b16 v[56:57], v95 offset:3072
    ds_read_b64_tr_b16 v[58:59], v95 offset:3840
    v_mfma_f32_32x32x16_bf16 v[16:31], v[72:75], v[156:159], v[16:31]
    ds_read_b64_tr_b16 v[60:61], v95 offset:3136
    ds_read_b64_tr_b16 v[62:63], v95 offset:3904
    s_waitcnt lgkmcnt(4)
    v_mfma_f32_32x32x16_bf16 v[32:47], v[52:55], v[160:163], v[32:47]
    ds_read_b64_tr_b16 v[64:65], v95 offset:6144
    ds_read_b64_tr_b16 v[66:67], v95 offset:6912
    v_mfma_f32_32x32x16_bf16 v[16:31], v[48:51], v[160:163], v[16:31]
    ds_read_b64_tr_b16 v[68:69], v95 offset:6208
    ds_read_b64_tr_b16 v[70:71], v95 offset:6976
    s_getreg_b32 s60, hwreg(HW_REG_IB_STS, 0, 4)
    s_or_b32 s60, s60, s35
    s_cmp_eq_u32 s60, 0
    s_cbranch_scc1 L_kv_publish16
L_kv_published16:
    s_waitcnt lgkmcnt(4)
    v_mfma_f32_32x32x16_bf16 v[32:47], v[60:63], v[164:167], v[32:47]
    ds_read_b64_tr_b16 v[72:73], v95 offset:9216
    ds_read_b64_tr_b16 v[74:75], v95 offset:9984
    v_mfma_f32_32x32x16_bf16 v[16:31], v[56:59], v[164:167], v[16:31]
    ds_read_b64_tr_b16 v[76:77], v95 offset:9280
    ds_read_b64_tr_b16 v[78:79], v95 offset:10048
    s_waitcnt lgkmcnt(4)
    v_mfma_f32_32x32x16_bf16 v[32:47], v[68:71], v[168:171], v[32:47]
    ds_read_b64_tr_b16 v[48:49], v95 offset:12288
    ds_read_b64_tr_b16 v[50:51], v95 offset:13056
    v_mfma_f32_32x32x16_bf16 v[16:31], v[64:67], v[168:171], v[16:31]
    ds_read_b64_tr_b16 v[52:53], v95 offset:12352
    ds_read_b64_tr_b16 v[54:55], v95 offset:13120
    s_getreg_b32 s60, hwreg(HW_REG_IB_STS, 0, 4)
    s_or_b32 s60, s60, s35
    s_cmp_eq_u32 s60, 0
    s_cbranch_scc1 L_kv_publish18
L_kv_published18:
    s_waitcnt lgkmcnt(4)
    v_mfma_f32_32x32x16_bf16 v[32:47], v[76:79], v[172:175], v[32:47]
    ds_read_b64_tr_b16 v[56:57], v95 offset:15360
    ds_read_b64_tr_b16 v[58:59], v95 offset:16128
    v_mfma_f32_32x32x16_bf16 v[16:31], v[72:75], v[172:175], v[16:31]
    ds_read_b64_tr_b16 v[60:61], v95 offset:15424
    ds_read_b64_tr_b16 v[62:63], v95 offset:16192
    s_waitcnt lgkmcnt(4)
    v_mfma_f32_32x32x16_bf16 v[32:47], v[52:55], v[176:179], v[32:47]
    ds_read_b64_tr_b16 v[64:65], v95 offset:18432
    ds_read_b64_tr_b16 v[66:67], v95 offset:19200
    ds_read_b64_tr_b16 v[68:69], v95 offset:18496
    v_mfma_f32_32x32x16_bf16 v[16:31], v[48:51], v[176:179], v[16:31]
    ds_read_b64_tr_b16 v[70:71], v95 offset:19264
    v_mov_b32 v104, 0
    v_mov_b32 v105, 0
    s_getreg_b32 s60, hwreg(HW_REG_IB_STS, 0, 4)
    s_or_b32 s60, s60, s35
    s_cmp_eq_u32 s60, 0
    s_cbranch_scc1 L_kv_publish20
L_kv_published20:
    s_waitcnt lgkmcnt(4)
    v_mfma_f32_32x32x16_bf16 v[32:47], v[60:63], v[180:183], v[32:47]
    ds_read_b64_tr_b16 v[72:73], v95 offset:21504
    ds_read_b64_tr_b16 v[74:75], v95 offset:22272
    ds_read_b64_tr_b16 v[76:77], v95 offset:21568
    v_mfma_f32_32x32x16_bf16 v[16:31], v[56:59], v[180:183], v[16:31]
    ds_read_b64_tr_b16 v[78:79], v95 offset:22336
    v_mov_b32 v106, 0
    v_mov_b32 v107, 0
    s_waitcnt lgkmcnt(4)
    v_mfma_f32_32x32x16_bf16 v[32:47], v[68:71], v[184:187], v[32:47]
    s_barrier
    ds_read_b64_tr_b16 v[48:49], v94 offset:0
    ds_read_b64_tr_b16 v[50:51], v94 offset:768
    ds_read_b64_tr_b16 v[52:53], v94 offset:64
    v_mfma_f32_32x32x16_bf16 v[16:31], v[64:67], v[184:187], v[16:31]
    ds_read_b64_tr_b16 v[54:55], v94 offset:832
    v_mov_b32 v108, 0
    v_mov_b32 v109, 0
    s_getreg_b32 s60, hwreg(HW_REG_IB_STS, 0, 4)
    s_or_b32 s60, s60, s35
    s_cmp_eq_u32 s60, 0
    s_cbranch_scc1 L_kv_publish22
L_kv_published22:
    s_waitcnt lgkmcnt(4)
    v_mfma_f32_32x32x16_bf16 v[32:47], v[76:79], v[188:191], v[32:47]
    ds_read_b64_tr_b16 v[56:57], v94 offset:3072
    ds_read_b64_tr_b16 v[58:59], v94 offset:3840
    ds_read_b64_tr_b16 v[60:61], v94 offset:3136
    v_mfma_f32_32x32x16_bf16 v[16:31], v[72:75], v[188:191], v[16:31]
    ds_read_b64_tr_b16 v[62:63], v94 offset:3904
    v_mov_b32 v110, 0
    v_mov_b32 v111, 0
    s_waitcnt lgkmcnt(4)
    v_mfma_f32_32x32x16_bf16 v[32:47], v[52:55], v[192:195], v[32:47]
    ds_read_b64_tr_b16 v[64:65], v94 offset:6144
    ds_read_b64_tr_b16 v[66:67], v94 offset:6912
    ds_read_b64_tr_b16 v[68:69], v94 offset:6208
    v_mfma_f32_32x32x16_bf16 v[16:31], v[48:51], v[192:195], v[16:31]
    ds_read_b64_tr_b16 v[70:71], v94 offset:6976
    v_mov_b32 v112, 0
    v_mov_b32 v113, 0
    s_cmp_eq_u32 s35, 0
    s_cbranch_scc1 L_kv_publish24
L_kv_published24:
    s_waitcnt lgkmcnt(4)
    v_mfma_f32_32x32x16_bf16 v[32:47], v[60:63], v[196:199], v[32:47]
    ds_read_b64_tr_b16 v[72:73], v94 offset:9216
    ds_read_b64_tr_b16 v[74:75], v94 offset:9984
    ds_read_b64_tr_b16 v[76:77], v94 offset:9280
    v_mfma_f32_32x32x16_bf16 v[16:31], v[56:59], v[196:199], v[16:31]
    ds_read_b64_tr_b16 v[78:79], v94 offset:10048
    v_mov_b32 v114, 0
    v_mov_b32 v115, 0
    s_waitcnt lgkmcnt(4)
    v_mfma_f32_32x32x16_bf16 v[32:47], v[68:71], v[200:203], v[32:47]
    ds_read_b64_tr_b16 v[48:49], v94 offset:12288
    ds_read_b64_tr_b16 v[50:51], v94 offset:13056
    ds_read_b64_tr_b16 v[52:53], v94 offset:12352
    v_mfma_f32_32x32x16_bf16 v[16:31], v[64:67], v[200:203], v[16:31]
    ds_read_b64_tr_b16 v[54:55], v94 offset:13120
    v_mov_b32 v116, 0
    v_mov_b32 v117, 0
    s_waitcnt lgkmcnt(4)
    v_mfma_f32_32x32x16_bf16 v[32:47], v[76:79], v[204:207], v[32:47]
    ds_read_b64_tr_b16 v[56:57], v94 offset:15360
    ds_read_b64_tr_b16 v[58:59], v94 offset:16128
    ds_read_b64_tr_b16 v[60:61], v94 offset:15424
    v_mfma_f32_32x32x16_bf16 v[16:31], v[72:75], v[204:207], v[16:31]
    ds_read_b64_tr_b16 v[62:63], v94 offset:16192
    v_mov_b32 v118, 0
    v_mov_b32 v119, 0
    s_waitcnt lgkmcnt(4)
    v_mfma_f32_32x32x16_bf16 v[32:47], v[52:55], v[208:211], v[32:47]
    ds_read_b64_tr_b16 v[64:65], v94 offset:18432
    ds_read_b64_tr_b16 v[66:67], v94 offset:19200
    ds_read_b64_tr_b16 v[68:69], v94 offset:18496
    v_mfma_f32_32x32x16_bf16 v[16:31], v[48:51], v[208:211], v[16:31]
    ds_read_b64_tr_b16 v[70:71], v94 offset:19264
    v_mov_b32 v120, 0
    v_mov_b32 v121, 0
    s_waitcnt lgkmcnt(4)
    v_mfma_f32_32x32x16_bf16 v[32:47], v[60:63], v[212:215], v[32:47]
    ds_read_b64_tr_b16 v[72:73], v94 offset:21504
    ds_read_b64_tr_b16 v[74:75], v94 offset:22272
    ds_read_b64_tr_b16 v[76:77], v94 offset:21568
    v_mfma_f32_32x32x16_bf16 v[16:31], v[56:59], v[212:215], v[16:31]
    ds_read_b64_tr_b16 v[78:79], v94 offset:22336
    v_mov_b32 v122, 0
    v_mov_b32 v123, 0
    s_waitcnt lgkmcnt(4)
    v_mfma_f32_32x32x16_bf16 v[32:47], v[68:71], v[216:219], v[32:47]
    s_barrier
    ds_read_b64_tr_b16 v[48:49], v94 offset:24576
    ds_read_b64_tr_b16 v[50:51], v94 offset:25344
    ds_read_b64_tr_b16 v[52:53], v94 offset:24640
    v_mfma_f32_32x32x16_bf16 v[16:31], v[64:67], v[216:219], v[16:31]
    ds_read_b64_tr_b16 v[54:55], v94 offset:25408
    v_mov_b32 v124, 0
    v_mov_b32 v125, 0
    s_waitcnt lgkmcnt(4)
    v_mfma_f32_32x32x16_bf16 v[32:47], v[76:79], v[220:223], v[32:47]
    ds_read_b64_tr_b16 v[56:57], v94 offset:27648
    ds_read_b64_tr_b16 v[58:59], v94 offset:28416
    ds_read_b64_tr_b16 v[60:61], v94 offset:27712
    v_mfma_f32_32x32x16_bf16 v[16:31], v[72:75], v[220:223], v[16:31]
    ds_read_b64_tr_b16 v[62:63], v94 offset:28480
    v_mov_b32 v126, 0
    v_mov_b32 v127, 0
    s_waitcnt lgkmcnt(4)
    v_mfma_f32_32x32x16_bf16 v[32:47], v[52:55], v[224:227], v[32:47]
    ds_read_b64_tr_b16 v[64:65], v94 offset:30720
    ds_read_b64_tr_b16 v[66:67], v94 offset:31488
    ds_read_b64_tr_b16 v[68:69], v94 offset:30784
    v_mfma_f32_32x32x16_bf16 v[16:31], v[48:51], v[224:227], v[16:31]
    ds_read_b64_tr_b16 v[70:71], v94 offset:31552
    v_mov_b32 v128, 0
    v_mov_b32 v129, 0
    s_waitcnt lgkmcnt(4)
    v_mfma_f32_32x32x16_bf16 v[32:47], v[60:63], v[228:231], v[32:47]
    ds_read_b64_tr_b16 v[72:73], v94 offset:33792
    ds_read_b64_tr_b16 v[74:75], v94 offset:34560
    ds_read_b64_tr_b16 v[76:77], v94 offset:33856
    v_mfma_f32_32x32x16_bf16 v[16:31], v[56:59], v[228:231], v[16:31]
    ds_read_b64_tr_b16 v[78:79], v94 offset:34624
    v_mov_b32 v130, 0
    v_mov_b32 v131, 0
    s_waitcnt lgkmcnt(4)
    v_mfma_f32_32x32x16_bf16 v[32:47], v[68:71], v[232:235], v[32:47]
    ds_read_b64_tr_b16 v[48:49], v94 offset:36864
    ds_read_b64_tr_b16 v[50:51], v94 offset:37632
    ds_read_b64_tr_b16 v[52:53], v94 offset:36928
    v_mfma_f32_32x32x16_bf16 v[16:31], v[64:67], v[232:235], v[16:31]
    ds_read_b64_tr_b16 v[54:55], v94 offset:37696
    v_mov_b32 v132, 0
    v_mov_b32 v133, 0
    s_waitcnt lgkmcnt(4)
    v_mfma_f32_32x32x16_bf16 v[32:47], v[76:79], v[236:239], v[32:47]
    ds_read_b64_tr_b16 v[56:57], v94 offset:39936
    ds_read_b64_tr_b16 v[58:59], v94 offset:40704
    ds_read_b64_tr_b16 v[60:61], v94 offset:40000
    v_mfma_f32_32x32x16_bf16 v[16:31], v[72:75], v[236:239], v[16:31]
    ds_read_b64_tr_b16 v[62:63], v94 offset:40768
    v_mov_b32 v134, 0
    v_mov_b32 v135, 0
    s_waitcnt lgkmcnt(4)
    v_mfma_f32_32x32x16_bf16 v[32:47], v[52:55], v[240:243], v[32:47]
    ds_read_b64_tr_b16 v[64:65], v94 offset:43008
    ds_read_b64_tr_b16 v[66:67], v94 offset:43776
    v_mfma_f32_32x32x16_bf16 v[16:31], v[48:51], v[240:243], v[16:31]
    ds_read_b64_tr_b16 v[68:69], v94 offset:43072
    ds_read_b64_tr_b16 v[70:71], v94 offset:43840
    s_waitcnt lgkmcnt(4)
    v_mfma_f32_32x32x16_bf16 v[32:47], v[60:63], v[244:247], v[32:47]
    ds_read_b64_tr_b16 v[72:73], v94 offset:46080
    ds_read_b64_tr_b16 v[74:75], v94 offset:46848
    v_mfma_f32_32x32x16_bf16 v[16:31], v[56:59], v[244:247], v[16:31]
    ds_read_b64_tr_b16 v[76:77], v94 offset:46144
    ds_read_b64_tr_b16 v[78:79], v94 offset:46912
    s_waitcnt lgkmcnt(4)
    v_mfma_f32_32x32x16_bf16 v[32:47], v[68:71], v[248:251], v[32:47]
    v_mfma_f32_32x32x16_bf16 v[16:31], v[64:67], v[248:251], v[16:31]
    s_waitcnt lgkmcnt(0)
    v_mfma_f32_32x32x16_bf16 v[32:47], v[76:79], v[96:99], v[32:47]
    v_mfma_f32_32x32x16_bf16 v[16:31], v[72:75], v[96:99], v[16:31]
    s_mul_i32 s60, s33, 1536
    v_lshl_add_u32 v12, v81, 4, s60
    v_xor_b32 v13, 1, v80
    s_mov_b32 s62, 0x3ea52b5c
    s_nop 7
    s_mov_b32 s61, 504
    v_mul_f32 v32, s62, v32
    v_mul_f32 v33, s62, v33
    v_mul_f32 v34, s62, v34
    v_mul_f32 v35, s62, v35
    v_mad_u32_u24 v14, v80, s61, v12
    v_add_u32 v14, 110088, v14
    v_cvt_pk_bf16_f32 v4, v32, v33
    v_cvt_pk_bf16_f32 v5, v34, v35
    ds_write_b64 v14, v[4:5]
    s_mov_b32 s61, 512
    v_mul_f32 v36, s62, v36
    v_mul_f32 v37, s62, v37
    v_mul_f32 v38, s62, v38
    v_mul_f32 v39, s62, v39
    v_mad_u32_u24 v14, v80, s61, v12
    v_add_u32 v14, 112640, v14
    v_cvt_pk_bf16_f32 v6, v36, v37
    v_cvt_pk_bf16_f32 v7, v38, v39
    ds_write_b64 v14, v[6:7]
    s_mov_b32 s61, 512
    v_mul_f32 v40, s62, v40
    v_mul_f32 v41, s62, v41
    v_mul_f32 v42, s62, v42
    v_mul_f32 v43, s62, v43
    v_mad_u32_u24 v14, v80, s61, v12
    v_add_u32 v14, 112648, v14
    v_cvt_pk_bf16_f32 v4, v40, v41
    v_cvt_pk_bf16_f32 v5, v42, v43
    ds_write_b64 v14, v[4:5]
    s_mov_b32 s61, 2048
    v_mul_f32 v44, s62, v44
    v_mul_f32 v45, s62, v45
    v_mul_f32 v46, s62, v46
    v_mul_f32 v47, s62, v47
    v_mad_u32_u24 v14, v80, s61, v12
    v_add_u32 v14, 113664, v14
    v_cvt_pk_bf16_f32 v6, v44, v45
    v_cvt_pk_bf16_f32 v7, v46, v47
    ds_write_b64 v14, v[6:7]
    s_mov_b32 s61, 512
    v_mul_f32 v16, s62, v16
    v_mul_f32 v17, s62, v17
    v_mul_f32 v18, s62, v18
    v_mul_f32 v19, s62, v19
    v_mad_u32_u24 v14, v80, s61, v12
    v_add_u32 v14, 106496, v14
    v_cvt_pk_bf16_f32 v4, v16, v17
    v_cvt_pk_bf16_f32 v5, v18, v19
    ds_write_b64 v14, v[4:5]
    s_mov_b32 s61, 512
    v_mul_f32 v20, s62, v20
    v_mul_f32 v21, s62, v21
    v_mul_f32 v22, s62, v22
    v_mul_f32 v23, s62, v23
    v_mad_u32_u24 v14, v80, s61, v12
    v_add_u32 v14, 106504, v14
    v_cvt_pk_bf16_f32 v6, v20, v21
    v_cvt_pk_bf16_f32 v7, v22, v23
    ds_write_b64 v14, v[6:7]
    s_mov_b32 s61, 2048
    v_mul_f32 v24, s62, v24
    v_mul_f32 v25, s62, v25
    v_mul_f32 v26, s62, v26
    v_mul_f32 v27, s62, v27
    v_mad_u32_u24 v14, v80, s61, v12
    v_add_u32 v14, 107520, v14
    v_cvt_pk_bf16_f32 v4, v24, v25
    v_cvt_pk_bf16_f32 v5, v26, v27
    ds_write_b64 v14, v[4:5]
    s_mov_b32 s61, 504
    v_mul_f32 v28, s62, v28
    v_mul_f32 v29, s62, v29
    v_mul_f32 v30, s62, v30
    v_mul_f32 v31, s62, v31
    v_mad_u32_u24 v14, v13, s61, v12
    v_add_u32 v14, 109576, v14
    v_cvt_pk_bf16_f32 v6, v28, v29
    v_cvt_pk_bf16_f32 v7, v30, v31
    ds_write_b64 v14, v[6:7]
    s_branch L_p1_q_done
L_p1_mq:
    ds_read_b128 v[96:99], v84 offset:0
    ds_read_b64_tr_b16 v[48:49], v8 offset:0
    ds_read_b64_tr_b16 v[50:51], v8 offset:768
    ds_read_b128 v[100:103], v85 offset:0
    ds_read_b64_tr_b16 v[56:57], v8 offset:3072
    ds_read_b64_tr_b16 v[58:59], v8 offset:3840
    s_waitcnt lgkmcnt(3)
    v_mfma_f32_32x32x16_bf16 v[16:31], v[48:51], v[96:99], 0
    ds_read_b64_tr_b16 v[64:65], v8 offset:6144
    ds_read_b64_tr_b16 v[66:67], v8 offset:6912
    ds_read_b128 v[104:107], v86 offset:0
    ds_read_b128 v[108:111], v87 offset:0
    ds_read_b128 v[112:115], v84 offset:4096
    ds_read_b128 v[116:119], v85 offset:4096
    ds_read_b128 v[120:123], v86 offset:4096
    s_waitcnt lgkmcnt(7)
    v_mfma_f32_32x32x16_bf16 v[16:31], v[56:59], v[100:103], v[16:31]
    ds_read_b64_tr_b16 v[72:73], v8 offset:9216
    ds_read_b64_tr_b16 v[74:75], v8 offset:9984
    ds_read_b128 v[124:127], v87 offset:4096
    ds_read_b128 v[128:131], v84 offset:8192
    ds_read_b128 v[132:135], v85 offset:8192
    ds_read_b128 v[136:139], v86 offset:8192
    ds_read_b128 v[140:143], v87 offset:8192
    s_waitcnt lgkmcnt(11)
    v_mfma_f32_32x32x16_bf16 v[16:31], v[64:67], v[104:107], v[16:31]
    ds_read_b64_tr_b16 v[48:49], v8 offset:12288
    ds_read_b64_tr_b16 v[50:51], v8 offset:13056
    ds_read_b128 v[144:147], v84 offset:12288
    ds_read_b128 v[148:151], v85 offset:12288
    ds_read_b128 v[152:155], v86 offset:12288
    ds_read_b128 v[156:159], v87 offset:12288
    ds_read_b128 v[160:163], v84 offset:16384
    s_waitcnt lgkmcnt(12)
    v_mfma_f32_32x32x16_bf16 v[16:31], v[72:75], v[108:111], v[16:31]
    ds_read_b64_tr_b16 v[56:57], v8 offset:15360
    ds_read_b64_tr_b16 v[58:59], v8 offset:16128
    ds_read_b128 v[164:167], v85 offset:16384
    ds_read_b128 v[168:171], v86 offset:16384
    ds_read_b128 v[172:175], v87 offset:16384
    ds_read_b128 v[176:179], v84 offset:20480
    ds_read_b128 v[180:183], v85 offset:20480
    s_waitcnt lgkmcnt(12)
    v_mfma_f32_32x32x16_bf16 v[16:31], v[48:51], v[112:115], v[16:31]
    ds_read_b64_tr_b16 v[64:65], v8 offset:18432
    ds_read_b64_tr_b16 v[66:67], v8 offset:19200
    ds_read_b128 v[184:187], v86 offset:20480
    ds_read_b128 v[188:191], v87 offset:20480
    ds_read_b128 v[192:195], v84 offset:24576
    ds_read_b128 v[196:199], v85 offset:24576
    ds_read_b128 v[200:203], v86 offset:24576
    s_waitcnt lgkmcnt(12)
    v_mfma_f32_32x32x16_bf16 v[16:31], v[56:59], v[116:119], v[16:31]
    ds_read_b64_tr_b16 v[72:73], v8 offset:21504
    ds_read_b64_tr_b16 v[74:75], v8 offset:22272
    ds_read_b128 v[204:207], v87 offset:24576
    ds_read_b128 v[208:211], v84 offset:28672
    ds_read_b128 v[212:215], v85 offset:28672
    ds_read_b128 v[216:219], v86 offset:28672
    ds_read_b128 v[220:223], v87 offset:28672
    s_waitcnt lgkmcnt(12)
    v_mfma_f32_32x32x16_bf16 v[16:31], v[64:67], v[120:123], v[16:31]
    ds_read_b64_tr_b16 v[48:49], v8 offset:24576
    ds_read_b64_tr_b16 v[50:51], v8 offset:25344
    ds_read_b128 v[224:227], v84 offset:32768
    ds_read_b128 v[228:231], v85 offset:32768
    ds_read_b128 v[232:235], v86 offset:32768
    ds_read_b128 v[236:239], v87 offset:32768
    ds_read_b128 v[240:243], v84 offset:36864
    s_waitcnt lgkmcnt(12)
    v_mfma_f32_32x32x16_bf16 v[16:31], v[72:75], v[124:127], v[16:31]
    ds_read_b64_tr_b16 v[56:57], v8 offset:27648
    ds_read_b64_tr_b16 v[58:59], v8 offset:28416
    ds_read_b128 v[244:247], v85 offset:36864
    ds_read_b128 v[248:251], v86 offset:36864
    ds_read_b128 v[96:99], v87 offset:36864
    s_waitcnt lgkmcnt(10)
    v_mfma_f32_32x32x16_bf16 v[16:31], v[48:51], v[128:131], v[16:31]
    ds_read_b64_tr_b16 v[64:65], v8 offset:30720
    ds_read_b64_tr_b16 v[66:67], v8 offset:31488
    s_waitcnt lgkmcnt(0)
    s_barrier
    s_waitcnt lgkmcnt(5)
    v_mfma_f32_32x32x16_bf16 v[16:31], v[56:59], v[132:135], v[16:31]
    ds_read_b64_tr_b16 v[72:73], v8 offset:33792
    ds_read_b64_tr_b16 v[74:75], v8 offset:34560
    s_waitcnt lgkmcnt(2)
    v_mfma_f32_32x32x16_bf16 v[16:31], v[64:67], v[136:139], v[16:31]
    ds_read_b64_tr_b16 v[48:49], v8 offset:36864
    ds_read_b64_tr_b16 v[50:51], v8 offset:37632
    s_waitcnt lgkmcnt(2)
    v_mfma_f32_32x32x16_bf16 v[16:31], v[72:75], v[140:143], v[16:31]
    ds_read_b64_tr_b16 v[56:57], v8 offset:39936
    ds_read_b64_tr_b16 v[58:59], v8 offset:40704
    s_waitcnt lgkmcnt(2)
    v_mfma_f32_32x32x16_bf16 v[16:31], v[48:51], v[144:147], v[16:31]
    ds_read_b64_tr_b16 v[64:65], v8 offset:43008
    ds_read_b64_tr_b16 v[66:67], v8 offset:43776
    s_waitcnt lgkmcnt(2)
    v_mfma_f32_32x32x16_bf16 v[16:31], v[56:59], v[148:151], v[16:31]
    ds_read_b64_tr_b16 v[72:73], v8 offset:46080
    ds_read_b64_tr_b16 v[74:75], v8 offset:46848
    s_waitcnt lgkmcnt(2)
    v_mfma_f32_32x32x16_bf16 v[16:31], v[64:67], v[152:155], v[16:31]
    s_barrier
    ds_read_b64_tr_b16 v[48:49], v95 offset:0
    ds_read_b64_tr_b16 v[50:51], v95 offset:768
    s_waitcnt lgkmcnt(2)
    v_mfma_f32_32x32x16_bf16 v[16:31], v[72:75], v[156:159], v[16:31]
    ds_read_b64_tr_b16 v[56:57], v95 offset:3072
    ds_read_b64_tr_b16 v[58:59], v95 offset:3840
    s_waitcnt lgkmcnt(2)
    v_mfma_f32_32x32x16_bf16 v[16:31], v[48:51], v[160:163], v[16:31]
    ds_read_b64_tr_b16 v[64:65], v95 offset:6144
    ds_read_b64_tr_b16 v[66:67], v95 offset:6912
    s_waitcnt lgkmcnt(2)
    v_mfma_f32_32x32x16_bf16 v[16:31], v[56:59], v[164:167], v[16:31]
    ds_read_b64_tr_b16 v[72:73], v95 offset:9216
    ds_read_b64_tr_b16 v[74:75], v95 offset:9984
    s_waitcnt lgkmcnt(2)
    v_mfma_f32_32x32x16_bf16 v[16:31], v[64:67], v[168:171], v[16:31]
    ds_read_b64_tr_b16 v[48:49], v95 offset:12288
    ds_read_b64_tr_b16 v[50:51], v95 offset:13056
    s_waitcnt lgkmcnt(2)
    v_mfma_f32_32x32x16_bf16 v[16:31], v[72:75], v[172:175], v[16:31]
    ds_read_b64_tr_b16 v[56:57], v95 offset:15360
    ds_read_b64_tr_b16 v[58:59], v95 offset:16128
    s_waitcnt lgkmcnt(2)
    v_mfma_f32_32x32x16_bf16 v[16:31], v[48:51], v[176:179], v[16:31]
    ds_read_b64_tr_b16 v[64:65], v95 offset:18432
    ds_read_b64_tr_b16 v[66:67], v95 offset:19200
    v_mov_b32 v104, 0
    v_mov_b32 v105, 0
    s_waitcnt lgkmcnt(2)
    v_mfma_f32_32x32x16_bf16 v[16:31], v[56:59], v[180:183], v[16:31]
    ds_read_b64_tr_b16 v[72:73], v95 offset:21504
    ds_read_b64_tr_b16 v[74:75], v95 offset:22272
    v_mov_b32 v106, 0
    v_mov_b32 v107, 0
    s_waitcnt lgkmcnt(2)
    v_mfma_f32_32x32x16_bf16 v[16:31], v[64:67], v[184:187], v[16:31]
    s_barrier
    ds_read_b64_tr_b16 v[48:49], v94 offset:0
    ds_read_b64_tr_b16 v[50:51], v94 offset:768
    v_mov_b32 v108, 0
    v_mov_b32 v109, 0
    s_waitcnt lgkmcnt(2)
    v_mfma_f32_32x32x16_bf16 v[16:31], v[72:75], v[188:191], v[16:31]
    ds_read_b64_tr_b16 v[56:57], v94 offset:3072
    ds_read_b64_tr_b16 v[58:59], v94 offset:3840
    v_mov_b32 v110, 0
    v_mov_b32 v111, 0
    s_waitcnt lgkmcnt(2)
    v_mfma_f32_32x32x16_bf16 v[16:31], v[48:51], v[192:195], v[16:31]
    ds_read_b64_tr_b16 v[64:65], v94 offset:6144
    ds_read_b64_tr_b16 v[66:67], v94 offset:6912
    v_mov_b32 v112, 0
    v_mov_b32 v113, 0
    s_waitcnt lgkmcnt(2)
    v_mfma_f32_32x32x16_bf16 v[16:31], v[56:59], v[196:199], v[16:31]
    ds_read_b64_tr_b16 v[72:73], v94 offset:9216
    ds_read_b64_tr_b16 v[74:75], v94 offset:9984
    v_mov_b32 v114, 0
    v_mov_b32 v115, 0
    s_waitcnt lgkmcnt(2)
    v_mfma_f32_32x32x16_bf16 v[16:31], v[64:67], v[200:203], v[16:31]
    ds_read_b64_tr_b16 v[48:49], v94 offset:12288
    ds_read_b64_tr_b16 v[50:51], v94 offset:13056
    v_mov_b32 v116, 0
    v_mov_b32 v117, 0
    s_waitcnt lgkmcnt(2)
    v_mfma_f32_32x32x16_bf16 v[16:31], v[72:75], v[204:207], v[16:31]
    ds_read_b64_tr_b16 v[56:57], v94 offset:15360
    ds_read_b64_tr_b16 v[58:59], v94 offset:16128
    v_mov_b32 v118, 0
    v_mov_b32 v119, 0
    s_waitcnt lgkmcnt(2)
    v_mfma_f32_32x32x16_bf16 v[16:31], v[48:51], v[208:211], v[16:31]
    ds_read_b64_tr_b16 v[64:65], v94 offset:18432
    ds_read_b64_tr_b16 v[66:67], v94 offset:19200
    v_mov_b32 v120, 0
    v_mov_b32 v121, 0
    s_waitcnt lgkmcnt(2)
    v_mfma_f32_32x32x16_bf16 v[16:31], v[56:59], v[212:215], v[16:31]
    ds_read_b64_tr_b16 v[72:73], v94 offset:21504
    ds_read_b64_tr_b16 v[74:75], v94 offset:22272
    v_mov_b32 v122, 0
    v_mov_b32 v123, 0
    s_waitcnt lgkmcnt(2)
    v_mfma_f32_32x32x16_bf16 v[16:31], v[64:67], v[216:219], v[16:31]
    s_barrier
    ds_read_b64_tr_b16 v[48:49], v94 offset:24576
    ds_read_b64_tr_b16 v[50:51], v94 offset:25344
    v_mov_b32 v124, 0
    v_mov_b32 v125, 0
    s_waitcnt lgkmcnt(2)
    v_mfma_f32_32x32x16_bf16 v[16:31], v[72:75], v[220:223], v[16:31]
    ds_read_b64_tr_b16 v[56:57], v94 offset:27648
    ds_read_b64_tr_b16 v[58:59], v94 offset:28416
    v_mov_b32 v126, 0
    v_mov_b32 v127, 0
    s_waitcnt lgkmcnt(2)
    v_mfma_f32_32x32x16_bf16 v[16:31], v[48:51], v[224:227], v[16:31]
    ds_read_b64_tr_b16 v[64:65], v94 offset:30720
    ds_read_b64_tr_b16 v[66:67], v94 offset:31488
    v_mov_b32 v128, 0
    v_mov_b32 v129, 0
    s_waitcnt lgkmcnt(2)
    v_mfma_f32_32x32x16_bf16 v[16:31], v[56:59], v[228:231], v[16:31]
    ds_read_b64_tr_b16 v[72:73], v94 offset:33792
    ds_read_b64_tr_b16 v[74:75], v94 offset:34560
    v_mov_b32 v130, 0
    v_mov_b32 v131, 0
    s_waitcnt lgkmcnt(2)
    v_mfma_f32_32x32x16_bf16 v[16:31], v[64:67], v[232:235], v[16:31]
    ds_read_b64_tr_b16 v[48:49], v94 offset:36864
    ds_read_b64_tr_b16 v[50:51], v94 offset:37632
    v_mov_b32 v132, 0
    v_mov_b32 v133, 0
    s_waitcnt lgkmcnt(2)
    v_mfma_f32_32x32x16_bf16 v[16:31], v[72:75], v[236:239], v[16:31]
    ds_read_b64_tr_b16 v[56:57], v94 offset:39936
    ds_read_b64_tr_b16 v[58:59], v94 offset:40704
    v_mov_b32 v134, 0
    v_mov_b32 v135, 0
    s_waitcnt lgkmcnt(2)
    v_mfma_f32_32x32x16_bf16 v[16:31], v[48:51], v[240:243], v[16:31]
    ds_read_b64_tr_b16 v[64:65], v94 offset:43008
    ds_read_b64_tr_b16 v[66:67], v94 offset:43776
    s_waitcnt lgkmcnt(2)
    v_mfma_f32_32x32x16_bf16 v[16:31], v[56:59], v[244:247], v[16:31]
    ds_read_b64_tr_b16 v[72:73], v94 offset:46080
    ds_read_b64_tr_b16 v[74:75], v94 offset:46848
    s_waitcnt lgkmcnt(2)
    v_mfma_f32_32x32x16_bf16 v[16:31], v[64:67], v[248:251], v[16:31]
    s_waitcnt lgkmcnt(0)
    v_mfma_f32_32x32x16_bf16 v[16:31], v[72:75], v[96:99], v[16:31]
    s_mul_i32 s60, s33, 1536
    v_lshl_add_u32 v12, v81, 4, s60
    v_xor_b32 v13, 1, v80
    s_mov_b32 s62, 0x3ea52b5c
    s_nop 7
    s_mov_b32 s61, 504
    v_mul_f32 v16, s62, v16
    v_mul_f32 v17, s62, v17
    v_mul_f32 v18, s62, v18
    v_mul_f32 v19, s62, v19
    v_mad_u32_u24 v14, v13, s61, v12
    v_add_u32 v14, 115720, v14
    v_cvt_pk_bf16_f32 v4, v16, v17
    v_cvt_pk_bf16_f32 v5, v18, v19
    ds_write_b64 v14, v[4:5]
    s_mov_b32 s61, 504
    v_mul_f32 v20, s62, v20
    v_mul_f32 v21, s62, v21
    v_mul_f32 v22, s62, v22
    v_mul_f32 v23, s62, v23
    v_mad_u32_u24 v14, v80, s61, v12
    v_add_u32 v14, 116232, v14
    v_cvt_pk_bf16_f32 v6, v20, v21
    v_cvt_pk_bf16_f32 v7, v22, v23
    ds_write_b64 v14, v[6:7]
L_p1_q_done:
    v_lshrrev_b32 v8, 5, v2
    v_and_b32 v9, 31, v2
    s_mul_i32 s60, s28, 12288
    v_add_u32 v4, s60, v3
    v_cmp_lt_u32 s[62:63], 20, v9
    v_add_u32 v14, 1024, v4
    s_add_u32 s61, s60, 1360
    v_cndmask_b32 v5, v4, v14, s[62:63]
    v_lshrrev_b32 v14, 4, v9
    v_lshlrev_b32 v14, 9, v14
    v_and_b32 v15, 15, v9
    v_lshl_add_u32 v14, v15, 3, v14
    v_add_u32 v6, s61, v14
    v_add_u32 v28, 81920, v4
    v_add_u32 v29, 81920, v5
    v_add_u32 v30, 81920, v6
    s_mul_i32 s33, s29, 3072
    s_add_u32 s32, s33, 0
    s_mul_i32 s61, s28, 1536
    s_add_u32 s62, s33, s61
    s_add_u32 s62, s62, 106496
    s_sub_u32 s63, s33, s61
    s_add_u32 s63, s63, 108032
    v_add_u32 v209, s62, v3
    v_add_u32 v210, s63, v3
    v_lshlrev_b32 v14, 4, v9
    v_add_u32 v211, s62, v14
    v_add_u32 v212, s63, v14
    v_mov_b32 v7, 155648
L_p1_x2:
    s_waitcnt lgkmcnt(0)
    s_barrier
    ds_read_b128 v[16:19], v209
    ds_read_b64 v[20:21], v211 offset:1024
    ds_read_b128 v[22:25], v210
    ds_read_b64 v[26:27], v212 offset:1024
    ds_read_b32 v10, v7
    ds_read_b128 v[136:139], v28 offset:0
    ds_read_b64 v[140:141], v30 offset:0
    ds_read_b128 v[148:151], v29 offset:1024
    ds_read_b128 v[152:155], v28 offset:2048
    v_cmp_eq_u32 s[64:65], 0, v8
    v_mov_b32 v14, 0
    v_mov_b32 v15, 0
    v_mov_b32 v166, 0x45bc84e9
    s_waitcnt lgkmcnt(4)
    v_cndmask_b32 v20, 0, v20, s[64:65]
    v_cndmask_b32 v21, 0, v21, s[64:65]
    v_cndmask_b32 v26, 0, v26, s[64:65]
    v_cndmask_b32 v27, 0, v27, s[64:65]
    v_dot2_f32_bf16 v14, v16, v16, v14
    v_dot2_f32_bf16 v15, v22, v22, v15
    v_dot2_f32_bf16 v14, v17, v17, v14
    v_dot2_f32_bf16 v15, v23, v23, v15
    v_dot2_f32_bf16 v14, v18, v18, v14
    v_dot2_f32_bf16 v15, v24, v24, v15
    v_dot2_f32_bf16 v14, v19, v19, v14
    v_dot2_f32_bf16 v15, v25, v25, v15
    v_dot2_f32_bf16 v14, v20, v20, v14
    v_dot2_f32_bf16 v15, v26, v26, v15
    v_dot2_f32_bf16 v14, v21, v21, v14
    v_dot2_f32_bf16 v15, v27, v27, v15
    s_nop 2
    v_mov_b32 v164, v14
    s_nop 1
    v_permlane32_swap_b32 v14, v164
    s_nop 1
    v_add_f32 v14, v14, v164
    v_mov_b32 v164, v15
    s_nop 1
    v_permlane32_swap_b32 v15, v164
    s_nop 1
    v_add_f32 v15, v15, v164
    v_max_f32 v14, v14, v15
    v_mul_f32 v14, v10, v14
    v_cmp_nle_f32 vcc, v14, v166
    s_nop 4
    s_cbranch_vccnz L_truemax
L_att_start:
    s_waitcnt lgkmcnt(0)
    v_mfma_f32_32x32x16_bf16 v[32:47], v[136:139], v[16:19], v[104:119]
    v_mfma_f32_32x32x8_bf16 v[32:47], v[140:141], v[20:21], v[32:47]
    s_cmp_ge_u32 s24, 4
    s_nop 7
    s_nop 2
    s_cbranch_scc1 L_att_young
    s_setprio 1
    v_mfma_f32_32x32x16_bf16 v[48:63], v[136:139], v[22:25], v[120:135]
    v_exp_f32 v32, v32
    v_exp_f32 v33, v33
    v_exp_f32 v34, v34
    v_exp_f32 v35, v35
    ds_read_b128 v[142:145], v28 offset:3072
    ds_read_b64 v[146:147], v30 offset:3072
    s_add_u32 m0, s33, 0
    s_add_u32 s61, s32, 12288
    buffer_load_dwordx4 v3, s[4:7], s61 offen sc1 lds
    v_exp_f32 v36, v36
    v_exp_f32 v37, v37
    v_exp_f32 v38, v38
    v_exp_f32 v39, v39
    v_mfma_f32_32x32x8_bf16 v[48:63], v[140:141], v[26:27], v[48:63]
    ds_read_b128 v[156:159], v29 offset:4096
    buffer_load_dwordx4 v3, s[4:7], s61 offen offset:1024 sc1 lds
    v_cvt_pk_bf16_f32 v64, v32, v33
    v_cvt_pk_bf16_f32 v65, v34, v35
    v_cvt_pk_bf16_f32 v66, v36, v37
    v_cvt_pk_bf16_f32 v67, v38, v39
    v_exp_f32 v40, v40
    v_exp_f32 v41, v41
    v_exp_f32 v42, v42
    v_exp_f32 v43, v43
    v_mfma_f32_32x32x16_bf16 v[72:87], v[148:151], v[64:67], 0
    ds_read_b128 v[160:163], v28 offset:5120
    buffer_load_dwordx4 v3, s[4:7], s61 offen offset:2048 sc1 lds
    v_exp_f32 v44, v44
    v_exp_f32 v45, v45
    v_exp_f32 v46, v46
    v_exp_f32 v47, v47
    v_cvt_pk_bf16_f32 v68, v40, v41
    v_cvt_pk_bf16_f32 v69, v42, v43
    v_cvt_pk_bf16_f32 v70, v44, v45
    v_cvt_pk_bf16_f32 v71, v46, v47
    s_setprio 0
    s_waitcnt lgkmcnt(0)
    v_mfma_f32_32x32x16_bf16 v[32:47], v[142:145], v[16:19], v[104:119]
    v_exp_f32 v48, v48
    v_exp_f32 v49, v49
    v_exp_f32 v50, v50
    v_exp_f32 v51, v51
    v_mfma_f32_32x32x16_bf16 v[72:87], v[152:155], v[68:71], v[72:87]
    s_add_u32 m0, s33, 12288
    s_add_u32 s61, s32, 110592
    buffer_load_dwordx4 v3, s[4:7], s61 offen sc1 lds
    v_exp_f32 v52, v52
    v_exp_f32 v53, v53
    v_exp_f32 v54, v54
    v_exp_f32 v55, v55
    v_mfma_f32_32x32x8_bf16 v[32:47], v[146:147], v[20:21], v[32:47]
    buffer_load_dwordx4 v3, s[4:7], s61 offen offset:1024 sc1 lds
    v_cvt_pk_bf16_f32 v64, v48, v49
    v_cvt_pk_bf16_f32 v65, v50, v51
    v_cvt_pk_bf16_f32 v66, v52, v53
    v_cvt_pk_bf16_f32 v67, v54, v55
    v_exp_f32 v56, v56
    v_exp_f32 v57, v57
    v_exp_f32 v58, v58
    v_exp_f32 v59, v59
    v_mfma_f32_32x32x16_bf16 v[88:103], v[148:151], v[64:67], 0
    buffer_load_dwordx4 v3, s[4:7], s61 offen offset:2048 sc1 lds
    v_exp_f32 v60, v60
    v_exp_f32 v61, v61
    v_exp_f32 v62, v62
    v_exp_f32 v63, v63
    v_cvt_pk_bf16_f32 v68, v56, v57
    v_cvt_pk_bf16_f32 v69, v58, v59
    v_cvt_pk_bf16_f32 v70, v60, v61
    v_cvt_pk_bf16_f32 v71, v62, v63
    s_setprio 1
    v_mfma_f32_32x32x16_bf16 v[48:63], v[142:145], v[22:25], v[120:135]
    v_exp_f32 v32, v32
    v_exp_f32 v33, v33
    v_exp_f32 v34, v34
    v_exp_f32 v35, v35
    v_mfma_f32_32x32x16_bf16 v[88:103], v[152:155], v[68:71], v[88:103]
    ds_read_b128 v[136:139], v28 offset:6144
    ds_read_b64 v[140:141], v30 offset:6144
    s_add_u32 m0, s33, 24576
    s_add_u32 s61, s32, 24576
    buffer_load_dwordx4 v3, s[4:7], s61 offen sc1 lds
    v_exp_f32 v36, v36
    v_exp_f32 v37, v37
    v_exp_f32 v38, v38
    v_exp_f32 v39, v39
    v_mfma_f32_32x32x8_bf16 v[48:63], v[146:147], v[26:27], v[48:63]
    ds_read_b128 v[148:151], v29 offset:7168
    buffer_load_dwordx4 v3, s[4:7], s61 offen offset:1024 sc1 lds
    v_cvt_pk_bf16_f32 v64, v32, v33
    v_cvt_pk_bf16_f32 v65, v34, v35
    v_cvt_pk_bf16_f32 v66, v36, v37
    v_cvt_pk_bf16_f32 v67, v38, v39
    v_exp_f32 v40, v40
    v_exp_f32 v41, v41
    v_exp_f32 v42, v42
    v_exp_f32 v43, v43
    v_mfma_f32_32x32x16_bf16 v[72:87], v[156:159], v[64:67], v[72:87]
    ds_read_b128 v[152:155], v28 offset:8192
    buffer_load_dwordx4 v3, s[4:7], s61 offen offset:2048 sc1 lds
    v_exp_f32 v44, v44
    v_exp_f32 v45, v45
    v_exp_f32 v46, v46
    v_exp_f32 v47, v47
    v_cvt_pk_bf16_f32 v68, v40, v41
    v_cvt_pk_bf16_f32 v69, v42, v43
    v_cvt_pk_bf16_f32 v70, v44, v45
    v_cvt_pk_bf16_f32 v71, v46, v47
    s_setprio 0
    s_waitcnt lgkmcnt(0)
    v_mfma_f32_32x32x16_bf16 v[32:47], v[136:139], v[16:19], v[104:119]
    v_exp_f32 v48, v48
    v_exp_f32 v49, v49
    v_exp_f32 v50, v50
    v_exp_f32 v51, v51
    v_mfma_f32_32x32x16_bf16 v[72:87], v[160:163], v[68:71], v[72:87]
    s_add_u32 m0, s33, 36864
    s_add_u32 s61, s32, 122880
    buffer_load_dwordx4 v3, s[4:7], s61 offen sc1 lds
    v_exp_f32 v52, v52
    v_exp_f32 v53, v53
    v_exp_f32 v54, v54
    v_exp_f32 v55, v55
    v_mfma_f32_32x32x8_bf16 v[32:47], v[140:141], v[20:21], v[32:47]
    buffer_load_dwordx4 v3, s[4:7], s61 offen offset:1024 sc1 lds
    v_cvt_pk_bf16_f32 v64, v48, v49
    v_cvt_pk_bf16_f32 v65, v50, v51
    v_cvt_pk_bf16_f32 v66, v52, v53
    v_cvt_pk_bf16_f32 v67, v54, v55
    v_exp_f32 v56, v56
    v_exp_f32 v57, v57
    v_exp_f32 v58, v58
    v_exp_f32 v59, v59
    v_mfma_f32_32x32x16_bf16 v[88:103], v[156:159], v[64:67], v[88:103]
    buffer_load_dwordx4 v3, s[4:7], s61 offen offset:2048 sc1 lds
    v_exp_f32 v60, v60
    v_exp_f32 v61, v61
    v_exp_f32 v62, v62
    v_exp_f32 v63, v63
    v_cvt_pk_bf16_f32 v68, v56, v57
    v_cvt_pk_bf16_f32 v69, v58, v59
    v_cvt_pk_bf16_f32 v70, v60, v61
    v_cvt_pk_bf16_f32 v71, v62, v63
    s_setprio 1
    v_mfma_f32_32x32x16_bf16 v[48:63], v[136:139], v[22:25], v[120:135]
    v_exp_f32 v32, v32
    v_exp_f32 v33, v33
    v_exp_f32 v34, v34
    v_exp_f32 v35, v35
    v_mfma_f32_32x32x16_bf16 v[88:103], v[160:163], v[68:71], v[88:103]
    ds_read_b128 v[142:145], v28 offset:9216
    ds_read_b64 v[146:147], v30 offset:9216
    v_exp_f32 v36, v36
    v_exp_f32 v37, v37
    v_exp_f32 v38, v38
    v_exp_f32 v39, v39
    v_mfma_f32_32x32x8_bf16 v[48:63], v[140:141], v[26:27], v[48:63]
    ds_read_b128 v[156:159], v29 offset:10240
    v_cvt_pk_bf16_f32 v64, v32, v33
    v_cvt_pk_bf16_f32 v65, v34, v35
    v_cvt_pk_bf16_f32 v66, v36, v37
    v_cvt_pk_bf16_f32 v67, v38, v39
    v_exp_f32 v40, v40
    v_exp_f32 v41, v41
    v_exp_f32 v42, v42
    v_exp_f32 v43, v43
    v_mfma_f32_32x32x16_bf16 v[72:87], v[148:151], v[64:67], v[72:87]
    ds_read_b128 v[160:163], v28 offset:11264
    v_exp_f32 v44, v44
    v_exp_f32 v45, v45
    v_exp_f32 v46, v46
    v_exp_f32 v47, v47
    v_cvt_pk_bf16_f32 v68, v40, v41
    v_cvt_pk_bf16_f32 v69, v42, v43
    v_cvt_pk_bf16_f32 v70, v44, v45
    v_cvt_pk_bf16_f32 v71, v46, v47
    s_setprio 0
    s_waitcnt lgkmcnt(0)
    v_mfma_f32_32x32x16_bf16 v[32:47], v[142:145], v[16:19], v[104:119]
    v_exp_f32 v48, v48
    v_exp_f32 v49, v49
    v_exp_f32 v50, v50
    v_exp_f32 v51, v51
    v_mfma_f32_32x32x16_bf16 v[72:87], v[152:155], v[68:71], v[72:87]
    v_exp_f32 v52, v52
    v_exp_f32 v53, v53
    v_exp_f32 v54, v54
    v_exp_f32 v55, v55
    v_mfma_f32_32x32x8_bf16 v[32:47], v[146:147], v[20:21], v[32:47]
    v_cvt_pk_bf16_f32 v64, v48, v49
    v_cvt_pk_bf16_f32 v65, v50, v51
    v_cvt_pk_bf16_f32 v66, v52, v53
    v_cvt_pk_bf16_f32 v67, v54, v55
    v_exp_f32 v56, v56
    v_exp_f32 v57, v57
    v_exp_f32 v58, v58
    v_exp_f32 v59, v59
    v_mfma_f32_32x32x16_bf16 v[88:103], v[148:151], v[64:67], v[88:103]
    v_exp_f32 v60, v60
    v_exp_f32 v61, v61
    v_exp_f32 v62, v62
    v_exp_f32 v63, v63
    v_cvt_pk_bf16_f32 v68, v56, v57
    v_cvt_pk_bf16_f32 v69, v58, v59
    v_cvt_pk_bf16_f32 v70, v60, v61
    v_cvt_pk_bf16_f32 v71, v62, v63
    s_setprio 1
    v_mfma_f32_32x32x16_bf16 v[48:63], v[142:145], v[22:25], v[120:135]
    v_exp_f32 v32, v32
    v_exp_f32 v33, v33
    v_exp_f32 v34, v34
    v_exp_f32 v35, v35
    v_mfma_f32_32x32x16_bf16 v[88:103], v[152:155], v[68:71], v[88:103]
    s_waitcnt vmcnt(6)
    s_barrier
    ds_read_b128 v[136:139], v4 offset:0
    ds_read_b64 v[140:141], v6 offset:0
    v_exp_f32 v36, v36
    v_exp_f32 v37, v37
    v_exp_f32 v38, v38
    v_exp_f32 v39, v39
    v_mfma_f32_32x32x8_bf16 v[48:63], v[146:147], v[26:27], v[48:63]
    ds_read_b128 v[148:151], v5 offset:1024
    v_cvt_pk_bf16_f32 v64, v32, v33
    v_cvt_pk_bf16_f32 v65, v34, v35
    v_cvt_pk_bf16_f32 v66, v36, v37
    v_cvt_pk_bf16_f32 v67, v38, v39
    v_exp_f32 v40, v40
    v_exp_f32 v41, v41
    v_exp_f32 v42, v42
    v_exp_f32 v43, v43
    v_mfma_f32_32x32x16_bf16 v[72:87], v[156:159], v[64:67], v[72:87]
    ds_read_b128 v[152:155], v4 offset:2048
    v_exp_f32 v44, v44
    v_exp_f32 v45, v45
    v_exp_f32 v46, v46
    v_exp_f32 v47, v47
    v_cvt_pk_bf16_f32 v68, v40, v41
    v_cvt_pk_bf16_f32 v69, v42, v43
    v_cvt_pk_bf16_f32 v70, v44, v45
    v_cvt_pk_bf16_f32 v71, v46, v47
    s_setprio 0
    s_waitcnt lgkmcnt(0)
    v_mfma_f32_32x32x16_bf16 v[32:47], v[136:139], v[16:19], v[104:119]
    v_exp_f32 v48, v48
    v_exp_f32 v49, v49
    v_exp_f32 v50, v50
    v_exp_f32 v51, v51
    v_mfma_f32_32x32x16_bf16 v[72:87], v[160:163], v[68:71], v[72:87]
    s_add_u32 m0, s33, 81920
    s_add_u32 s61, s32, 36864
    buffer_load_dwordx4 v3, s[4:7], s61 offen sc1 lds
    v_exp_f32 v52, v52
    v_exp_f32 v53, v53
    v_exp_f32 v54, v54
    v_exp_f32 v55, v55
    v_mfma_f32_32x32x8_bf16 v[32:47], v[140:141], v[20:21], v[32:47]
    buffer_load_dwordx4 v3, s[4:7], s61 offen offset:1024 sc1 lds
    v_cvt_pk_bf16_f32 v64, v48, v49
    v_cvt_pk_bf16_f32 v65, v50, v51
    v_cvt_pk_bf16_f32 v66, v52, v53
    v_cvt_pk_bf16_f32 v67, v54, v55
    v_exp_f32 v56, v56
    v_exp_f32 v57, v57
    v_exp_f32 v58, v58
    v_exp_f32 v59, v59
    v_mfma_f32_32x32x16_bf16 v[88:103], v[156:159], v[64:67], v[88:103]
    buffer_load_dwordx4 v3, s[4:7], s61 offen offset:2048 sc1 lds
    v_exp_f32 v60, v60
    v_exp_f32 v61, v61
    v_exp_f32 v62, v62
    v_exp_f32 v63, v63
    v_cvt_pk_bf16_f32 v68, v56, v57
    v_cvt_pk_bf16_f32 v69, v58, v59
    v_cvt_pk_bf16_f32 v70, v60, v61
    v_cvt_pk_bf16_f32 v71, v62, v63
    s_setprio 1
    v_mfma_f32_32x32x16_bf16 v[48:63], v[136:139], v[22:25], v[120:135]
    v_exp_f32 v32, v32
    v_exp_f32 v33, v33
    v_exp_f32 v34, v34
    v_exp_f32 v35, v35
    v_mfma_f32_32x32x16_bf16 v[88:103], v[160:163], v[68:71], v[88:103]
    ds_read_b128 v[142:145], v4 offset:3072
    ds_read_b64 v[146:147], v6 offset:3072
    s_add_u32 m0, s33, 94208
    s_add_u32 s61, s32, 135168
    buffer_load_dwordx4 v3, s[4:7], s61 offen sc1 lds
    v_exp_f32 v36, v36
    v_exp_f32 v37, v37
    v_exp_f32 v38, v38
    v_exp_f32 v39, v39
    v_mfma_f32_32x32x8_bf16 v[48:63], v[140:141], v[26:27], v[48:63]
    ds_read_b128 v[156:159], v5 offset:4096
    buffer_load_dwordx4 v3, s[4:7], s61 offen offset:1024 sc1 lds
    v_cvt_pk_bf16_f32 v64, v32, v33
    v_cvt_pk_bf16_f32 v65, v34, v35
    v_cvt_pk_bf16_f32 v66, v36, v37
    v_cvt_pk_bf16_f32 v67, v38, v39
    v_exp_f32 v40, v40
    v_exp_f32 v41, v41
    v_exp_f32 v42, v42
    v_exp_f32 v43, v43
    v_mfma_f32_32x32x16_bf16 v[72:87], v[148:151], v[64:67], v[72:87]
    ds_read_b128 v[160:163], v4 offset:5120
    buffer_load_dwordx4 v3, s[4:7], s61 offen offset:2048 sc1 lds
    v_exp_f32 v44, v44
    v_exp_f32 v45, v45
    v_exp_f32 v46, v46
    v_exp_f32 v47, v47
    v_cvt_pk_bf16_f32 v68, v40, v41
    v_cvt_pk_bf16_f32 v69, v42, v43
    v_cvt_pk_bf16_f32 v70, v44, v45
    v_cvt_pk_bf16_f32 v71, v46, v47
    s_setprio 0
    s_waitcnt lgkmcnt(0)
    v_mfma_f32_32x32x16_bf16 v[32:47], v[142:145], v[16:19], v[104:119]
    v_exp_f32 v48, v48
    v_exp_f32 v49, v49
    v_exp_f32 v50, v50
    v_exp_f32 v51, v51
    v_mfma_f32_32x32x16_bf16 v[72:87], v[152:155], v[68:71], v[72:87]
    v_exp_f32 v52, v52
    v_exp_f32 v53, v53
    v_exp_f32 v54, v54
    v_exp_f32 v55, v55
    v_mfma_f32_32x32x8_bf16 v[32:47], v[146:147], v[20:21], v[32:47]
    v_cvt_pk_bf16_f32 v64, v48, v49
    v_cvt_pk_bf16_f32 v65, v50, v51
    v_cvt_pk_bf16_f32 v66, v52, v53
    v_cvt_pk_bf16_f32 v67, v54, v55
    v_exp_f32 v56, v56
    v_exp_f32 v57, v57
    v_exp_f32 v58, v58
    v_exp_f32 v59, v59
    v_mfma_f32_32x32x16_bf16 v[88:103], v[148:151], v[64:67], v[88:103]
    v_exp_f32 v60, v60
    v_exp_f32 v61, v61
    v_exp_f32 v62, v62
    v_exp_f32 v63, v63
    v_cvt_pk_bf16_f32 v68, v56, v57
    v_cvt_pk_bf16_f32 v69, v58, v59
    v_cvt_pk_bf16_f32 v70, v60, v61
    v_cvt_pk_bf16_f32 v71, v62, v63
    s_setprio 1
    v_mfma_f32_32x32x16_bf16 v[48:63], v[142:145], v[22:25], v[120:135]
    v_exp_f32 v32, v32
    v_exp_f32 v33, v33
    v_exp_f32 v34, v34
    v_exp_f32 v35, v35
    v_mfma_f32_32x32x16_bf16 v[88:103], v[152:155], v[68:71], v[88:103]
    ds_read_b128 v[136:139], v4 offset:6144
    ds_read_b64 v[140:141], v6 offset:6144
    v_exp_f32 v36, v36
    v_exp_f32 v37, v37
    v_exp_f32 v38, v38
    v_exp_f32 v39, v39
    v_mfma_f32_32x32x8_bf16 v[48:63], v[146:147], v[26:27], v[48:63]
    ds_read_b128 v[148:151], v5 offset:7168
    v_cvt_pk_bf16_f32 v64, v32, v33
    v_cvt_pk_bf16_f32 v65, v34, v35
    v_cvt_pk_bf16_f32 v66, v36, v37
    v_cvt_pk_bf16_f32 v67, v38, v39
    v_exp_f32 v40, v40
    v_exp_f32 v41, v41
    v_exp_f32 v42, v42
    v_exp_f32 v43, v43
    v_mfma_f32_32x32x16_bf16 v[72:87], v[156:159], v[64:67], v[72:87]
    ds_read_b128 v[152:155], v4 offset:8192
    v_exp_f32 v44, v44
    v_exp_f32 v45, v45
    v_exp_f32 v46, v46
    v_exp_f32 v47, v47
    v_cvt_pk_bf16_f32 v68, v40, v41
    v_cvt_pk_bf16_f32 v69, v42, v43
    v_cvt_pk_bf16_f32 v70, v44, v45
    v_cvt_pk_bf16_f32 v71, v46, v47
    s_setprio 0
    s_waitcnt lgkmcnt(0)
    v_mfma_f32_32x32x16_bf16 v[32:47], v[136:139], v[16:19], v[104:119]
    v_exp_f32 v48, v48
    v_exp_f32 v49, v49
    v_exp_f32 v50, v50
    v_exp_f32 v51, v51
    v_mfma_f32_32x32x16_bf16 v[72:87], v[160:163], v[68:71], v[72:87]
    v_exp_f32 v52, v52
    v_exp_f32 v53, v53
    v_exp_f32 v54, v54
    v_exp_f32 v55, v55
    v_mfma_f32_32x32x8_bf16 v[32:47], v[140:141], v[20:21], v[32:47]
    v_cvt_pk_bf16_f32 v64, v48, v49
    v_cvt_pk_bf16_f32 v65, v50, v51
    v_cvt_pk_bf16_f32 v66, v52, v53
    v_cvt_pk_bf16_f32 v67, v54, v55
    v_exp_f32 v56, v56
    v_exp_f32 v57, v57
    v_exp_f32 v58, v58
    v_exp_f32 v59, v59
    v_mfma_f32_32x32x16_bf16 v[88:103], v[156:159], v[64:67], v[88:103]
    v_exp_f32 v60, v60
    v_exp_f32 v61, v61
    v_exp_f32 v62, v62
    v_exp_f32 v63, v63
    v_cvt_pk_bf16_f32 v68, v56, v57
    v_cvt_pk_bf16_f32 v69, v58, v59
    v_cvt_pk_bf16_f32 v70, v60, v61
    v_cvt_pk_bf16_f32 v71, v62, v63
    s_setprio 1
    v_mfma_f32_32x32x16_bf16 v[48:63], v[136:139], v[22:25], v[120:135]
    v_exp_f32 v32, v32
    v_exp_f32 v33, v33
    v_exp_f32 v34, v34
    v_exp_f32 v35, v35
    v_mfma_f32_32x32x16_bf16 v[88:103], v[160:163], v[68:71], v[88:103]
    ds_read_b128 v[142:145], v4 offset:9216
    ds_read_b64 v[146:147], v6 offset:9216
    v_exp_f32 v36, v36
    v_exp_f32 v37, v37
    v_exp_f32 v38, v38
    v_exp_f32 v39, v39
    v_mfma_f32_32x32x8_bf16 v[48:63], v[140:141], v[26:27], v[48:63]
    ds_read_b128 v[156:159], v5 offset:10240
    v_cvt_pk_bf16_f32 v64, v32, v33
    v_cvt_pk_bf16_f32 v65, v34, v35
    v_cvt_pk_bf16_f32 v66, v36, v37
    v_cvt_pk_bf16_f32 v67, v38, v39
    v_exp_f32 v40, v40
    v_exp_f32 v41, v41
    v_exp_f32 v42, v42
    v_exp_f32 v43, v43
    v_mfma_f32_32x32x16_bf16 v[72:87], v[148:151], v[64:67], v[72:87]
    ds_read_b128 v[160:163], v4 offset:11264
    v_exp_f32 v44, v44
    v_exp_f32 v45, v45
    v_exp_f32 v46, v46
    v_exp_f32 v47, v47
    v_cvt_pk_bf16_f32 v68, v40, v41
    v_cvt_pk_bf16_f32 v69, v42, v43
    v_cvt_pk_bf16_f32 v70, v44, v45
    v_cvt_pk_bf16_f32 v71, v46, v47
    s_setprio 0
    s_waitcnt lgkmcnt(0)
    v_mfma_f32_32x32x16_bf16 v[32:47], v[142:145], v[16:19], v[104:119]
    v_exp_f32 v48, v48
    v_exp_f32 v49, v49
    v_exp_f32 v50, v50
    v_exp_f32 v51, v51
    v_mfma_f32_32x32x16_bf16 v[72:87], v[152:155], v[68:71], v[72:87]
    v_exp_f32 v52, v52
    v_exp_f32 v53, v53
    v_exp_f32 v54, v54
    v_exp_f32 v55, v55
    v_mfma_f32_32x32x8_bf16 v[32:47], v[146:147], v[20:21], v[32:47]
    v_cvt_pk_bf16_f32 v64, v48, v49
    v_cvt_pk_bf16_f32 v65, v50, v51
    v_cvt_pk_bf16_f32 v66, v52, v53
    v_cvt_pk_bf16_f32 v67, v54, v55
    v_exp_f32 v56, v56
    v_exp_f32 v57, v57
    v_exp_f32 v58, v58
    v_exp_f32 v59, v59
    v_mfma_f32_32x32x16_bf16 v[88:103], v[148:151], v[64:67], v[88:103]
    v_exp_f32 v60, v60
    v_exp_f32 v61, v61
    v_exp_f32 v62, v62
    v_exp_f32 v63, v63
    v_cvt_pk_bf16_f32 v68, v56, v57
    v_cvt_pk_bf16_f32 v69, v58, v59
    v_cvt_pk_bf16_f32 v70, v60, v61
    v_cvt_pk_bf16_f32 v71, v62, v63
    s_setprio 1
    v_mfma_f32_32x32x16_bf16 v[48:63], v[142:145], v[22:25], v[120:135]
    v_exp_f32 v32, v32
    v_exp_f32 v33, v33
    v_exp_f32 v34, v34
    v_exp_f32 v35, v35
    v_mfma_f32_32x32x16_bf16 v[88:103], v[152:155], v[68:71], v[88:103]
    s_waitcnt vmcnt(6)
    s_barrier
    ds_read_b128 v[136:139], v4 offset:24576
    ds_read_b64 v[140:141], v6 offset:24576
    v_exp_f32 v36, v36
    v_exp_f32 v37, v37
    v_exp_f32 v38, v38
    v_exp_f32 v39, v39
    v_mfma_f32_32x32x8_bf16 v[48:63], v[146:147], v[26:27], v[48:63]
    ds_read_b128 v[148:151], v5 offset:25600
    v_cvt_pk_bf16_f32 v64, v32, v33
    v_cvt_pk_bf16_f32 v65, v34, v35
    v_cvt_pk_bf16_f32 v66, v36, v37
    v_cvt_pk_bf16_f32 v67, v38, v39
    v_exp_f32 v40, v40
    v_exp_f32 v41, v41
    v_exp_f32 v42, v42
    v_exp_f32 v43, v43
    v_mfma_f32_32x32x16_bf16 v[72:87], v[156:159], v[64:67], v[72:87]
    ds_read_b128 v[152:155], v4 offset:26624
    v_exp_f32 v44, v44
    v_exp_f32 v45, v45
    v_exp_f32 v46, v46
    v_exp_f32 v47, v47
    v_cvt_pk_bf16_f32 v68, v40, v41
    v_cvt_pk_bf16_f32 v69, v42, v43
    v_cvt_pk_bf16_f32 v70, v44, v45
    v_cvt_pk_bf16_f32 v71, v46, v47
    s_setprio 0
    s_waitcnt lgkmcnt(0)
    v_mfma_f32_32x32x16_bf16 v[32:47], v[136:139], v[16:19], v[104:119]
    v_exp_f32 v48, v48
    v_exp_f32 v49, v49
    v_exp_f32 v50, v50
    v_exp_f32 v51, v51
    v_mfma_f32_32x32x16_bf16 v[72:87], v[160:163], v[68:71], v[72:87]
    v_exp_f32 v52, v52
    v_exp_f32 v53, v53
    v_exp_f32 v54, v54
    v_exp_f32 v55, v55
    v_mfma_f32_32x32x8_bf16 v[32:47], v[140:141], v[20:21], v[32:47]
    v_cvt_pk_bf16_f32 v64, v48, v49
    v_cvt_pk_bf16_f32 v65, v50, v51
    v_cvt_pk_bf16_f32 v66, v52, v53
    v_cvt_pk_bf16_f32 v67, v54, v55
    v_exp_f32 v56, v56
    v_exp_f32 v57, v57
    v_exp_f32 v58, v58
    v_exp_f32 v59, v59
    v_mfma_f32_32x32x16_bf16 v[88:103], v[156:159], v[64:67], v[88:103]
    v_exp_f32 v60, v60
    v_exp_f32 v61, v61
    v_exp_f32 v62, v62
    v_exp_f32 v63, v63
    v_cvt_pk_bf16_f32 v68, v56, v57
    v_cvt_pk_bf16_f32 v69, v58, v59
    v_cvt_pk_bf16_f32 v70, v60, v61
    v_cvt_pk_bf16_f32 v71, v62, v63
    s_setprio 1
    v_mfma_f32_32x32x16_bf16 v[48:63], v[136:139], v[22:25], v[120:135]
    v_exp_f32 v32, v32
    v_exp_f32 v33, v33
    v_exp_f32 v34, v34
    v_exp_f32 v35, v35
    v_mfma_f32_32x32x16_bf16 v[88:103], v[160:163], v[68:71], v[88:103]
    ds_read_b128 v[142:145], v4 offset:27648
    ds_read_b64 v[146:147], v6 offset:27648
    v_exp_f32 v36, v36
    v_exp_f32 v37, v37
    v_exp_f32 v38, v38
    v_exp_f32 v39, v39
    v_mfma_f32_32x32x8_bf16 v[48:63], v[140:141], v[26:27], v[48:63]
    ds_read_b128 v[156:159], v5 offset:28672
    v_cvt_pk_bf16_f32 v64, v32, v33
    v_cvt_pk_bf16_f32 v65, v34, v35
    v_cvt_pk_bf16_f32 v66, v36, v37
    v_cvt_pk_bf16_f32 v67, v38, v39
    v_exp_f32 v40, v40
    v_exp_f32 v41, v41
    v_exp_f32 v42, v42
    v_exp_f32 v43, v43
    v_mfma_f32_32x32x16_bf16 v[72:87], v[148:151], v[64:67], v[72:87]
    ds_read_b128 v[160:163], v4 offset:29696
    v_exp_f32 v44, v44
    v_exp_f32 v45, v45
    v_exp_f32 v46, v46
    v_exp_f32 v47, v47
    v_cvt_pk_bf16_f32 v68, v40, v41
    v_cvt_pk_bf16_f32 v69, v42, v43
    v_cvt_pk_bf16_f32 v70, v44, v45
    v_cvt_pk_bf16_f32 v71, v46, v47
    s_setprio 0
    s_waitcnt lgkmcnt(0)
    v_mfma_f32_32x32x16_bf16 v[32:47], v[142:145], v[16:19], v[104:119]
    v_exp_f32 v48, v48
    v_exp_f32 v49, v49
    v_exp_f32 v50, v50
    v_exp_f32 v51, v51
    v_mfma_f32_32x32x16_bf16 v[72:87], v[152:155], v[68:71], v[72:87]
    v_exp_f32 v52, v52
    v_exp_f32 v53, v53
    v_exp_f32 v54, v54
    v_exp_f32 v55, v55
    v_mfma_f32_32x32x8_bf16 v[32:47], v[146:147], v[20:21], v[32:47]
    v_cvt_pk_bf16_f32 v64, v48, v49
    v_cvt_pk_bf16_f32 v65, v50, v51
    v_cvt_pk_bf16_f32 v66, v52, v53
    v_cvt_pk_bf16_f32 v67, v54, v55
    v_exp_f32 v56, v56
    v_exp_f32 v57, v57
    v_exp_f32 v58, v58
    v_exp_f32 v59, v59
    v_mfma_f32_32x32x16_bf16 v[88:103], v[148:151], v[64:67], v[88:103]
    v_exp_f32 v60, v60
    v_exp_f32 v61, v61
    v_exp_f32 v62, v62
    v_exp_f32 v63, v63
    v_cvt_pk_bf16_f32 v68, v56, v57
    v_cvt_pk_bf16_f32 v69, v58, v59
    v_cvt_pk_bf16_f32 v70, v60, v61
    v_cvt_pk_bf16_f32 v71, v62, v63
    s_setprio 1
    v_mfma_f32_32x32x16_bf16 v[48:63], v[142:145], v[22:25], v[120:135]
    v_exp_f32 v32, v32
    v_exp_f32 v33, v33
    v_exp_f32 v34, v34
    v_exp_f32 v35, v35
    v_mfma_f32_32x32x16_bf16 v[88:103], v[152:155], v[68:71], v[88:103]
    ds_read_b128 v[136:139], v4 offset:30720
    ds_read_b64 v[140:141], v6 offset:30720
    v_exp_f32 v36, v36
    v_exp_f32 v37, v37
    v_exp_f32 v38, v38
    v_exp_f32 v39, v39
    v_mfma_f32_32x32x8_bf16 v[48:63], v[146:147], v[26:27], v[48:63]
    ds_read_b128 v[148:151], v5 offset:31744
    v_cvt_pk_bf16_f32 v64, v32, v33
    v_cvt_pk_bf16_f32 v65, v34, v35
    v_cvt_pk_bf16_f32 v66, v36, v37
    v_cvt_pk_bf16_f32 v67, v38, v39
    v_exp_f32 v40, v40
    v_exp_f32 v41, v41
    v_exp_f32 v42, v42
    v_exp_f32 v43, v43
    v_mfma_f32_32x32x16_bf16 v[72:87], v[156:159], v[64:67], v[72:87]
    ds_read_b128 v[152:155], v4 offset:32768
    v_exp_f32 v44, v44
    v_exp_f32 v45, v45
    v_exp_f32 v46, v46
    v_exp_f32 v47, v47
    v_cvt_pk_bf16_f32 v68, v40, v41
    v_cvt_pk_bf16_f32 v69, v42, v43
    v_cvt_pk_bf16_f32 v70, v44, v45
    v_cvt_pk_bf16_f32 v71, v46, v47
    s_setprio 0
    s_waitcnt lgkmcnt(0)
    v_mfma_f32_32x32x16_bf16 v[32:47], v[136:139], v[16:19], v[104:119]
    v_exp_f32 v48, v48
    v_exp_f32 v49, v49
    v_exp_f32 v50, v50
    v_exp_f32 v51, v51
    v_mfma_f32_32x32x16_bf16 v[72:87], v[160:163], v[68:71], v[72:87]
    v_exp_f32 v52, v52
    v_exp_f32 v53, v53
    v_exp_f32 v54, v54
    v_exp_f32 v55, v55
    v_mfma_f32_32x32x8_bf16 v[32:47], v[140:141], v[20:21], v[32:47]
    v_cvt_pk_bf16_f32 v64, v48, v49
    v_cvt_pk_bf16_f32 v65, v50, v51
    v_cvt_pk_bf16_f32 v66, v52, v53
    v_cvt_pk_bf16_f32 v67, v54, v55
    v_exp_f32 v56, v56
    v_exp_f32 v57, v57
    v_exp_f32 v58, v58
    v_exp_f32 v59, v59
    v_mfma_f32_32x32x16_bf16 v[88:103], v[156:159], v[64:67], v[88:103]
    v_exp_f32 v60, v60
    v_exp_f32 v61, v61
    v_exp_f32 v62, v62
    v_exp_f32 v63, v63
    v_cvt_pk_bf16_f32 v68, v56, v57
    v_cvt_pk_bf16_f32 v69, v58, v59
    v_cvt_pk_bf16_f32 v70, v60, v61
    v_cvt_pk_bf16_f32 v71, v62, v63
    s_setprio 1
    v_mfma_f32_32x32x16_bf16 v[48:63], v[136:139], v[22:25], v[120:135]
    v_exp_f32 v32, v32
    v_exp_f32 v33, v33
    v_exp_f32 v34, v34
    v_exp_f32 v35, v35
    v_mfma_f32_32x32x16_bf16 v[88:103], v[160:163], v[68:71], v[88:103]
    ds_read_b128 v[142:145], v4 offset:33792
    ds_read_b64 v[146:147], v6 offset:33792
    v_exp_f32 v36, v36
    v_exp_f32 v37, v37
    v_exp_f32 v38, v38
    v_exp_f32 v39, v39
    v_mfma_f32_32x32x8_bf16 v[48:63], v[140:141], v[26:27], v[48:63]
    ds_read_b128 v[156:159], v5 offset:34816
    v_cvt_pk_bf16_f32 v64, v32, v33
    v_cvt_pk_bf16_f32 v65, v34, v35
    v_cvt_pk_bf16_f32 v66, v36, v37
    v_cvt_pk_bf16_f32 v67, v38, v39
    v_exp_f32 v40, v40
    v_exp_f32 v41, v41
    v_exp_f32 v42, v42
    v_exp_f32 v43, v43
    v_mfma_f32_32x32x16_bf16 v[72:87], v[148:151], v[64:67], v[72:87]
    ds_read_b128 v[160:163], v4 offset:35840
    v_exp_f32 v44, v44
    v_exp_f32 v45, v45
    v_exp_f32 v46, v46
    v_exp_f32 v47, v47
    v_cvt_pk_bf16_f32 v68, v40, v41
    v_cvt_pk_bf16_f32 v69, v42, v43
    v_cvt_pk_bf16_f32 v70, v44, v45
    v_cvt_pk_bf16_f32 v71, v46, v47
    s_setprio 0
    s_waitcnt lgkmcnt(0)
    v_mfma_f32_32x32x16_bf16 v[32:47], v[142:145], v[16:19], v[104:119]
    v_exp_f32 v48, v48
    v_exp_f32 v49, v49
    v_exp_f32 v50, v50
    v_exp_f32 v51, v51
    v_mfma_f32_32x32x16_bf16 v[72:87], v[152:155], v[68:71], v[72:87]
    v_exp_f32 v52, v52
    v_exp_f32 v53, v53
    v_exp_f32 v54, v54
    v_exp_f32 v55, v55
    v_mfma_f32_32x32x8_bf16 v[32:47], v[146:147], v[20:21], v[32:47]
    v_cvt_pk_bf16_f32 v64, v48, v49
    v_cvt_pk_bf16_f32 v65, v50, v51
    v_cvt_pk_bf16_f32 v66, v52, v53
    v_cvt_pk_bf16_f32 v67, v54, v55
    v_exp_f32 v56, v56
    v_exp_f32 v57, v57
    v_exp_f32 v58, v58
    v_exp_f32 v59, v59
    v_mfma_f32_32x32x16_bf16 v[88:103], v[148:151], v[64:67], v[88:103]
    v_exp_f32 v60, v60
    v_exp_f32 v61, v61
    v_exp_f32 v62, v62
    v_exp_f32 v63, v63
    v_cvt_pk_bf16_f32 v68, v56, v57
    v_cvt_pk_bf16_f32 v69, v58, v59
    v_cvt_pk_bf16_f32 v70, v60, v61
    v_cvt_pk_bf16_f32 v71, v62, v63
    s_setprio 1
    v_mfma_f32_32x32x16_bf16 v[48:63], v[142:145], v[22:25], v[120:135]
    v_exp_f32 v32, v32
    v_exp_f32 v33, v33
    v_exp_f32 v34, v34
    v_exp_f32 v35, v35
    v_mfma_f32_32x32x16_bf16 v[88:103], v[152:155], v[68:71], v[88:103]
    s_waitcnt vmcnt(0)
    s_barrier
    ds_read_b128 v[136:139], v28 offset:0
    ds_read_b64 v[140:141], v30 offset:0
    v_exp_f32 v36, v36
    v_exp_f32 v37, v37
    v_exp_f32 v38, v38
    v_exp_f32 v39, v39
    v_mfma_f32_32x32x8_bf16 v[48:63], v[146:147], v[26:27], v[48:63]
    ds_read_b128 v[148:151], v29 offset:1024
    v_cvt_pk_bf16_f32 v64, v32, v33
    v_cvt_pk_bf16_f32 v65, v34, v35
    v_cvt_pk_bf16_f32 v66, v36, v37
    v_cvt_pk_bf16_f32 v67, v38, v39
    v_exp_f32 v40, v40
    v_exp_f32 v41, v41
    v_exp_f32 v42, v42
    v_exp_f32 v43, v43
    v_mfma_f32_32x32x16_bf16 v[72:87], v[156:159], v[64:67], v[72:87]
    ds_read_b128 v[152:155], v28 offset:2048
    v_exp_f32 v44, v44
    v_exp_f32 v45, v45
    v_exp_f32 v46, v46
    v_exp_f32 v47, v47
    v_cvt_pk_bf16_f32 v68, v40, v41
    v_cvt_pk_bf16_f32 v69, v42, v43
    v_cvt_pk_bf16_f32 v70, v44, v45
    v_cvt_pk_bf16_f32 v71, v46, v47
    s_setprio 0
    s_waitcnt lgkmcnt(0)
    v_mfma_f32_32x32x16_bf16 v[32:47], v[136:139], v[16:19], v[104:119]
    v_exp_f32 v48, v48
    v_exp_f32 v49, v49
    v_exp_f32 v50, v50
    v_exp_f32 v51, v51
    v_mfma_f32_32x32x16_bf16 v[72:87], v[160:163], v[68:71], v[72:87]
    s_add_u32 m0, s33, 0
    s_add_u32 s61, s32, 49152
    buffer_load_dwordx4 v3, s[4:7], s61 offen sc1 lds
    v_exp_f32 v52, v52
    v_exp_f32 v53, v53
    v_exp_f32 v54, v54
    v_exp_f32 v55, v55
    v_mfma_f32_32x32x8_bf16 v[32:47], v[140:141], v[20:21], v[32:47]
    buffer_load_dwordx4 v3, s[4:7], s61 offen offset:1024 sc1 lds
    v_cvt_pk_bf16_f32 v64, v48, v49
    v_cvt_pk_bf16_f32 v65, v50, v51
    v_cvt_pk_bf16_f32 v66, v52, v53
    v_cvt_pk_bf16_f32 v67, v54, v55
    v_exp_f32 v56, v56
    v_exp_f32 v57, v57
    v_exp_f32 v58, v58
    v_exp_f32 v59, v59
    v_mfma_f32_32x32x16_bf16 v[88:103], v[156:159], v[64:67], v[88:103]
    buffer_load_dwordx4 v3, s[4:7], s61 offen offset:2048 sc1 lds
    v_exp_f32 v60, v60
    v_exp_f32 v61, v61
    v_exp_f32 v62, v62
    v_exp_f32 v63, v63
    v_cvt_pk_bf16_f32 v68, v56, v57
    v_cvt_pk_bf16_f32 v69, v58, v59
    v_cvt_pk_bf16_f32 v70, v60, v61
    v_cvt_pk_bf16_f32 v71, v62, v63
    s_setprio 1
    v_mfma_f32_32x32x16_bf16 v[48:63], v[136:139], v[22:25], v[120:135]
    v_exp_f32 v32, v32
    v_exp_f32 v33, v33
    v_exp_f32 v34, v34
    v_exp_f32 v35, v35
    v_mfma_f32_32x32x16_bf16 v[88:103], v[160:163], v[68:71], v[88:103]
    ds_read_b128 v[142:145], v28 offset:3072
    ds_read_b64 v[146:147], v30 offset:3072
    s_add_u32 m0, s33, 12288
    s_add_u32 s61, s32, 147456
    buffer_load_dwordx4 v3, s[4:7], s61 offen sc1 lds
    v_exp_f32 v36, v36
    v_exp_f32 v37, v37
    v_exp_f32 v38, v38
    v_exp_f32 v39, v39
    v_mfma_f32_32x32x8_bf16 v[48:63], v[140:141], v[26:27], v[48:63]
    ds_read_b128 v[156:159], v29 offset:4096
    buffer_load_dwordx4 v3, s[4:7], s61 offen offset:1024 sc1 lds
    v_cvt_pk_bf16_f32 v64, v32, v33
    v_cvt_pk_bf16_f32 v65, v34, v35
    v_cvt_pk_bf16_f32 v66, v36, v37
    v_cvt_pk_bf16_f32 v67, v38, v39
    v_exp_f32 v40, v40
    v_exp_f32 v41, v41
    v_exp_f32 v42, v42
    v_exp_f32 v43, v43
    v_mfma_f32_32x32x16_bf16 v[72:87], v[148:151], v[64:67], v[72:87]
    ds_read_b128 v[160:163], v28 offset:5120
    buffer_load_dwordx4 v3, s[4:7], s61 offen offset:2048 sc1 lds
    v_exp_f32 v44, v44
    v_exp_f32 v45, v45
    v_exp_f32 v46, v46
    v_exp_f32 v47, v47
    v_cvt_pk_bf16_f32 v68, v40, v41
    v_cvt_pk_bf16_f32 v69, v42, v43
    v_cvt_pk_bf16_f32 v70, v44, v45
    v_cvt_pk_bf16_f32 v71, v46, v47
    s_setprio 0
    s_waitcnt lgkmcnt(0)
    v_mfma_f32_32x32x16_bf16 v[32:47], v[142:145], v[16:19], v[104:119]
    v_exp_f32 v48, v48
    v_exp_f32 v49, v49
    v_exp_f32 v50, v50
    v_exp_f32 v51, v51
    v_mfma_f32_32x32x16_bf16 v[72:87], v[152:155], v[68:71], v[72:87]
    v_exp_f32 v52, v52
    v_exp_f32 v53, v53
    v_exp_f32 v54, v54
    v_exp_f32 v55, v55
    v_mfma_f32_32x32x8_bf16 v[32:47], v[146:147], v[20:21], v[32:47]
    v_cvt_pk_bf16_f32 v64, v48, v49
    v_cvt_pk_bf16_f32 v65, v50, v51
    v_cvt_pk_bf16_f32 v66, v52, v53
    v_cvt_pk_bf16_f32 v67, v54, v55
    v_exp_f32 v56, v56
    v_exp_f32 v57, v57
    v_exp_f32 v58, v58
    v_exp_f32 v59, v59
    v_mfma_f32_32x32x16_bf16 v[88:103], v[148:151], v[64:67], v[88:103]
    v_exp_f32 v60, v60
    v_exp_f32 v61, v61
    v_exp_f32 v62, v62
    v_exp_f32 v63, v63
    v_cvt_pk_bf16_f32 v68, v56, v57
    v_cvt_pk_bf16_f32 v69, v58, v59
    v_cvt_pk_bf16_f32 v70, v60, v61
    v_cvt_pk_bf16_f32 v71, v62, v63
    s_setprio 1
    v_mfma_f32_32x32x16_bf16 v[48:63], v[142:145], v[22:25], v[120:135]
    v_exp_f32 v32, v32
    v_exp_f32 v33, v33
    v_exp_f32 v34, v34
    v_exp_f32 v35, v35
    v_mfma_f32_32x32x16_bf16 v[88:103], v[152:155], v[68:71], v[88:103]
    ds_read_b128 v[136:139], v28 offset:6144
    ds_read_b64 v[140:141], v30 offset:6144
    v_exp_f32 v36, v36
    v_exp_f32 v37, v37
    v_exp_f32 v38, v38
    v_exp_f32 v39, v39
    v_mfma_f32_32x32x8_bf16 v[48:63], v[146:147], v[26:27], v[48:63]
    ds_read_b128 v[148:151], v29 offset:7168
    v_cvt_pk_bf16_f32 v64, v32, v33
    v_cvt_pk_bf16_f32 v65, v34, v35
    v_cvt_pk_bf16_f32 v66, v36, v37
    v_cvt_pk_bf16_f32 v67, v38, v39
    v_exp_f32 v40, v40
    v_exp_f32 v41, v41
    v_exp_f32 v42, v42
    v_exp_f32 v43, v43
    v_mfma_f32_32x32x16_bf16 v[72:87], v[156:159], v[64:67], v[72:87]
    ds_read_b128 v[152:155], v28 offset:8192
    v_exp_f32 v44, v44
    v_exp_f32 v45, v45
    v_exp_f32 v46, v46
    v_exp_f32 v47, v47
    v_cvt_pk_bf16_f32 v68, v40, v41
    v_cvt_pk_bf16_f32 v69, v42, v43
    v_cvt_pk_bf16_f32 v70, v44, v45
    v_cvt_pk_bf16_f32 v71, v46, v47
    s_setprio 0
    s_waitcnt lgkmcnt(0)
    v_mfma_f32_32x32x16_bf16 v[32:47], v[136:139], v[16:19], v[104:119]
    v_exp_f32 v48, v48
    v_exp_f32 v49, v49
    v_exp_f32 v50, v50
    v_exp_f32 v51, v51
    v_mfma_f32_32x32x16_bf16 v[72:87], v[160:163], v[68:71], v[72:87]
    v_exp_f32 v52, v52
    v_exp_f32 v53, v53
    v_exp_f32 v54, v54
    v_exp_f32 v55, v55
    v_mfma_f32_32x32x8_bf16 v[32:47], v[140:141], v[20:21], v[32:47]
    v_cvt_pk_bf16_f32 v64, v48, v49
    v_cvt_pk_bf16_f32 v65, v50, v51
    v_cvt_pk_bf16_f32 v66, v52, v53
    v_cvt_pk_bf16_f32 v67, v54, v55
    v_exp_f32 v56, v56
    v_exp_f32 v57, v57
    v_exp_f32 v58, v58
    v_exp_f32 v59, v59
    v_mfma_f32_32x32x16_bf16 v[88:103], v[156:159], v[64:67], v[88:103]
    v_exp_f32 v60, v60
    v_exp_f32 v61, v61
    v_exp_f32 v62, v62
    v_exp_f32 v63, v63
    v_cvt_pk_bf16_f32 v68, v56, v57
    v_cvt_pk_bf16_f32 v69, v58, v59
    v_cvt_pk_bf16_f32 v70, v60, v61
    v_cvt_pk_bf16_f32 v71, v62, v63
    s_setprio 1
    v_mfma_f32_32x32x16_bf16 v[48:63], v[136:139], v[22:25], v[120:135]
    v_exp_f32 v32, v32
    v_exp_f32 v33, v33
    v_exp_f32 v34, v34
    v_exp_f32 v35, v35
    v_mfma_f32_32x32x16_bf16 v[88:103], v[160:163], v[68:71], v[88:103]
    ds_read_b128 v[142:145], v28 offset:9216
    ds_read_b64 v[146:147], v30 offset:9216
    v_exp_f32 v36, v36
    v_exp_f32 v37, v37
    v_exp_f32 v38, v38
    v_exp_f32 v39, v39
    v_mfma_f32_32x32x8_bf16 v[48:63], v[140:141], v[26:27], v[48:63]
    ds_read_b128 v[156:159], v29 offset:10240
    v_cvt_pk_bf16_f32 v64, v32, v33
    v_cvt_pk_bf16_f32 v65, v34, v35
    v_cvt_pk_bf16_f32 v66, v36, v37
    v_cvt_pk_bf16_f32 v67, v38, v39
    v_exp_f32 v40, v40
    v_exp_f32 v41, v41
    v_exp_f32 v42, v42
    v_exp_f32 v43, v43
    v_mfma_f32_32x32x16_bf16 v[72:87], v[148:151], v[64:67], v[72:87]
    ds_read_b128 v[160:163], v28 offset:11264
    v_exp_f32 v44, v44
    v_exp_f32 v45, v45
    v_exp_f32 v46, v46
    v_exp_f32 v47, v47
    v_cvt_pk_bf16_f32 v68, v40, v41
    v_cvt_pk_bf16_f32 v69, v42, v43
    v_cvt_pk_bf16_f32 v70, v44, v45
    v_cvt_pk_bf16_f32 v71, v46, v47
    s_setprio 0
    s_waitcnt lgkmcnt(0)
    v_mfma_f32_32x32x16_bf16 v[32:47], v[142:145], v[16:19], v[104:119]
    v_exp_f32 v48, v48
    v_exp_f32 v49, v49
    v_exp_f32 v50, v50
    v_exp_f32 v51, v51
    v_mfma_f32_32x32x16_bf16 v[72:87], v[152:155], v[68:71], v[72:87]
    v_exp_f32 v52, v52
    v_exp_f32 v53, v53
    v_exp_f32 v54, v54
    v_exp_f32 v55, v55
    v_mfma_f32_32x32x8_bf16 v[32:47], v[146:147], v[20:21], v[32:47]
    v_cvt_pk_bf16_f32 v64, v48, v49
    v_cvt_pk_bf16_f32 v65, v50, v51
    v_cvt_pk_bf16_f32 v66, v52, v53
    v_cvt_pk_bf16_f32 v67, v54, v55
    v_exp_f32 v56, v56
    v_exp_f32 v57, v57
    v_exp_f32 v58, v58
    v_exp_f32 v59, v59
    v_mfma_f32_32x32x16_bf16 v[88:103], v[148:151], v[64:67], v[88:103]
    v_exp_f32 v60, v60
    v_exp_f32 v61, v61
    v_exp_f32 v62, v62
    v_exp_f32 v63, v63
    v_cvt_pk_bf16_f32 v68, v56, v57
    v_cvt_pk_bf16_f32 v69, v58, v59
    v_cvt_pk_bf16_f32 v70, v60, v61
    v_cvt_pk_bf16_f32 v71, v62, v63
    s_setprio 1
    v_mfma_f32_32x32x16_bf16 v[48:63], v[142:145], v[22:25], v[120:135]
    v_exp_f32 v32, v32
    v_exp_f32 v33, v33
    v_exp_f32 v34, v34
    v_exp_f32 v35, v35
    v_mfma_f32_32x32x16_bf16 v[88:103], v[152:155], v[68:71], v[88:103]
    s_waitcnt vmcnt(0)
    s_barrier
    ds_read_b128 v[136:139], v4 offset:0
    ds_read_b64 v[140:141], v6 offset:0
    v_exp_f32 v36, v36
    v_exp_f32 v37, v37
    v_exp_f32 v38, v38
    v_exp_f32 v39, v39
    v_mfma_f32_32x32x8_bf16 v[48:63], v[146:147], v[26:27], v[48:63]
    ds_read_b128 v[148:151], v5 offset:1024
    v_cvt_pk_bf16_f32 v64, v32, v33
    v_cvt_pk_bf16_f32 v65, v34, v35
    v_cvt_pk_bf16_f32 v66, v36, v37
    v_cvt_pk_bf16_f32 v67, v38, v39
    v_exp_f32 v40, v40
    v_exp_f32 v41, v41
    v_exp_f32 v42, v42
    v_exp_f32 v43, v43
    v_mfma_f32_32x32x16_bf16 v[72:87], v[156:159], v[64:67], v[72:87]
    ds_read_b128 v[152:155], v4 offset:2048
    v_exp_f32 v44, v44
    v_exp_f32 v45, v45
    v_exp_f32 v46, v46
    v_exp_f32 v47, v47
    v_cvt_pk_bf16_f32 v68, v40, v41
    v_cvt_pk_bf16_f32 v69, v42, v43
    v_cvt_pk_bf16_f32 v70, v44, v45
    v_cvt_pk_bf16_f32 v71, v46, v47
    s_setprio 0
    s_waitcnt lgkmcnt(0)
    v_mfma_f32_32x32x16_bf16 v[32:47], v[136:139], v[16:19], v[104:119]
    v_exp_f32 v48, v48
    v_exp_f32 v49, v49
    v_exp_f32 v50, v50
    v_exp_f32 v51, v51
    v_mfma_f32_32x32x16_bf16 v[72:87], v[160:163], v[68:71], v[72:87]
    s_add_u32 m0, s33, 24576
    s_add_u32 s61, s32, 61440
    buffer_load_dwordx4 v3, s[4:7], s61 offen sc1 lds
    v_exp_f32 v52, v52
    v_exp_f32 v53, v53
    v_exp_f32 v54, v54
    v_exp_f32 v55, v55
    v_mfma_f32_32x32x8_bf16 v[32:47], v[140:141], v[20:21], v[32:47]
    buffer_load_dwordx4 v3, s[4:7], s61 offen offset:1024 sc1 lds
    v_cvt_pk_bf16_f32 v64, v48, v49
    v_cvt_pk_bf16_f32 v65, v50, v51
    v_cvt_pk_bf16_f32 v66, v52, v53
    v_cvt_pk_bf16_f32 v67, v54, v55
    v_exp_f32 v56, v56
    v_exp_f32 v57, v57
    v_exp_f32 v58, v58
    v_exp_f32 v59, v59
    v_mfma_f32_32x32x16_bf16 v[88:103], v[156:159], v[64:67], v[88:103]
    buffer_load_dwordx4 v3, s[4:7], s61 offen offset:2048 sc1 lds
    v_exp_f32 v60, v60
    v_exp_f32 v61, v61
    v_exp_f32 v62, v62
    v_exp_f32 v63, v63
    v_cvt_pk_bf16_f32 v68, v56, v57
    v_cvt_pk_bf16_f32 v69, v58, v59
    v_cvt_pk_bf16_f32 v70, v60, v61
    v_cvt_pk_bf16_f32 v71, v62, v63
    s_setprio 1
    v_mfma_f32_32x32x16_bf16 v[48:63], v[136:139], v[22:25], v[120:135]
    v_exp_f32 v32, v32
    v_exp_f32 v33, v33
    v_exp_f32 v34, v34
    v_exp_f32 v35, v35
    v_mfma_f32_32x32x16_bf16 v[88:103], v[160:163], v[68:71], v[88:103]
    ds_read_b128 v[142:145], v4 offset:3072
    ds_read_b64 v[146:147], v6 offset:3072
    s_add_u32 m0, s33, 36864
    s_add_u32 s61, s32, 159744
    buffer_load_dwordx4 v3, s[4:7], s61 offen sc1 lds
    v_exp_f32 v36, v36
    v_exp_f32 v37, v37
    v_exp_f32 v38, v38
    v_exp_f32 v39, v39
    v_mfma_f32_32x32x8_bf16 v[48:63], v[140:141], v[26:27], v[48:63]
    ds_read_b128 v[156:159], v5 offset:4096
    buffer_load_dwordx4 v3, s[4:7], s61 offen offset:1024 sc1 lds
    v_cvt_pk_bf16_f32 v64, v32, v33
    v_cvt_pk_bf16_f32 v65, v34, v35
    v_cvt_pk_bf16_f32 v66, v36, v37
    v_cvt_pk_bf16_f32 v67, v38, v39
    v_exp_f32 v40, v40
    v_exp_f32 v41, v41
    v_exp_f32 v42, v42
    v_exp_f32 v43, v43
    v_mfma_f32_32x32x16_bf16 v[72:87], v[148:151], v[64:67], v[72:87]
    ds_read_b128 v[160:163], v4 offset:5120
    buffer_load_dwordx4 v3, s[4:7], s61 offen offset:2048 sc1 lds
    v_exp_f32 v44, v44
    v_exp_f32 v45, v45
    v_exp_f32 v46, v46
    v_exp_f32 v47, v47
    v_cvt_pk_bf16_f32 v68, v40, v41
    v_cvt_pk_bf16_f32 v69, v42, v43
    v_cvt_pk_bf16_f32 v70, v44, v45
    v_cvt_pk_bf16_f32 v71, v46, v47
    s_setprio 0
    s_waitcnt lgkmcnt(0)
    v_mfma_f32_32x32x16_bf16 v[32:47], v[142:145], v[16:19], v[104:119]
    v_exp_f32 v48, v48
    v_exp_f32 v49, v49
    v_exp_f32 v50, v50
    v_exp_f32 v51, v51
    v_mfma_f32_32x32x16_bf16 v[72:87], v[152:155], v[68:71], v[72:87]
    v_exp_f32 v52, v52
    v_exp_f32 v53, v53
    v_exp_f32 v54, v54
    v_exp_f32 v55, v55
    v_mfma_f32_32x32x8_bf16 v[32:47], v[146:147], v[20:21], v[32:47]
    v_cvt_pk_bf16_f32 v64, v48, v49
    v_cvt_pk_bf16_f32 v65, v50, v51
    v_cvt_pk_bf16_f32 v66, v52, v53
    v_cvt_pk_bf16_f32 v67, v54, v55
    v_exp_f32 v56, v56
    v_exp_f32 v57, v57
    v_exp_f32 v58, v58
    v_exp_f32 v59, v59
    v_mfma_f32_32x32x16_bf16 v[88:103], v[148:151], v[64:67], v[88:103]
    v_exp_f32 v60, v60
    v_exp_f32 v61, v61
    v_exp_f32 v62, v62
    v_exp_f32 v63, v63
    v_cvt_pk_bf16_f32 v68, v56, v57
    v_cvt_pk_bf16_f32 v69, v58, v59
    v_cvt_pk_bf16_f32 v70, v60, v61
    v_cvt_pk_bf16_f32 v71, v62, v63
    s_setprio 1
    v_mfma_f32_32x32x16_bf16 v[48:63], v[142:145], v[22:25], v[120:135]
    v_exp_f32 v32, v32
    v_exp_f32 v33, v33
    v_exp_f32 v34, v34
    v_exp_f32 v35, v35
    v_mfma_f32_32x32x16_bf16 v[88:103], v[152:155], v[68:71], v[88:103]
    ds_read_b128 v[136:139], v4 offset:6144
    ds_read_b64 v[140:141], v6 offset:6144
    v_exp_f32 v36, v36
    v_exp_f32 v37, v37
    v_exp_f32 v38, v38
    v_exp_f32 v39, v39
    v_mfma_f32_32x32x8_bf16 v[48:63], v[146:147], v[26:27], v[48:63]
    ds_read_b128 v[148:151], v5 offset:7168
    v_cvt_pk_bf16_f32 v64, v32, v33
    v_cvt_pk_bf16_f32 v65, v34, v35
    v_cvt_pk_bf16_f32 v66, v36, v37
    v_cvt_pk_bf16_f32 v67, v38, v39
    v_exp_f32 v40, v40
    v_exp_f32 v41, v41
    v_exp_f32 v42, v42
    v_exp_f32 v43, v43
    v_mfma_f32_32x32x16_bf16 v[72:87], v[156:159], v[64:67], v[72:87]
    ds_read_b128 v[152:155], v4 offset:8192
    v_exp_f32 v44, v44
    v_exp_f32 v45, v45
    v_exp_f32 v46, v46
    v_exp_f32 v47, v47
    v_cvt_pk_bf16_f32 v68, v40, v41
    v_cvt_pk_bf16_f32 v69, v42, v43
    v_cvt_pk_bf16_f32 v70, v44, v45
    v_cvt_pk_bf16_f32 v71, v46, v47
    s_setprio 0
    s_waitcnt lgkmcnt(0)
    v_mfma_f32_32x32x16_bf16 v[32:47], v[136:139], v[16:19], v[104:119]
    v_exp_f32 v48, v48
    v_exp_f32 v49, v49
    v_exp_f32 v50, v50
    v_exp_f32 v51, v51
    v_mfma_f32_32x32x16_bf16 v[72:87], v[160:163], v[68:71], v[72:87]
    v_exp_f32 v52, v52
    v_exp_f32 v53, v53
    v_exp_f32 v54, v54
    v_exp_f32 v55, v55
    v_mfma_f32_32x32x8_bf16 v[32:47], v[140:141], v[20:21], v[32:47]
    v_cvt_pk_bf16_f32 v64, v48, v49
    v_cvt_pk_bf16_f32 v65, v50, v51
    v_cvt_pk_bf16_f32 v66, v52, v53
    v_cvt_pk_bf16_f32 v67, v54, v55
    v_exp_f32 v56, v56
    v_exp_f32 v57, v57
    v_exp_f32 v58, v58
    v_exp_f32 v59, v59
    v_mfma_f32_32x32x16_bf16 v[88:103], v[156:159], v[64:67], v[88:103]
    v_exp_f32 v60, v60
    v_exp_f32 v61, v61
    v_exp_f32 v62, v62
    v_exp_f32 v63, v63
    v_cvt_pk_bf16_f32 v68, v56, v57
    v_cvt_pk_bf16_f32 v69, v58, v59
    v_cvt_pk_bf16_f32 v70, v60, v61
    v_cvt_pk_bf16_f32 v71, v62, v63
    s_setprio 1
    v_mfma_f32_32x32x16_bf16 v[48:63], v[136:139], v[22:25], v[120:135]
    v_exp_f32 v32, v32
    v_exp_f32 v33, v33
    v_exp_f32 v34, v34
    v_exp_f32 v35, v35
    v_mfma_f32_32x32x16_bf16 v[88:103], v[160:163], v[68:71], v[88:103]
    ds_read_b128 v[142:145], v4 offset:9216
    ds_read_b64 v[146:147], v6 offset:9216
    v_exp_f32 v36, v36
    v_exp_f32 v37, v37
    v_exp_f32 v38, v38
    v_exp_f32 v39, v39
    v_mfma_f32_32x32x8_bf16 v[48:63], v[140:141], v[26:27], v[48:63]
    ds_read_b128 v[156:159], v5 offset:10240
    v_cvt_pk_bf16_f32 v64, v32, v33
    v_cvt_pk_bf16_f32 v65, v34, v35
    v_cvt_pk_bf16_f32 v66, v36, v37
    v_cvt_pk_bf16_f32 v67, v38, v39
    v_exp_f32 v40, v40
    v_exp_f32 v41, v41
    v_exp_f32 v42, v42
    v_exp_f32 v43, v43
    v_mfma_f32_32x32x16_bf16 v[72:87], v[148:151], v[64:67], v[72:87]
    ds_read_b128 v[160:163], v4 offset:11264
    v_exp_f32 v44, v44
    v_exp_f32 v45, v45
    v_exp_f32 v46, v46
    v_exp_f32 v47, v47
    v_cvt_pk_bf16_f32 v68, v40, v41
    v_cvt_pk_bf16_f32 v69, v42, v43
    v_cvt_pk_bf16_f32 v70, v44, v45
    v_cvt_pk_bf16_f32 v71, v46, v47
    s_setprio 0
    s_waitcnt lgkmcnt(0)
    v_mfma_f32_32x32x16_bf16 v[32:47], v[142:145], v[16:19], v[104:119]
    v_exp_f32 v48, v48
    v_exp_f32 v49, v49
    v_exp_f32 v50, v50
    v_exp_f32 v51, v51
    v_mfma_f32_32x32x16_bf16 v[72:87], v[152:155], v[68:71], v[72:87]
    v_exp_f32 v52, v52
    v_exp_f32 v53, v53
    v_exp_f32 v54, v54
    v_exp_f32 v55, v55
    v_mfma_f32_32x32x8_bf16 v[32:47], v[146:147], v[20:21], v[32:47]
    v_cvt_pk_bf16_f32 v64, v48, v49
    v_cvt_pk_bf16_f32 v65, v50, v51
    v_cvt_pk_bf16_f32 v66, v52, v53
    v_cvt_pk_bf16_f32 v67, v54, v55
    v_exp_f32 v56, v56
    v_exp_f32 v57, v57
    v_exp_f32 v58, v58
    v_exp_f32 v59, v59
    v_mfma_f32_32x32x16_bf16 v[88:103], v[148:151], v[64:67], v[88:103]
    v_exp_f32 v60, v60
    v_exp_f32 v61, v61
    v_exp_f32 v62, v62
    v_exp_f32 v63, v63
    v_cvt_pk_bf16_f32 v68, v56, v57
    v_cvt_pk_bf16_f32 v69, v58, v59
    v_cvt_pk_bf16_f32 v70, v60, v61
    v_cvt_pk_bf16_f32 v71, v62, v63
    s_setprio 1
    v_mfma_f32_32x32x16_bf16 v[48:63], v[142:145], v[22:25], v[120:135]
    v_exp_f32 v32, v32
    v_exp_f32 v33, v33
    v_exp_f32 v34, v34
    v_exp_f32 v35, v35
    v_mfma_f32_32x32x16_bf16 v[88:103], v[152:155], v[68:71], v[88:103]
    s_waitcnt vmcnt(0)
    s_barrier
    ds_read_b128 v[136:139], v4 offset:24576
    ds_read_b64 v[140:141], v6 offset:24576
    v_exp_f32 v36, v36
    v_exp_f32 v37, v37
    v_exp_f32 v38, v38
    v_exp_f32 v39, v39
    v_mfma_f32_32x32x8_bf16 v[48:63], v[146:147], v[26:27], v[48:63]
    ds_read_b128 v[148:151], v5 offset:25600
    v_cvt_pk_bf16_f32 v64, v32, v33
    v_cvt_pk_bf16_f32 v65, v34, v35
    v_cvt_pk_bf16_f32 v66, v36, v37
    v_cvt_pk_bf16_f32 v67, v38, v39
    v_exp_f32 v40, v40
    v_exp_f32 v41, v41
    v_exp_f32 v42, v42
    v_exp_f32 v43, v43
    v_mfma_f32_32x32x16_bf16 v[72:87], v[156:159], v[64:67], v[72:87]
    ds_read_b128 v[152:155], v4 offset:26624
    v_exp_f32 v44, v44
    v_exp_f32 v45, v45
    v_exp_f32 v46, v46
    v_exp_f32 v47, v47
    v_cvt_pk_bf16_f32 v68, v40, v41
    v_cvt_pk_bf16_f32 v69, v42, v43
    v_cvt_pk_bf16_f32 v70, v44, v45
    v_cvt_pk_bf16_f32 v71, v46, v47
    s_setprio 0
    s_waitcnt lgkmcnt(0)
    v_mfma_f32_32x32x16_bf16 v[32:47], v[136:139], v[16:19], v[104:119]
    v_exp_f32 v48, v48
    v_exp_f32 v49, v49
    v_exp_f32 v50, v50
    v_exp_f32 v51, v51
    v_mfma_f32_32x32x16_bf16 v[72:87], v[160:163], v[68:71], v[72:87]
    s_add_u32 m0, s33, 0
    s_add_u32 s61, s32, 73728
    buffer_load_dwordx4 v3, s[4:7], s61 offen sc1 lds
    v_exp_f32 v52, v52
    v_exp_f32 v53, v53
    v_exp_f32 v54, v54
    v_exp_f32 v55, v55
    v_mfma_f32_32x32x8_bf16 v[32:47], v[140:141], v[20:21], v[32:47]
    buffer_load_dwordx4 v3, s[4:7], s61 offen offset:1024 sc1 lds
    v_cvt_pk_bf16_f32 v64, v48, v49
    v_cvt_pk_bf16_f32 v65, v50, v51
    v_cvt_pk_bf16_f32 v66, v52, v53
    v_cvt_pk_bf16_f32 v67, v54, v55
    v_exp_f32 v56, v56
    v_exp_f32 v57, v57
    v_exp_f32 v58, v58
    v_exp_f32 v59, v59
    v_mfma_f32_32x32x16_bf16 v[88:103], v[156:159], v[64:67], v[88:103]
    buffer_load_dwordx4 v3, s[4:7], s61 offen offset:2048 sc1 lds
    v_exp_f32 v60, v60
    v_exp_f32 v61, v61
    v_exp_f32 v62, v62
    v_exp_f32 v63, v63
    v_cvt_pk_bf16_f32 v68, v56, v57
    v_cvt_pk_bf16_f32 v69, v58, v59
    v_cvt_pk_bf16_f32 v70, v60, v61
    v_cvt_pk_bf16_f32 v71, v62, v63
    s_setprio 1
    v_mfma_f32_32x32x16_bf16 v[48:63], v[136:139], v[22:25], v[120:135]
    v_exp_f32 v32, v32
    v_exp_f32 v33, v33
    v_exp_f32 v34, v34
    v_exp_f32 v35, v35
    v_mfma_f32_32x32x16_bf16 v[88:103], v[160:163], v[68:71], v[88:103]
    ds_read_b128 v[142:145], v4 offset:27648
    ds_read_b64 v[146:147], v6 offset:27648
    s_add_u32 m0, s33, 12288
    s_add_u32 s61, s32, 172032
    buffer_load_dwordx4 v3, s[4:7], s61 offen sc1 lds
    v_exp_f32 v36, v36
    v_exp_f32 v37, v37
    v_exp_f32 v38, v38
    v_exp_f32 v39, v39
    v_mfma_f32_32x32x8_bf16 v[48:63], v[140:141], v[26:27], v[48:63]
    ds_read_b128 v[156:159], v5 offset:28672
    buffer_load_dwordx4 v3, s[4:7], s61 offen offset:1024 sc1 lds
    v_cvt_pk_bf16_f32 v64, v32, v33
    v_cvt_pk_bf16_f32 v65, v34, v35
    v_cvt_pk_bf16_f32 v66, v36, v37
    v_cvt_pk_bf16_f32 v67, v38, v39
    v_exp_f32 v40, v40
    v_exp_f32 v41, v41
    v_exp_f32 v42, v42
    v_exp_f32 v43, v43
    v_mfma_f32_32x32x16_bf16 v[72:87], v[148:151], v[64:67], v[72:87]
    ds_read_b128 v[160:163], v4 offset:29696
    buffer_load_dwordx4 v3, s[4:7], s61 offen offset:2048 sc1 lds
    v_exp_f32 v44, v44
    v_exp_f32 v45, v45
    v_exp_f32 v46, v46
    v_exp_f32 v47, v47
    v_cvt_pk_bf16_f32 v68, v40, v41
    v_cvt_pk_bf16_f32 v69, v42, v43
    v_cvt_pk_bf16_f32 v70, v44, v45
    v_cvt_pk_bf16_f32 v71, v46, v47
    s_setprio 0
    s_waitcnt lgkmcnt(0)
    v_mfma_f32_32x32x16_bf16 v[32:47], v[142:145], v[16:19], v[104:119]
    v_exp_f32 v48, v48
    v_exp_f32 v49, v49
    v_exp_f32 v50, v50
    v_exp_f32 v51, v51
    v_mfma_f32_32x32x16_bf16 v[72:87], v[152:155], v[68:71], v[72:87]
    v_exp_f32 v52, v52
    v_exp_f32 v53, v53
    v_exp_f32 v54, v54
    v_exp_f32 v55, v55
    v_mfma_f32_32x32x8_bf16 v[32:47], v[146:147], v[20:21], v[32:47]
    v_cvt_pk_bf16_f32 v64, v48, v49
    v_cvt_pk_bf16_f32 v65, v50, v51
    v_cvt_pk_bf16_f32 v66, v52, v53
    v_cvt_pk_bf16_f32 v67, v54, v55
    v_exp_f32 v56, v56
    v_exp_f32 v57, v57
    v_exp_f32 v58, v58
    v_exp_f32 v59, v59
    v_mfma_f32_32x32x16_bf16 v[88:103], v[148:151], v[64:67], v[88:103]
    v_exp_f32 v60, v60
    v_exp_f32 v61, v61
    v_exp_f32 v62, v62
    v_exp_f32 v63, v63
    v_cvt_pk_bf16_f32 v68, v56, v57
    v_cvt_pk_bf16_f32 v69, v58, v59
    v_cvt_pk_bf16_f32 v70, v60, v61
    v_cvt_pk_bf16_f32 v71, v62, v63
    s_setprio 1
    v_mfma_f32_32x32x16_bf16 v[48:63], v[142:145], v[22:25], v[120:135]
    v_exp_f32 v32, v32
    v_exp_f32 v33, v33
    v_exp_f32 v34, v34
    v_exp_f32 v35, v35
    v_mfma_f32_32x32x16_bf16 v[88:103], v[152:155], v[68:71], v[88:103]
    ds_read_b128 v[136:139], v4 offset:30720
    ds_read_b64 v[140:141], v6 offset:30720
    v_exp_f32 v36, v36
    v_exp_f32 v37, v37
    v_exp_f32 v38, v38
    v_exp_f32 v39, v39
    v_mfma_f32_32x32x8_bf16 v[48:63], v[146:147], v[26:27], v[48:63]
    ds_read_b128 v[148:151], v5 offset:31744
    v_cvt_pk_bf16_f32 v64, v32, v33
    v_cvt_pk_bf16_f32 v65, v34, v35
    v_cvt_pk_bf16_f32 v66, v36, v37
    v_cvt_pk_bf16_f32 v67, v38, v39
    v_exp_f32 v40, v40
    v_exp_f32 v41, v41
    v_exp_f32 v42, v42
    v_exp_f32 v43, v43
    v_mfma_f32_32x32x16_bf16 v[72:87], v[156:159], v[64:67], v[72:87]
    ds_read_b128 v[152:155], v4 offset:32768
    v_exp_f32 v44, v44
    v_exp_f32 v45, v45
    v_exp_f32 v46, v46
    v_exp_f32 v47, v47
    v_cvt_pk_bf16_f32 v68, v40, v41
    v_cvt_pk_bf16_f32 v69, v42, v43
    v_cvt_pk_bf16_f32 v70, v44, v45
    v_cvt_pk_bf16_f32 v71, v46, v47
    s_setprio 0
    s_waitcnt lgkmcnt(0)
    v_mfma_f32_32x32x16_bf16 v[32:47], v[136:139], v[16:19], v[104:119]
    v_exp_f32 v48, v48
    v_exp_f32 v49, v49
    v_exp_f32 v50, v50
    v_exp_f32 v51, v51
    v_mfma_f32_32x32x16_bf16 v[72:87], v[160:163], v[68:71], v[72:87]
    v_exp_f32 v52, v52
    v_exp_f32 v53, v53
    v_exp_f32 v54, v54
    v_exp_f32 v55, v55
    v_mfma_f32_32x32x8_bf16 v[32:47], v[140:141], v[20:21], v[32:47]
    v_cvt_pk_bf16_f32 v64, v48, v49
    v_cvt_pk_bf16_f32 v65, v50, v51
    v_cvt_pk_bf16_f32 v66, v52, v53
    v_cvt_pk_bf16_f32 v67, v54, v55
    v_exp_f32 v56, v56
    v_exp_f32 v57, v57
    v_exp_f32 v58, v58
    v_exp_f32 v59, v59
    v_mfma_f32_32x32x16_bf16 v[88:103], v[156:159], v[64:67], v[88:103]
    v_exp_f32 v60, v60
    v_exp_f32 v61, v61
    v_exp_f32 v62, v62
    v_exp_f32 v63, v63
    v_cvt_pk_bf16_f32 v68, v56, v57
    v_cvt_pk_bf16_f32 v69, v58, v59
    v_cvt_pk_bf16_f32 v70, v60, v61
    v_cvt_pk_bf16_f32 v71, v62, v63
    s_setprio 1
    v_mfma_f32_32x32x16_bf16 v[48:63], v[136:139], v[22:25], v[120:135]
    v_exp_f32 v32, v32
    v_exp_f32 v33, v33
    v_exp_f32 v34, v34
    v_exp_f32 v35, v35
    v_mfma_f32_32x32x16_bf16 v[88:103], v[160:163], v[68:71], v[88:103]
    ds_read_b128 v[142:145], v4 offset:33792
    ds_read_b64 v[146:147], v6 offset:33792
    v_exp_f32 v36, v36
    v_exp_f32 v37, v37
    v_exp_f32 v38, v38
    v_exp_f32 v39, v39
    v_mfma_f32_32x32x8_bf16 v[48:63], v[140:141], v[26:27], v[48:63]
    ds_read_b128 v[156:159], v5 offset:34816
    v_cvt_pk_bf16_f32 v64, v32, v33
    v_cvt_pk_bf16_f32 v65, v34, v35
    v_cvt_pk_bf16_f32 v66, v36, v37
    v_cvt_pk_bf16_f32 v67, v38, v39
    v_exp_f32 v40, v40
    v_exp_f32 v41, v41
    v_exp_f32 v42, v42
    v_exp_f32 v43, v43
    v_mfma_f32_32x32x16_bf16 v[72:87], v[148:151], v[64:67], v[72:87]
    ds_read_b128 v[160:163], v4 offset:35840
    v_exp_f32 v44, v44
    v_exp_f32 v45, v45
    v_exp_f32 v46, v46
    v_exp_f32 v47, v47
    v_cvt_pk_bf16_f32 v68, v40, v41
    v_cvt_pk_bf16_f32 v69, v42, v43
    v_cvt_pk_bf16_f32 v70, v44, v45
    v_cvt_pk_bf16_f32 v71, v46, v47
    s_setprio 0
    s_waitcnt lgkmcnt(0)
    v_mfma_f32_32x32x16_bf16 v[32:47], v[142:145], v[16:19], v[104:119]
    v_exp_f32 v48, v48
    v_exp_f32 v49, v49
    v_exp_f32 v50, v50
    v_exp_f32 v51, v51
    v_mfma_f32_32x32x16_bf16 v[72:87], v[152:155], v[68:71], v[72:87]
    v_exp_f32 v52, v52
    v_exp_f32 v53, v53
    v_exp_f32 v54, v54
    v_exp_f32 v55, v55
    v_mfma_f32_32x32x8_bf16 v[32:47], v[146:147], v[20:21], v[32:47]
    v_cvt_pk_bf16_f32 v64, v48, v49
    v_cvt_pk_bf16_f32 v65, v50, v51
    v_cvt_pk_bf16_f32 v66, v52, v53
    v_cvt_pk_bf16_f32 v67, v54, v55
    v_exp_f32 v56, v56
    v_exp_f32 v57, v57
    v_exp_f32 v58, v58
    v_exp_f32 v59, v59
    v_mfma_f32_32x32x16_bf16 v[88:103], v[148:151], v[64:67], v[88:103]
    v_exp_f32 v60, v60
    v_exp_f32 v61, v61
    v_exp_f32 v62, v62
    v_exp_f32 v63, v63
    v_cvt_pk_bf16_f32 v68, v56, v57
    v_cvt_pk_bf16_f32 v69, v58, v59
    v_cvt_pk_bf16_f32 v70, v60, v61
    v_cvt_pk_bf16_f32 v71, v62, v63
    s_setprio 1
    v_mfma_f32_32x32x16_bf16 v[48:63], v[142:145], v[22:25], v[120:135]
    v_exp_f32 v32, v32
    v_exp_f32 v33, v33
    v_exp_f32 v34, v34
    v_exp_f32 v35, v35
    v_mfma_f32_32x32x16_bf16 v[88:103], v[152:155], v[68:71], v[88:103]
    s_waitcnt vmcnt(0)
    s_barrier
    ds_read_b128 v[136:139], v4 offset:0
    ds_read_b64 v[140:141], v6 offset:0
    v_exp_f32 v36, v36
    v_exp_f32 v37, v37
    v_exp_f32 v38, v38
    v_exp_f32 v39, v39
    v_mfma_f32_32x32x8_bf16 v[48:63], v[146:147], v[26:27], v[48:63]
    ds_read_b128 v[148:151], v5 offset:1024
    v_cvt_pk_bf16_f32 v64, v32, v33
    v_cvt_pk_bf16_f32 v65, v34, v35
    v_cvt_pk_bf16_f32 v66, v36, v37
    v_cvt_pk_bf16_f32 v67, v38, v39
    v_exp_f32 v40, v40
    v_exp_f32 v41, v41
    v_exp_f32 v42, v42
    v_exp_f32 v43, v43
    v_mfma_f32_32x32x16_bf16 v[72:87], v[156:159], v[64:67], v[72:87]
    ds_read_b128 v[152:155], v4 offset:2048
    v_exp_f32 v44, v44
    v_exp_f32 v45, v45
    v_exp_f32 v46, v46
    v_exp_f32 v47, v47
    v_cvt_pk_bf16_f32 v68, v40, v41
    v_cvt_pk_bf16_f32 v69, v42, v43
    v_cvt_pk_bf16_f32 v70, v44, v45
    v_cvt_pk_bf16_f32 v71, v46, v47
    s_setprio 0
    s_waitcnt lgkmcnt(0)
    v_mfma_f32_32x32x16_bf16 v[32:47], v[136:139], v[16:19], v[104:119]
    v_exp_f32 v48, v48
    v_exp_f32 v49, v49
    v_exp_f32 v50, v50
    v_exp_f32 v51, v51
    v_mfma_f32_32x32x16_bf16 v[72:87], v[160:163], v[68:71], v[72:87]
    s_add_u32 m0, s33, 24576
    s_add_u32 s61, s32, 86016
    buffer_load_dwordx4 v3, s[4:7], s61 offen sc1 lds
    v_exp_f32 v52, v52
    v_exp_f32 v53, v53
    v_exp_f32 v54, v54
    v_exp_f32 v55, v55
    v_mfma_f32_32x32x8_bf16 v[32:47], v[140:141], v[20:21], v[32:47]
    buffer_load_dwordx4 v3, s[4:7], s61 offen offset:1024 sc1 lds
    v_cvt_pk_bf16_f32 v64, v48, v49
    v_cvt_pk_bf16_f32 v65, v50, v51
    v_cvt_pk_bf16_f32 v66, v52, v53
    v_cvt_pk_bf16_f32 v67, v54, v55
    v_exp_f32 v56, v56
    v_exp_f32 v57, v57
    v_exp_f32 v58, v58
    v_exp_f32 v59, v59
    v_mfma_f32_32x32x16_bf16 v[88:103], v[156:159], v[64:67], v[88:103]
    buffer_load_dwordx4 v3, s[4:7], s61 offen offset:2048 sc1 lds
    v_exp_f32 v60, v60
    v_exp_f32 v61, v61
    v_exp_f32 v62, v62
    v_exp_f32 v63, v63
    v_cvt_pk_bf16_f32 v68, v56, v57
    v_cvt_pk_bf16_f32 v69, v58, v59
    v_cvt_pk_bf16_f32 v70, v60, v61
    v_cvt_pk_bf16_f32 v71, v62, v63
    s_setprio 1
    v_mfma_f32_32x32x16_bf16 v[48:63], v[136:139], v[22:25], v[120:135]
    v_exp_f32 v32, v32
    v_exp_f32 v33, v33
    v_exp_f32 v34, v34
    v_exp_f32 v35, v35
    v_mfma_f32_32x32x16_bf16 v[88:103], v[160:163], v[68:71], v[88:103]
    ds_read_b128 v[142:145], v4 offset:3072
    ds_read_b64 v[146:147], v6 offset:3072
    s_add_u32 m0, s33, 36864
    s_add_u32 s61, s32, 184320
    buffer_load_dwordx4 v3, s[4:7], s61 offen sc1 lds
    v_exp_f32 v36, v36
    v_exp_f32 v37, v37
    v_exp_f32 v38, v38
    v_exp_f32 v39, v39
    v_mfma_f32_32x32x8_bf16 v[48:63], v[140:141], v[26:27], v[48:63]
    ds_read_b128 v[156:159], v5 offset:4096
    buffer_load_dwordx4 v3, s[4:7], s61 offen offset:1024 sc1 lds
    v_cvt_pk_bf16_f32 v64, v32, v33
    v_cvt_pk_bf16_f32 v65, v34, v35
    v_cvt_pk_bf16_f32 v66, v36, v37
    v_cvt_pk_bf16_f32 v67, v38, v39
    v_exp_f32 v40, v40
    v_exp_f32 v41, v41
    v_exp_f32 v42, v42
    v_exp_f32 v43, v43
    v_mfma_f32_32x32x16_bf16 v[72:87], v[148:151], v[64:67], v[72:87]
    ds_read_b128 v[160:163], v4 offset:5120
    buffer_load_dwordx4 v3, s[4:7], s61 offen offset:2048 sc1 lds
    v_exp_f32 v44, v44
    v_exp_f32 v45, v45
    v_exp_f32 v46, v46
    v_exp_f32 v47, v47
    v_cvt_pk_bf16_f32 v68, v40, v41
    v_cvt_pk_bf16_f32 v69, v42, v43
    v_cvt_pk_bf16_f32 v70, v44, v45
    v_cvt_pk_bf16_f32 v71, v46, v47
    s_setprio 0
    s_waitcnt lgkmcnt(0)
    v_mfma_f32_32x32x16_bf16 v[32:47], v[142:145], v[16:19], v[104:119]
    v_exp_f32 v48, v48
    v_exp_f32 v49, v49
    v_exp_f32 v50, v50
    v_exp_f32 v51, v51
    v_mfma_f32_32x32x16_bf16 v[72:87], v[152:155], v[68:71], v[72:87]
    v_exp_f32 v52, v52
    v_exp_f32 v53, v53
    v_exp_f32 v54, v54
    v_exp_f32 v55, v55
    v_mfma_f32_32x32x8_bf16 v[32:47], v[146:147], v[20:21], v[32:47]
    v_cvt_pk_bf16_f32 v64, v48, v49
    v_cvt_pk_bf16_f32 v65, v50, v51
    v_cvt_pk_bf16_f32 v66, v52, v53
    v_cvt_pk_bf16_f32 v67, v54, v55
    v_exp_f32 v56, v56
    v_exp_f32 v57, v57
    v_exp_f32 v58, v58
    v_exp_f32 v59, v59
    v_mfma_f32_32x32x16_bf16 v[88:103], v[148:151], v[64:67], v[88:103]
    v_exp_f32 v60, v60
    v_exp_f32 v61, v61
    v_exp_f32 v62, v62
    v_exp_f32 v63, v63
    v_cvt_pk_bf16_f32 v68, v56, v57
    v_cvt_pk_bf16_f32 v69, v58, v59
    v_cvt_pk_bf16_f32 v70, v60, v61
    v_cvt_pk_bf16_f32 v71, v62, v63
    s_setprio 1
    v_mfma_f32_32x32x16_bf16 v[48:63], v[142:145], v[22:25], v[120:135]
    v_exp_f32 v32, v32
    v_exp_f32 v33, v33
    v_exp_f32 v34, v34
    v_exp_f32 v35, v35
    v_mfma_f32_32x32x16_bf16 v[88:103], v[152:155], v[68:71], v[88:103]
    ds_read_b128 v[136:139], v4 offset:6144
    ds_read_b64 v[140:141], v6 offset:6144
    v_exp_f32 v36, v36
    v_exp_f32 v37, v37
    v_exp_f32 v38, v38
    v_exp_f32 v39, v39
    v_mfma_f32_32x32x8_bf16 v[48:63], v[146:147], v[26:27], v[48:63]
    ds_read_b128 v[148:151], v5 offset:7168
    v_cvt_pk_bf16_f32 v64, v32, v33
    v_cvt_pk_bf16_f32 v65, v34, v35
    v_cvt_pk_bf16_f32 v66, v36, v37
    v_cvt_pk_bf16_f32 v67, v38, v39
    v_exp_f32 v40, v40
    v_exp_f32 v41, v41
    v_exp_f32 v42, v42
    v_exp_f32 v43, v43
    v_mfma_f32_32x32x16_bf16 v[72:87], v[156:159], v[64:67], v[72:87]
    ds_read_b128 v[152:155], v4 offset:8192
    v_exp_f32 v44, v44
    v_exp_f32 v45, v45
    v_exp_f32 v46, v46
    v_exp_f32 v47, v47
    v_cvt_pk_bf16_f32 v68, v40, v41
    v_cvt_pk_bf16_f32 v69, v42, v43
    v_cvt_pk_bf16_f32 v70, v44, v45
    v_cvt_pk_bf16_f32 v71, v46, v47
    s_setprio 0
    s_waitcnt lgkmcnt(0)
    v_mfma_f32_32x32x16_bf16 v[32:47], v[136:139], v[16:19], v[104:119]
    v_exp_f32 v48, v48
    v_exp_f32 v49, v49
    v_exp_f32 v50, v50
    v_exp_f32 v51, v51
    v_mfma_f32_32x32x16_bf16 v[72:87], v[160:163], v[68:71], v[72:87]
    v_exp_f32 v52, v52
    v_exp_f32 v53, v53
    v_exp_f32 v54, v54
    v_exp_f32 v55, v55
    v_mfma_f32_32x32x8_bf16 v[32:47], v[140:141], v[20:21], v[32:47]
    v_cvt_pk_bf16_f32 v64, v48, v49
    v_cvt_pk_bf16_f32 v65, v50, v51
    v_cvt_pk_bf16_f32 v66, v52, v53
    v_cvt_pk_bf16_f32 v67, v54, v55
    v_exp_f32 v56, v56
    v_exp_f32 v57, v57
    v_exp_f32 v58, v58
    v_exp_f32 v59, v59
    v_mfma_f32_32x32x16_bf16 v[88:103], v[156:159], v[64:67], v[88:103]
    v_exp_f32 v60, v60
    v_exp_f32 v61, v61
    v_exp_f32 v62, v62
    v_exp_f32 v63, v63
    v_cvt_pk_bf16_f32 v68, v56, v57
    v_cvt_pk_bf16_f32 v69, v58, v59
    v_cvt_pk_bf16_f32 v70, v60, v61
    v_cvt_pk_bf16_f32 v71, v62, v63
    s_setprio 1
    v_mfma_f32_32x32x16_bf16 v[48:63], v[136:139], v[22:25], v[120:135]
    v_exp_f32 v32, v32
    v_exp_f32 v33, v33
    v_exp_f32 v34, v34
    v_exp_f32 v35, v35
    v_mfma_f32_32x32x16_bf16 v[88:103], v[160:163], v[68:71], v[88:103]
    ds_read_b128 v[142:145], v4 offset:9216
    ds_read_b64 v[146:147], v6 offset:9216
    v_exp_f32 v36, v36
    v_exp_f32 v37, v37
    v_exp_f32 v38, v38
    v_exp_f32 v39, v39
    v_mfma_f32_32x32x8_bf16 v[48:63], v[140:141], v[26:27], v[48:63]
    ds_read_b128 v[156:159], v5 offset:10240
    v_cvt_pk_bf16_f32 v64, v32, v33
    v_cvt_pk_bf16_f32 v65, v34, v35
    v_cvt_pk_bf16_f32 v66, v36, v37
    v_cvt_pk_bf16_f32 v67, v38, v39
    v_exp_f32 v40, v40
    v_exp_f32 v41, v41
    v_exp_f32 v42, v42
    v_exp_f32 v43, v43
    v_mfma_f32_32x32x16_bf16 v[72:87], v[148:151], v[64:67], v[72:87]
    ds_read_b128 v[160:163], v4 offset:11264
    v_exp_f32 v44, v44
    v_exp_f32 v45, v45
    v_exp_f32 v46, v46
    v_exp_f32 v47, v47
    v_cvt_pk_bf16_f32 v68, v40, v41
    v_cvt_pk_bf16_f32 v69, v42, v43
    v_cvt_pk_bf16_f32 v70, v44, v45
    v_cvt_pk_bf16_f32 v71, v46, v47
    s_setprio 0
    s_waitcnt lgkmcnt(0)
    v_mfma_f32_32x32x16_bf16 v[32:47], v[142:145], v[16:19], v[104:119]
    v_exp_f32 v48, v48
    v_exp_f32 v49, v49
    v_exp_f32 v50, v50
    v_exp_f32 v51, v51
    v_mfma_f32_32x32x16_bf16 v[72:87], v[152:155], v[68:71], v[72:87]
    v_exp_f32 v52, v52
    v_exp_f32 v53, v53
    v_exp_f32 v54, v54
    v_exp_f32 v55, v55
    v_mfma_f32_32x32x8_bf16 v[32:47], v[146:147], v[20:21], v[32:47]
    v_cvt_pk_bf16_f32 v64, v48, v49
    v_cvt_pk_bf16_f32 v65, v50, v51
    v_cvt_pk_bf16_f32 v66, v52, v53
    v_cvt_pk_bf16_f32 v67, v54, v55
    v_exp_f32 v56, v56
    v_exp_f32 v57, v57
    v_exp_f32 v58, v58
    v_exp_f32 v59, v59
    v_mfma_f32_32x32x16_bf16 v[88:103], v[148:151], v[64:67], v[88:103]
    v_exp_f32 v60, v60
    v_exp_f32 v61, v61
    v_exp_f32 v62, v62
    v_exp_f32 v63, v63
    v_cvt_pk_bf16_f32 v68, v56, v57
    v_cvt_pk_bf16_f32 v69, v58, v59
    v_cvt_pk_bf16_f32 v70, v60, v61
    v_cvt_pk_bf16_f32 v71, v62, v63
    s_setprio 1
    v_mfma_f32_32x32x16_bf16 v[48:63], v[142:145], v[22:25], v[120:135]
    v_exp_f32 v32, v32
    v_exp_f32 v33, v33
    v_exp_f32 v34, v34
    v_exp_f32 v35, v35
    v_mfma_f32_32x32x16_bf16 v[88:103], v[152:155], v[68:71], v[88:103]
    s_waitcnt vmcnt(0)
    s_barrier
    ds_read_b128 v[136:139], v4 offset:24576
    ds_read_b64 v[140:141], v6 offset:24576
    v_exp_f32 v36, v36
    v_exp_f32 v37, v37
    v_exp_f32 v38, v38
    v_exp_f32 v39, v39
    v_mfma_f32_32x32x8_bf16 v[48:63], v[146:147], v[26:27], v[48:63]
    ds_read_b128 v[148:151], v5 offset:25600
    v_cvt_pk_bf16_f32 v64, v32, v33
    v_cvt_pk_bf16_f32 v65, v34, v35
    v_cvt_pk_bf16_f32 v66, v36, v37
    v_cvt_pk_bf16_f32 v67, v38, v39
    v_exp_f32 v40, v40
    v_exp_f32 v41, v41
    v_exp_f32 v42, v42
    v_exp_f32 v43, v43
    v_mfma_f32_32x32x16_bf16 v[72:87], v[156:159], v[64:67], v[72:87]
    ds_read_b128 v[152:155], v4 offset:26624
    v_exp_f32 v44, v44
    v_exp_f32 v45, v45
    v_exp_f32 v46, v46
    v_exp_f32 v47, v47
    v_cvt_pk_bf16_f32 v68, v40, v41
    v_cvt_pk_bf16_f32 v69, v42, v43
    v_cvt_pk_bf16_f32 v70, v44, v45
    v_cvt_pk_bf16_f32 v71, v46, v47
    s_setprio 0
    s_waitcnt lgkmcnt(0)
    v_mfma_f32_32x32x16_bf16 v[32:47], v[136:139], v[16:19], v[104:119]
    v_exp_f32 v48, v48
    v_exp_f32 v49, v49
    v_exp_f32 v50, v50
    v_exp_f32 v51, v51
    v_mfma_f32_32x32x16_bf16 v[72:87], v[160:163], v[68:71], v[72:87]
    v_exp_f32 v52, v52
    v_exp_f32 v53, v53
    v_exp_f32 v54, v54
    v_exp_f32 v55, v55
    v_mfma_f32_32x32x8_bf16 v[32:47], v[140:141], v[20:21], v[32:47]
    v_cvt_pk_bf16_f32 v64, v48, v49
    v_cvt_pk_bf16_f32 v65, v50, v51
    v_cvt_pk_bf16_f32 v66, v52, v53
    v_cvt_pk_bf16_f32 v67, v54, v55
    v_exp_f32 v56, v56
    v_exp_f32 v57, v57
    v_exp_f32 v58, v58
    v_exp_f32 v59, v59
    v_mfma_f32_32x32x16_bf16 v[88:103], v[156:159], v[64:67], v[88:103]
    v_exp_f32 v60, v60
    v_exp_f32 v61, v61
    v_exp_f32 v62, v62
    v_exp_f32 v63, v63
    v_cvt_pk_bf16_f32 v68, v56, v57
    v_cvt_pk_bf16_f32 v69, v58, v59
    v_cvt_pk_bf16_f32 v70, v60, v61
    v_cvt_pk_bf16_f32 v71, v62, v63
    s_setprio 1
    v_mfma_f32_32x32x16_bf16 v[48:63], v[136:139], v[22:25], v[120:135]
    v_exp_f32 v32, v32
    v_exp_f32 v33, v33
    v_exp_f32 v34, v34
    v_exp_f32 v35, v35
    v_mfma_f32_32x32x16_bf16 v[88:103], v[160:163], v[68:71], v[88:103]
    ds_read_b128 v[142:145], v4 offset:27648
    ds_read_b64 v[146:147], v6 offset:27648
    v_exp_f32 v36, v36
    v_exp_f32 v37, v37
    v_exp_f32 v38, v38
    v_exp_f32 v39, v39
    v_mfma_f32_32x32x8_bf16 v[48:63], v[140:141], v[26:27], v[48:63]
    ds_read_b128 v[156:159], v5 offset:28672
    v_cvt_pk_bf16_f32 v64, v32, v33
    v_cvt_pk_bf16_f32 v65, v34, v35
    v_cvt_pk_bf16_f32 v66, v36, v37
    v_cvt_pk_bf16_f32 v67, v38, v39
    v_exp_f32 v40, v40
    v_exp_f32 v41, v41
    v_exp_f32 v42, v42
    v_exp_f32 v43, v43
    v_mfma_f32_32x32x16_bf16 v[72:87], v[148:151], v[64:67], v[72:87]
    ds_read_b128 v[160:163], v4 offset:29696
    v_exp_f32 v44, v44
    v_exp_f32 v45, v45
    v_exp_f32 v46, v46
    v_exp_f32 v47, v47
    s_lshl_b32 s60, s25, 6
    s_lshl_b32 s61, s24, 4
    s_add_u32 s60, s60, s61
    v_and_b32 v10, 15, v2
    v_add_u32 v10, s60, v10
    v_mul_u32_u24 v10, 1280, v10
    v_lshrrev_b32 v12, 4, v2
    v_lshl_add_u32 v10, v12, 3, v10
    s_mul_i32 s60, s26, 160
    v_cvt_pk_bf16_f32 v68, v40, v41
    v_cvt_pk_bf16_f32 v69, v42, v43
    v_cvt_pk_bf16_f32 v70, v44, v45
    v_cvt_pk_bf16_f32 v71, v46, v47
    s_setprio 0
    s_waitcnt lgkmcnt(0)
    v_mfma_f32_32x32x16_bf16 v[32:47], v[142:145], v[16:19], v[104:119]
    v_exp_f32 v48, v48
    v_exp_f32 v49, v49
    v_exp_f32 v50, v50
    v_exp_f32 v51, v51
    v_mfma_f32_32x32x16_bf16 v[72:87], v[152:155], v[68:71], v[72:87]
    buffer_load_dwordx2 v[230:231], v10, s[8:11], s60 offen offset:0
    v_exp_f32 v52, v52
    v_exp_f32 v53, v53
    v_exp_f32 v54, v54
    v_exp_f32 v55, v55
    v_mfma_f32_32x32x8_bf16 v[32:47], v[146:147], v[20:21], v[32:47]
    buffer_load_dwordx2 v[232:233], v10, s[8:11], s60 offen offset:32
    v_cvt_pk_bf16_f32 v64, v48, v49
    v_cvt_pk_bf16_f32 v65, v50, v51
    v_cvt_pk_bf16_f32 v66, v52, v53
    v_cvt_pk_bf16_f32 v67, v54, v55
    v_exp_f32 v56, v56
    v_exp_f32 v57, v57
    v_exp_f32 v58, v58
    v_exp_f32 v59, v59
    v_mfma_f32_32x32x16_bf16 v[88:103], v[148:151], v[64:67], v[88:103]
    buffer_load_dwordx2 v[234:235], v10, s[8:11], s60 offen offset:64
    v_exp_f32 v60, v60
    v_exp_f32 v61, v61
    v_exp_f32 v62, v62
    v_exp_f32 v63, v63
    v_cvt_pk_bf16_f32 v68, v56, v57
    v_cvt_pk_bf16_f32 v69, v58, v59
    v_cvt_pk_bf16_f32 v70, v60, v61
    v_cvt_pk_bf16_f32 v71, v62, v63
    s_setprio 1
    v_mfma_f32_32x32x16_bf16 v[48:63], v[142:145], v[22:25], v[120:135]
    v_exp_f32 v32, v32
    v_exp_f32 v33, v33
    v_exp_f32 v34, v34
    v_exp_f32 v35, v35
    v_mfma_f32_32x32x16_bf16 v[88:103], v[152:155], v[68:71], v[88:103]
    ds_read_b128 v[136:139], v4 offset:30720
    ds_read_b64 v[140:141], v6 offset:30720
    buffer_load_dwordx2 v[236:237], v10, s[8:11], s60 offen offset:96
    v_exp_f32 v36, v36
    v_exp_f32 v37, v37
    v_exp_f32 v38, v38
    v_exp_f32 v39, v39
    v_mfma_f32_32x32x8_bf16 v[48:63], v[146:147], v[26:27], v[48:63]
    ds_read_b128 v[148:151], v5 offset:31744
    buffer_load_dwordx2 v[238:239], v10, s[8:11], s60 offen offset:128
    v_cvt_pk_bf16_f32 v64, v32, v33
    v_cvt_pk_bf16_f32 v65, v34, v35
    v_cvt_pk_bf16_f32 v66, v36, v37
    v_cvt_pk_bf16_f32 v67, v38, v39
    v_exp_f32 v40, v40
    v_exp_f32 v41, v41
    v_exp_f32 v42, v42
    v_exp_f32 v43, v43
    v_mfma_f32_32x32x16_bf16 v[72:87], v[156:159], v[64:67], v[72:87]
    ds_read_b128 v[152:155], v4 offset:32768
    v_exp_f32 v44, v44
    v_exp_f32 v45, v45
    v_exp_f32 v46, v46
    v_exp_f32 v47, v47
    v_cvt_pk_bf16_f32 v68, v40, v41
    v_cvt_pk_bf16_f32 v69, v42, v43
    v_cvt_pk_bf16_f32 v70, v44, v45
    v_cvt_pk_bf16_f32 v71, v46, v47
    s_setprio 0
    s_waitcnt lgkmcnt(0)
    v_mfma_f32_32x32x16_bf16 v[32:47], v[136:139], v[16:19], v[104:119]
    v_exp_f32 v48, v48
    v_exp_f32 v49, v49
    v_exp_f32 v50, v50
    v_exp_f32 v51, v51
    v_mfma_f32_32x32x16_bf16 v[72:87], v[160:163], v[68:71], v[72:87]
    v_exp_f32 v52, v52
    v_exp_f32 v53, v53
    v_exp_f32 v54, v54
    v_exp_f32 v55, v55
    v_mfma_f32_32x32x8_bf16 v[32:47], v[140:141], v[20:21], v[32:47]
    v_cvt_pk_bf16_f32 v64, v48, v49
    v_cvt_pk_bf16_f32 v65, v50, v51
    v_cvt_pk_bf16_f32 v66, v52, v53
    v_cvt_pk_bf16_f32 v67, v54, v55
    v_exp_f32 v56, v56
    v_exp_f32 v57, v57
    v_exp_f32 v58, v58
    v_exp_f32 v59, v59
    v_mfma_f32_32x32x16_bf16 v[88:103], v[156:159], v[64:67], v[88:103]
    v_exp_f32 v60, v60
    v_exp_f32 v61, v61
    v_exp_f32 v62, v62
    v_exp_f32 v63, v63
    v_cvt_pk_bf16_f32 v68, v56, v57
    v_cvt_pk_bf16_f32 v69, v58, v59
    v_cvt_pk_bf16_f32 v70, v60, v61
    v_cvt_pk_bf16_f32 v71, v62, v63
    s_setprio 1
    v_mfma_f32_32x32x16_bf16 v[48:63], v[136:139], v[22:25], v[120:135]
    v_exp_f32 v32, v32
    v_exp_f32 v33, v33
    v_exp_f32 v34, v34
    v_exp_f32 v35, v35
    v_mfma_f32_32x32x16_bf16 v[88:103], v[160:163], v[68:71], v[88:103]
    ds_read_b128 v[142:145], v4 offset:33792
    ds_read_b64 v[146:147], v6 offset:33792
    v_exp_f32 v36, v36
    v_exp_f32 v37, v37
    v_exp_f32 v38, v38
    v_exp_f32 v39, v39
    v_mfma_f32_32x32x8_bf16 v[48:63], v[140:141], v[26:27], v[48:63]
    ds_read_b128 v[156:159], v5 offset:34816
    v_cvt_pk_bf16_f32 v64, v32, v33
    v_cvt_pk_bf16_f32 v65, v34, v35
    v_cvt_pk_bf16_f32 v66, v36, v37
    v_cvt_pk_bf16_f32 v67, v38, v39
    v_exp_f32 v40, v40
    v_exp_f32 v41, v41
    v_exp_f32 v42, v42
    v_exp_f32 v43, v43
    v_mfma_f32_32x32x16_bf16 v[72:87], v[148:151], v[64:67], v[72:87]
    ds_read_b128 v[160:163], v4 offset:35840
    v_exp_f32 v44, v44
    v_exp_f32 v45, v45
    v_exp_f32 v46, v46
    v_exp_f32 v47, v47
    v_cvt_pk_bf16_f32 v68, v40, v41
    v_cvt_pk_bf16_f32 v69, v42, v43
    v_cvt_pk_bf16_f32 v70, v44, v45
    v_cvt_pk_bf16_f32 v71, v46, v47
    s_setprio 0
    s_waitcnt lgkmcnt(0)
    v_mfma_f32_32x32x16_bf16 v[32:47], v[142:145], v[16:19], v[104:119]
    v_exp_f32 v48, v48
    v_exp_f32 v49, v49
    v_exp_f32 v50, v50
    v_exp_f32 v51, v51
    v_mfma_f32_32x32x16_bf16 v[72:87], v[152:155], v[68:71], v[72:87]
    v_exp_f32 v52, v52
    v_exp_f32 v53, v53
    v_exp_f32 v54, v54
    v_exp_f32 v55, v55
    v_mfma_f32_32x32x8_bf16 v[32:47], v[146:147], v[20:21], v[32:47]
    v_cvt_pk_bf16_f32 v64, v48, v49
    v_cvt_pk_bf16_f32 v65, v50, v51
    v_cvt_pk_bf16_f32 v66, v52, v53
    v_cvt_pk_bf16_f32 v67, v54, v55
    v_exp_f32 v56, v56
    v_exp_f32 v57, v57
    v_exp_f32 v58, v58
    v_exp_f32 v59, v59
    v_mfma_f32_32x32x16_bf16 v[88:103], v[148:151], v[64:67], v[88:103]
    v_exp_f32 v60, v60
    v_exp_f32 v61, v61
    v_exp_f32 v62, v62
    v_exp_f32 v63, v63
    v_cvt_pk_bf16_f32 v68, v56, v57
    v_cvt_pk_bf16_f32 v69, v58, v59
    v_cvt_pk_bf16_f32 v70, v60, v61
    v_cvt_pk_bf16_f32 v71, v62, v63
    s_setprio 1
    v_mfma_f32_32x32x16_bf16 v[48:63], v[142:145], v[22:25], v[120:135]
    v_exp_f32 v32, v32
    v_exp_f32 v33, v33
    v_exp_f32 v34, v34
    v_exp_f32 v35, v35
    v_mfma_f32_32x32x16_bf16 v[88:103], v[152:155], v[68:71], v[88:103]
    v_exp_f32 v36, v36
    v_exp_f32 v37, v37
    v_exp_f32 v38, v38
    v_exp_f32 v39, v39
    v_mfma_f32_32x32x8_bf16 v[48:63], v[146:147], v[26:27], v[48:63]
    v_cvt_pk_bf16_f32 v64, v32, v33
    v_cvt_pk_bf16_f32 v65, v34, v35
    v_cvt_pk_bf16_f32 v66, v36, v37
    v_cvt_pk_bf16_f32 v67, v38, v39
    v_exp_f32 v40, v40
    v_exp_f32 v41, v41
    v_exp_f32 v42, v42
    v_exp_f32 v43, v43
    v_mfma_f32_32x32x16_bf16 v[72:87], v[156:159], v[64:67], v[72:87]
    v_exp_f32 v44, v44
    v_exp_f32 v45, v45
    v_exp_f32 v46, v46
    v_exp_f32 v47, v47
    v_cvt_pk_bf16_f32 v68, v40, v41
    v_cvt_pk_bf16_f32 v69, v42, v43
    v_cvt_pk_bf16_f32 v70, v44, v45
    v_cvt_pk_bf16_f32 v71, v46, v47
    s_setprio 0
    v_exp_f32 v48, v48
    v_exp_f32 v49, v49
    v_exp_f32 v50, v50
    v_exp_f32 v51, v51
    v_mfma_f32_32x32x16_bf16 v[72:87], v[160:163], v[68:71], v[72:87]
    v_exp_f32 v52, v52
    v_exp_f32 v53, v53
    v_exp_f32 v54, v54
    v_exp_f32 v55, v55
    s_nop 0
    v_cvt_pk_bf16_f32 v64, v48, v49
    v_cvt_pk_bf16_f32 v65, v50, v51
    v_cvt_pk_bf16_f32 v66, v52, v53
    v_cvt_pk_bf16_f32 v67, v54, v55
    v_exp_f32 v56, v56
    v_exp_f32 v57, v57
    v_exp_f32 v58, v58
    v_exp_f32 v59, v59
    v_mfma_f32_32x32x16_bf16 v[88:103], v[156:159], v[64:67], v[88:103]
    v_exp_f32 v60, v60
    v_exp_f32 v61, v61
    v_exp_f32 v62, v62
    v_exp_f32 v63, v63
    v_cvt_pk_bf16_f32 v68, v56, v57
    v_cvt_pk_bf16_f32 v69, v58, v59
    v_cvt_pk_bf16_f32 v70, v60, v61
    v_cvt_pk_bf16_f32 v71, v62, v63
    s_nop 0
    v_mfma_f32_32x32x16_bf16 v[88:103], v[160:163], v[68:71], v[88:103]
    s_branch L_att_done
L_att_young:
    s_setprio 1
    v_mfma_f32_32x32x16_bf16 v[48:63], v[136:139], v[22:25], v[120:135]
    v_exp_f32 v32, v32
    v_exp_f32 v33, v33
    v_exp_f32 v34, v34
    v_exp_f32 v35, v35
    ds_read_b128 v[142:145], v28 offset:3072
    ds_read_b64 v[146:147], v30 offset:3072
    v_exp_f32 v36, v36
    v_exp_f32 v37, v37
    v_exp_f32 v38, v38
    v_exp_f32 v39, v39
    v_mfma_f32_32x32x8_bf16 v[48:63], v[140:141], v[26:27], v[48:63]
    ds_read_b128 v[156:159], v29 offset:4096
    v_cvt_pk_bf16_f32 v64, v32, v33
    v_cvt_pk_bf16_f32 v65, v34, v35
    v_cvt_pk_bf16_f32 v66, v36, v37
    v_cvt_pk_bf16_f32 v67, v38, v39
    v_exp_f32 v40, v40
    v_exp_f32 v41, v41
    v_exp_f32 v42, v42
    v_exp_f32 v43, v43
    v_mfma_f32_32x32x16_bf16 v[72:87], v[148:151], v[64:67], 0
    ds_read_b128 v[160:163], v28 offset:5120
    v_exp_f32 v44, v44
    v_exp_f32 v45, v45
    v_exp_f32 v46, v46
    v_exp_f32 v47, v47
    v_cvt_pk_bf16_f32 v68, v40, v41
    v_cvt_pk_bf16_f32 v69, v42, v43
    v_cvt_pk_bf16_f32 v70, v44, v45
    v_cvt_pk_bf16_f32 v71, v46, v47
    s_setprio 0
    s_waitcnt lgkmcnt(0)
    v_mfma_f32_32x32x16_bf16 v[32:47], v[142:145], v[16:19], v[104:119]
    v_exp_f32 v48, v48
    v_exp_f32 v49, v49
    v_exp_f32 v50, v50
    v_exp_f32 v51, v51
    v_mfma_f32_32x32x16_bf16 v[72:87], v[152:155], v[68:71], v[72:87]
    v_exp_f32 v52, v52
    v_exp_f32 v53, v53
    v_exp_f32 v54, v54
    v_exp_f32 v55, v55
    v_mfma_f32_32x32x8_bf16 v[32:47], v[146:147], v[20:21], v[32:47]
    v_cvt_pk_bf16_f32 v64, v48, v49
    v_cvt_pk_bf16_f32 v65, v50, v51
    v_cvt_pk_bf16_f32 v66, v52, v53
    v_cvt_pk_bf16_f32 v67, v54, v55
    v_exp_f32 v56, v56
    v_exp_f32 v57, v57
    v_exp_f32 v58, v58
    v_exp_f32 v59, v59
    v_mfma_f32_32x32x16_bf16 v[88:103], v[148:151], v[64:67], 0
    v_exp_f32 v60, v60
    v_exp_f32 v61, v61
    v_exp_f32 v62, v62
    v_exp_f32 v63, v63
    v_cvt_pk_bf16_f32 v68, v56, v57
    v_cvt_pk_bf16_f32 v69, v58, v59
    v_cvt_pk_bf16_f32 v70, v60, v61
    v_cvt_pk_bf16_f32 v71, v62, v63
    s_setprio 1
    v_mfma_f32_32x32x16_bf16 v[48:63], v[142:145], v[22:25], v[120:135]
    v_exp_f32 v32, v32
    v_exp_f32 v33, v33
    v_exp_f32 v34, v34
    v_exp_f32 v35, v35
    v_mfma_f32_32x32x16_bf16 v[88:103], v[152:155], v[68:71], v[88:103]
    ds_read_b128 v[136:139], v28 offset:6144
    ds_read_b64 v[140:141], v30 offset:6144
    v_exp_f32 v36, v36
    v_exp_f32 v37, v37
    v_exp_f32 v38, v38
    v_exp_f32 v39, v39
    v_mfma_f32_32x32x8_bf16 v[48:63], v[146:147], v[26:27], v[48:63]
    ds_read_b128 v[148:151], v29 offset:7168
    v_cvt_pk_bf16_f32 v64, v32, v33
    v_cvt_pk_bf16_f32 v65, v34, v35
    v_cvt_pk_bf16_f32 v66, v36, v37
    v_cvt_pk_bf16_f32 v67, v38, v39
    v_exp_f32 v40, v40
    v_exp_f32 v41, v41
    v_exp_f32 v42, v42
    v_exp_f32 v43, v43
    v_mfma_f32_32x32x16_bf16 v[72:87], v[156:159], v[64:67], v[72:87]
    ds_read_b128 v[152:155], v28 offset:8192
    v_exp_f32 v44, v44
    v_exp_f32 v45, v45
    v_exp_f32 v46, v46
    v_exp_f32 v47, v47
    v_cvt_pk_bf16_f32 v68, v40, v41
    v_cvt_pk_bf16_f32 v69, v42, v43
    v_cvt_pk_bf16_f32 v70, v44, v45
    v_cvt_pk_bf16_f32 v71, v46, v47
    s_setprio 0
    s_waitcnt lgkmcnt(0)
    v_mfma_f32_32x32x16_bf16 v[32:47], v[136:139], v[16:19], v[104:119]
    v_exp_f32 v48, v48
    v_exp_f32 v49, v49
    v_exp_f32 v50, v50
    v_exp_f32 v51, v51
    v_mfma_f32_32x32x16_bf16 v[72:87], v[160:163], v[68:71], v[72:87]
    v_exp_f32 v52, v52
    v_exp_f32 v53, v53
    v_exp_f32 v54, v54
    v_exp_f32 v55, v55
    v_mfma_f32_32x32x8_bf16 v[32:47], v[140:141], v[20:21], v[32:47]
    v_cvt_pk_bf16_f32 v64, v48, v49
    v_cvt_pk_bf16_f32 v65, v50, v51
    v_cvt_pk_bf16_f32 v66, v52, v53
    v_cvt_pk_bf16_f32 v67, v54, v55
    v_exp_f32 v56, v56
    v_exp_f32 v57, v57
    v_exp_f32 v58, v58
    v_exp_f32 v59, v59
    v_mfma_f32_32x32x16_bf16 v[88:103], v[156:159], v[64:67], v[88:103]
    v_exp_f32 v60, v60
    v_exp_f32 v61, v61
    v_exp_f32 v62, v62
    v_exp_f32 v63, v63
    v_cvt_pk_bf16_f32 v68, v56, v57
    v_cvt_pk_bf16_f32 v69, v58, v59
    v_cvt_pk_bf16_f32 v70, v60, v61
    v_cvt_pk_bf16_f32 v71, v62, v63
    s_setprio 1
    v_mfma_f32_32x32x16_bf16 v[48:63], v[136:139], v[22:25], v[120:135]
    v_exp_f32 v32, v32
    v_exp_f32 v33, v33
    v_exp_f32 v34, v34
    v_exp_f32 v35, v35
    v_mfma_f32_32x32x16_bf16 v[88:103], v[160:163], v[68:71], v[88:103]
    ds_read_b128 v[142:145], v28 offset:9216
    ds_read_b64 v[146:147], v30 offset:9216
    v_exp_f32 v36, v36
    v_exp_f32 v37, v37
    v_exp_f32 v38, v38
    v_exp_f32 v39, v39
    v_mfma_f32_32x32x8_bf16 v[48:63], v[140:141], v[26:27], v[48:63]
    ds_read_b128 v[156:159], v29 offset:10240
    v_cvt_pk_bf16_f32 v64, v32, v33
    v_cvt_pk_bf16_f32 v65, v34, v35
    v_cvt_pk_bf16_f32 v66, v36, v37
    v_cvt_pk_bf16_f32 v67, v38, v39
    v_exp_f32 v40, v40
    v_exp_f32 v41, v41
    v_exp_f32 v42, v42
    v_exp_f32 v43, v43
    v_mfma_f32_32x32x16_bf16 v[72:87], v[148:151], v[64:67], v[72:87]
    ds_read_b128 v[160:163], v28 offset:11264
    v_exp_f32 v44, v44
    v_exp_f32 v45, v45
    v_exp_f32 v46, v46
    v_exp_f32 v47, v47
    v_cvt_pk_bf16_f32 v68, v40, v41
    v_cvt_pk_bf16_f32 v69, v42, v43
    v_cvt_pk_bf16_f32 v70, v44, v45
    v_cvt_pk_bf16_f32 v71, v46, v47
    s_setprio 0
    s_waitcnt lgkmcnt(0)
    v_mfma_f32_32x32x16_bf16 v[32:47], v[142:145], v[16:19], v[104:119]
    v_exp_f32 v48, v48
    v_exp_f32 v49, v49
    v_exp_f32 v50, v50
    v_exp_f32 v51, v51
    v_mfma_f32_32x32x16_bf16 v[72:87], v[152:155], v[68:71], v[72:87]
    v_exp_f32 v52, v52
    v_exp_f32 v53, v53
    v_exp_f32 v54, v54
    v_exp_f32 v55, v55
    v_mfma_f32_32x32x8_bf16 v[32:47], v[146:147], v[20:21], v[32:47]
    v_cvt_pk_bf16_f32 v64, v48, v49
    v_cvt_pk_bf16_f32 v65, v50, v51
    v_cvt_pk_bf16_f32 v66, v52, v53
    v_cvt_pk_bf16_f32 v67, v54, v55
    v_exp_f32 v56, v56
    v_exp_f32 v57, v57
    v_exp_f32 v58, v58
    v_exp_f32 v59, v59
    v_mfma_f32_32x32x16_bf16 v[88:103], v[148:151], v[64:67], v[88:103]
    v_exp_f32 v60, v60
    v_exp_f32 v61, v61
    v_exp_f32 v62, v62
    v_exp_f32 v63, v63
    v_cvt_pk_bf16_f32 v68, v56, v57
    v_cvt_pk_bf16_f32 v69, v58, v59
    v_cvt_pk_bf16_f32 v70, v60, v61
    v_cvt_pk_bf16_f32 v71, v62, v63
    s_setprio 1
    v_mfma_f32_32x32x16_bf16 v[48:63], v[142:145], v[22:25], v[120:135]
    v_exp_f32 v32, v32
    v_exp_f32 v33, v33
    v_exp_f32 v34, v34
    v_exp_f32 v35, v35
    v_mfma_f32_32x32x16_bf16 v[88:103], v[152:155], v[68:71], v[88:103]
    s_barrier
    ds_read_b128 v[136:139], v4 offset:0
    ds_read_b64 v[140:141], v6 offset:0
    v_exp_f32 v36, v36
    v_exp_f32 v37, v37
    v_exp_f32 v38, v38
    v_exp_f32 v39, v39
    v_mfma_f32_32x32x8_bf16 v[48:63], v[146:147], v[26:27], v[48:63]
    ds_read_b128 v[148:151], v5 offset:1024
    v_cvt_pk_bf16_f32 v64, v32, v33
    v_cvt_pk_bf16_f32 v65, v34, v35
    v_cvt_pk_bf16_f32 v66, v36, v37
    v_cvt_pk_bf16_f32 v67, v38, v39
    v_exp_f32 v40, v40
    v_exp_f32 v41, v41
    v_exp_f32 v42, v42
    v_exp_f32 v43, v43
    v_mfma_f32_32x32x16_bf16 v[72:87], v[156:159], v[64:67], v[72:87]
    ds_read_b128 v[152:155], v4 offset:2048
    v_exp_f32 v44, v44
    v_exp_f32 v45, v45
    v_exp_f32 v46, v46
    v_exp_f32 v47, v47
    v_cvt_pk_bf16_f32 v68, v40, v41
    v_cvt_pk_bf16_f32 v69, v42, v43
    v_cvt_pk_bf16_f32 v70, v44, v45
    v_cvt_pk_bf16_f32 v71, v46, v47
    s_setprio 0
    s_waitcnt lgkmcnt(0)
    v_mfma_f32_32x32x16_bf16 v[32:47], v[136:139], v[16:19], v[104:119]
    v_exp_f32 v48, v48
    v_exp_f32 v49, v49
    v_exp_f32 v50, v50
    v_exp_f32 v51, v51
    v_mfma_f32_32x32x16_bf16 v[72:87], v[160:163], v[68:71], v[72:87]
    s_lshl_b32 s60, s2, 2
    s_add_u32 s60, s60, s29
    s_mul_i32 s61, s60, 1920
    v_lshlrev_b32 v10, 7, v2
    v_add_u32 v15, s61, v10
    s_mul_i32 s61, s60, 800
    v_add_u32 v14, s61, v10
    v_and_b32 v14, 0xffffff80, v14
    v_exp_f32 v52, v52
    v_exp_f32 v53, v53
    v_exp_f32 v54, v54
    v_exp_f32 v55, v55
    v_mfma_f32_32x32x8_bf16 v[32:47], v[140:141], v[20:21], v[32:47]
    v_cvt_pk_bf16_f32 v64, v48, v49
    v_cvt_pk_bf16_f32 v65, v50, v51
    v_cvt_pk_bf16_f32 v66, v52, v53
    v_cvt_pk_bf16_f32 v67, v54, v55
    v_exp_f32 v56, v56
    v_exp_f32 v57, v57
    v_exp_f32 v58, v58
    v_exp_f32 v59, v59
    v_mfma_f32_32x32x16_bf16 v[88:103], v[156:159], v[64:67], v[88:103]
    s_mov_b64 exec, 0x7fff
    global_load_dword v194, v15, s[48:49]
    global_load_dword v195, v15, s[50:51]
    global_load_dword v196, v15, s[52:53]
    s_mov_b64 exec, 0x7f
    global_load_dword v197, v14, s[44:45]
    s_mov_b64 exec, -1
    v_exp_f32 v60, v60
    v_exp_f32 v61, v61
    v_exp_f32 v62, v62
    v_exp_f32 v63, v63
    v_cvt_pk_bf16_f32 v68, v56, v57
    v_cvt_pk_bf16_f32 v69, v58, v59
    v_cvt_pk_bf16_f32 v70, v60, v61
    v_cvt_pk_bf16_f32 v71, v62, v63
    s_setprio 1
    v_mfma_f32_32x32x16_bf16 v[48:63], v[136:139], v[22:25], v[120:135]
    v_exp_f32 v32, v32
    v_exp_f32 v33, v33
    v_exp_f32 v34, v34
    v_exp_f32 v35, v35
    v_mfma_f32_32x32x16_bf16 v[88:103], v[160:163], v[68:71], v[88:103]
    ds_read_b128 v[142:145], v4 offset:3072
    ds_read_b64 v[146:147], v6 offset:3072
    v_exp_f32 v36, v36
    v_exp_f32 v37, v37
    v_exp_f32 v38, v38
    v_exp_f32 v39, v39
    v_mfma_f32_32x32x8_bf16 v[48:63], v[140:141], v[26:27], v[48:63]
    ds_read_b128 v[156:159], v5 offset:4096
    v_cvt_pk_bf16_f32 v64, v32, v33
    v_cvt_pk_bf16_f32 v65, v34, v35
    v_cvt_pk_bf16_f32 v66, v36, v37
    v_cvt_pk_bf16_f32 v67, v38, v39
    v_exp_f32 v40, v40
    v_exp_f32 v41, v41
    v_exp_f32 v42, v42
    v_exp_f32 v43, v43
    v_mfma_f32_32x32x16_bf16 v[72:87], v[148:151], v[64:67], v[72:87]
    ds_read_b128 v[160:163], v4 offset:5120
    v_exp_f32 v44, v44
    v_exp_f32 v45, v45
    v_exp_f32 v46, v46
    v_exp_f32 v47, v47
    v_cvt_pk_bf16_f32 v68, v40, v41
    v_cvt_pk_bf16_f32 v69, v42, v43
    v_cvt_pk_bf16_f32 v70, v44, v45
    v_cvt_pk_bf16_f32 v71, v46, v47
    s_setprio 0
    s_waitcnt lgkmcnt(0)
    v_mfma_f32_32x32x16_bf16 v[32:47], v[142:145], v[16:19], v[104:119]
    v_exp_f32 v48, v48
    v_exp_f32 v49, v49
    v_exp_f32 v50, v50
    v_exp_f32 v51, v51
    v_mfma_f32_32x32x16_bf16 v[72:87], v[152:155], v[68:71], v[72:87]
    v_exp_f32 v52, v52
    v_exp_f32 v53, v53
    v_exp_f32 v54, v54
    v_exp_f32 v55, v55
    v_mfma_f32_32x32x8_bf16 v[32:47], v[146:147], v[20:21], v[32:47]
    v_cvt_pk_bf16_f32 v64, v48, v49
    v_cvt_pk_bf16_f32 v65, v50, v51
    v_cvt_pk_bf16_f32 v66, v52, v53
    v_cvt_pk_bf16_f32 v67, v54, v55
    v_exp_f32 v56, v56
    v_exp_f32 v57, v57
    v_exp_f32 v58, v58
    v_exp_f32 v59, v59
    v_mfma_f32_32x32x16_bf16 v[88:103], v[148:151], v[64:67], v[88:103]
    v_exp_f32 v60, v60
    v_exp_f32 v61, v61
    v_exp_f32 v62, v62
    v_exp_f32 v63, v63
    v_cvt_pk_bf16_f32 v68, v56, v57
    v_cvt_pk_bf16_f32 v69, v58, v59
    v_cvt_pk_bf16_f32 v70, v60, v61
    v_cvt_pk_bf16_f32 v71, v62, v63
    s_setprio 1
    v_mfma_f32_32x32x16_bf16 v[48:63], v[142:145], v[22:25], v[120:135]
    v_exp_f32 v32, v32
    v_exp_f32 v33, v33
    v_exp_f32 v34, v34
    v_exp_f32 v35, v35
    v_mfma_f32_32x32x16_bf16 v[88:103], v[152:155], v[68:71], v[88:103]
    ds_read_b128 v[136:139], v4 offset:6144
    ds_read_b64 v[140:141], v6 offset:6144
    v_exp_f32 v36, v36
    v_exp_f32 v37, v37
    v_exp_f32 v38, v38
    v_exp_f32 v39, v39
    v_mfma_f32_32x32x8_bf16 v[48:63], v[146:147], v[26:27], v[48:63]
    ds_read_b128 v[148:151], v5 offset:7168
    v_cvt_pk_bf16_f32 v64, v32, v33
    v_cvt_pk_bf16_f32 v65, v34, v35
    v_cvt_pk_bf16_f32 v66, v36, v37
    v_cvt_pk_bf16_f32 v67, v38, v39
    v_exp_f32 v40, v40
    v_exp_f32 v41, v41
    v_exp_f32 v42, v42
    v_exp_f32 v43, v43
    v_mfma_f32_32x32x16_bf16 v[72:87], v[156:159], v[64:67], v[72:87]
    ds_read_b128 v[152:155], v4 offset:8192
    v_exp_f32 v44, v44
    v_exp_f32 v45, v45
    v_exp_f32 v46, v46
    v_exp_f32 v47, v47
    v_cvt_pk_bf16_f32 v68, v40, v41
    v_cvt_pk_bf16_f32 v69, v42, v43
    v_cvt_pk_bf16_f32 v70, v44, v45
    v_cvt_pk_bf16_f32 v71, v46, v47
    s_setprio 0
    s_waitcnt lgkmcnt(0)
    v_mfma_f32_32x32x16_bf16 v[32:47], v[136:139], v[16:19], v[104:119]
    v_exp_f32 v48, v48
    v_exp_f32 v49, v49
    v_exp_f32 v50, v50
    v_exp_f32 v51, v51
    v_mfma_f32_32x32x16_bf16 v[72:87], v[160:163], v[68:71], v[72:87]
    v_exp_f32 v52, v52
    v_exp_f32 v53, v53
    v_exp_f32 v54, v54
    v_exp_f32 v55, v55
    v_mfma_f32_32x32x8_bf16 v[32:47], v[140:141], v[20:21], v[32:47]
    v_cvt_pk_bf16_f32 v64, v48, v49
    v_cvt_pk_bf16_f32 v65, v50, v51
    v_cvt_pk_bf16_f32 v66, v52, v53
    v_cvt_pk_bf16_f32 v67, v54, v55
    v_exp_f32 v56, v56
    v_exp_f32 v57, v57
    v_exp_f32 v58, v58
    v_exp_f32 v59, v59
    v_mfma_f32_32x32x16_bf16 v[88:103], v[156:159], v[64:67], v[88:103]
    v_exp_f32 v60, v60
    v_exp_f32 v61, v61
    v_exp_f32 v62, v62
    v_exp_f32 v63, v63
    v_cvt_pk_bf16_f32 v68, v56, v57
    v_cvt_pk_bf16_f32 v69, v58, v59
    v_cvt_pk_bf16_f32 v70, v60, v61
    v_cvt_pk_bf16_f32 v71, v62, v63
    s_setprio 1
    v_mfma_f32_32x32x16_bf16 v[48:63], v[136:139], v[22:25], v[120:135]
    v_exp_f32 v32, v32
    v_exp_f32 v33, v33
    v_exp_f32 v34, v34
    v_exp_f32 v35, v35
    v_mfma_f32_32x32x16_bf16 v[88:103], v[160:163], v[68:71], v[88:103]
    ds_read_b128 v[142:145], v4 offset:9216
    ds_read_b64 v[146:147], v6 offset:9216
    v_exp_f32 v36, v36
    v_exp_f32 v37, v37
    v_exp_f32 v38, v38
    v_exp_f32 v39, v39
    v_mfma_f32_32x32x8_bf16 v[48:63], v[140:141], v[26:27], v[48:63]
    ds_read_b128 v[156:159], v5 offset:10240
    v_cvt_pk_bf16_f32 v64, v32, v33
    v_cvt_pk_bf16_f32 v65, v34, v35
    v_cvt_pk_bf16_f32 v66, v36, v37
    v_cvt_pk_bf16_f32 v67, v38, v39
    v_exp_f32 v40, v40
    v_exp_f32 v41, v41
    v_exp_f32 v42, v42
    v_exp_f32 v43, v43
    v_mfma_f32_32x32x16_bf16 v[72:87], v[148:151], v[64:67], v[72:87]
    ds_read_b128 v[160:163], v4 offset:11264
    v_exp_f32 v44, v44
    v_exp_f32 v45, v45
    v_exp_f32 v46, v46
    v_exp_f32 v47, v47
    v_cvt_pk_bf16_f32 v68, v40, v41
    v_cvt_pk_bf16_f32 v69, v42, v43
    v_cvt_pk_bf16_f32 v70, v44, v45
    v_cvt_pk_bf16_f32 v71, v46, v47
    s_setprio 0
    s_waitcnt lgkmcnt(0)
    v_mfma_f32_32x32x16_bf16 v[32:47], v[142:145], v[16:19], v[104:119]
    v_exp_f32 v48, v48
    v_exp_f32 v49, v49
    v_exp_f32 v50, v50
    v_exp_f32 v51, v51
    v_mfma_f32_32x32x16_bf16 v[72:87], v[152:155], v[68:71], v[72:87]
    v_exp_f32 v52, v52
    v_exp_f32 v53, v53
    v_exp_f32 v54, v54
    v_exp_f32 v55, v55
    v_mfma_f32_32x32x8_bf16 v[32:47], v[146:147], v[20:21], v[32:47]
    v_cvt_pk_bf16_f32 v64, v48, v49
    v_cvt_pk_bf16_f32 v65, v50, v51
    v_cvt_pk_bf16_f32 v66, v52, v53
    v_cvt_pk_bf16_f32 v67, v54, v55
    v_exp_f32 v56, v56
    v_exp_f32 v57, v57
    v_exp_f32 v58, v58
    v_exp_f32 v59, v59
    v_mfma_f32_32x32x16_bf16 v[88:103], v[148:151], v[64:67], v[88:103]
    v_exp_f32 v60, v60
    v_exp_f32 v61, v61
    v_exp_f32 v62, v62
    v_exp_f32 v63, v63
    v_cvt_pk_bf16_f32 v68, v56, v57
    v_cvt_pk_bf16_f32 v69, v58, v59
    v_cvt_pk_bf16_f32 v70, v60, v61
    v_cvt_pk_bf16_f32 v71, v62, v63
    s_setprio 1
    v_mfma_f32_32x32x16_bf16 v[48:63], v[142:145], v[22:25], v[120:135]
    v_exp_f32 v32, v32
    v_exp_f32 v33, v33
    v_exp_f32 v34, v34
    v_exp_f32 v35, v35
    v_mfma_f32_32x32x16_bf16 v[88:103], v[152:155], v[68:71], v[88:103]
    s_barrier
    ds_read_b128 v[136:139], v4 offset:24576
    ds_read_b64 v[140:141], v6 offset:24576
    v_exp_f32 v36, v36
    v_exp_f32 v37, v37
    v_exp_f32 v38, v38
    v_exp_f32 v39, v39
    v_mfma_f32_32x32x8_bf16 v[48:63], v[146:147], v[26:27], v[48:63]
    ds_read_b128 v[148:151], v5 offset:25600
    v_cvt_pk_bf16_f32 v64, v32, v33
    v_cvt_pk_bf16_f32 v65, v34, v35
    v_cvt_pk_bf16_f32 v66, v36, v37
    v_cvt_pk_bf16_f32 v67, v38, v39
    v_exp_f32 v40, v40
    v_exp_f32 v41, v41
    v_exp_f32 v42, v42
    v_exp_f32 v43, v43
    v_mfma_f32_32x32x16_bf16 v[72:87], v[156:159], v[64:67], v[72:87]
    ds_read_b128 v[152:155], v4 offset:26624
    v_exp_f32 v44, v44
    v_exp_f32 v45, v45
    v_exp_f32 v46, v46
    v_exp_f32 v47, v47
    v_cvt_pk_bf16_f32 v68, v40, v41
    v_cvt_pk_bf16_f32 v69, v42, v43
    v_cvt_pk_bf16_f32 v70, v44, v45
    v_cvt_pk_bf16_f32 v71, v46, v47
    s_setprio 0
    s_waitcnt lgkmcnt(0)
    v_mfma_f32_32x32x16_bf16 v[32:47], v[136:139], v[16:19], v[104:119]
    v_exp_f32 v48, v48
    v_exp_f32 v49, v49
    v_exp_f32 v50, v50
    v_exp_f32 v51, v51
    v_mfma_f32_32x32x16_bf16 v[72:87], v[160:163], v[68:71], v[72:87]
    v_exp_f32 v52, v52
    v_exp_f32 v53, v53
    v_exp_f32 v54, v54
    v_exp_f32 v55, v55
    v_mfma_f32_32x32x8_bf16 v[32:47], v[140:141], v[20:21], v[32:47]
    v_cvt_pk_bf16_f32 v64, v48, v49
    v_cvt_pk_bf16_f32 v65, v50, v51
    v_cvt_pk_bf16_f32 v66, v52, v53
    v_cvt_pk_bf16_f32 v67, v54, v55
    v_exp_f32 v56, v56
    v_exp_f32 v57, v57
    v_exp_f32 v58, v58
    v_exp_f32 v59, v59
    v_mfma_f32_32x32x16_bf16 v[88:103], v[156:159], v[64:67], v[88:103]
    v_exp_f32 v60, v60
    v_exp_f32 v61, v61
    v_exp_f32 v62, v62
    v_exp_f32 v63, v63
    v_cvt_pk_bf16_f32 v68, v56, v57
    v_cvt_pk_bf16_f32 v69, v58, v59
    v_cvt_pk_bf16_f32 v70, v60, v61
    v_cvt_pk_bf16_f32 v71, v62, v63
    s_setprio 1
    v_mfma_f32_32x32x16_bf16 v[48:63], v[136:139], v[22:25], v[120:135]
    v_exp_f32 v32, v32
    v_exp_f32 v33, v33
    v_exp_f32 v34, v34
    v_exp_f32 v35, v35
    v_mfma_f32_32x32x16_bf16 v[88:103], v[160:163], v[68:71], v[88:103]
    ds_read_b128 v[142:145], v4 offset:27648
    ds_read_b64 v[146:147], v6 offset:27648
    v_exp_f32 v36, v36
    v_exp_f32 v37, v37
    v_exp_f32 v38, v38
    v_exp_f32 v39, v39
    v_mfma_f32_32x32x8_bf16 v[48:63], v[140:141], v[26:27], v[48:63]
    ds_read_b128 v[156:159], v5 offset:28672
    v_cvt_pk_bf16_f32 v64, v32, v33
    v_cvt_pk_bf16_f32 v65, v34, v35
    v_cvt_pk_bf16_f32 v66, v36, v37
    v_cvt_pk_bf16_f32 v67, v38, v39
    v_exp_f32 v40, v40
    v_exp_f32 v41, v41
    v_exp_f32 v42, v42
    v_exp_f32 v43, v43
    v_mfma_f32_32x32x16_bf16 v[72:87], v[148:151], v[64:67], v[72:87]
    ds_read_b128 v[160:163], v4 offset:29696
    v_exp_f32 v44, v44
    v_exp_f32 v45, v45
    v_exp_f32 v46, v46
    v_exp_f32 v47, v47
    v_cvt_pk_bf16_f32 v68, v40, v41
    v_cvt_pk_bf16_f32 v69, v42, v43
    v_cvt_pk_bf16_f32 v70, v44, v45
    v_cvt_pk_bf16_f32 v71, v46, v47
    s_setprio 0
    s_waitcnt lgkmcnt(0)
    v_mfma_f32_32x32x16_bf16 v[32:47], v[142:145], v[16:19], v[104:119]
    v_exp_f32 v48, v48
    v_exp_f32 v49, v49
    v_exp_f32 v50, v50
    v_exp_f32 v51, v51
    v_mfma_f32_32x32x16_bf16 v[72:87], v[152:155], v[68:71], v[72:87]
    s_add_u32 m0, s34, 0
    s_add_u32 s61, s82, s87
    buffer_load_dwordx4 v12, s[16:19], s82 offen lds
    v_exp_f32 v52, v52
    v_exp_f32 v53, v53
    v_exp_f32 v54, v54
    v_exp_f32 v55, v55
    v_mfma_f32_32x32x8_bf16 v[32:47], v[146:147], v[20:21], v[32:47]
    s_add_u32 m0, s34, 1024
    s_nop 0
    buffer_load_dwordx4 v12, s[16:19], s61 offen lds
    v_cvt_pk_bf16_f32 v64, v48, v49
    v_cvt_pk_bf16_f32 v65, v50, v51
    v_cvt_pk_bf16_f32 v66, v52, v53
    v_cvt_pk_bf16_f32 v67, v54, v55
    v_exp_f32 v56, v56
    v_exp_f32 v57, v57
    v_exp_f32 v58, v58
    v_exp_f32 v59, v59
    v_mfma_f32_32x32x16_bf16 v[88:103], v[148:151], v[64:67], v[88:103]
    s_add_u32 m0, s34, 2048
    s_add_u32 s61, s83, s87
    buffer_load_dwordx4 v12, s[16:19], s83 offen lds
    v_exp_f32 v60, v60
    v_exp_f32 v61, v61
    v_exp_f32 v62, v62
    v_exp_f32 v63, v63
    v_cvt_pk_bf16_f32 v68, v56, v57
    v_cvt_pk_bf16_f32 v69, v58, v59
    v_cvt_pk_bf16_f32 v70, v60, v61
    v_cvt_pk_bf16_f32 v71, v62, v63
    s_setprio 1
    v_mfma_f32_32x32x16_bf16 v[48:63], v[142:145], v[22:25], v[120:135]
    v_exp_f32 v32, v32
    v_exp_f32 v33, v33
    v_exp_f32 v34, v34
    v_exp_f32 v35, v35
    v_mfma_f32_32x32x16_bf16 v[88:103], v[152:155], v[68:71], v[88:103]
    ds_read_b128 v[136:139], v4 offset:30720
    ds_read_b64 v[140:141], v6 offset:30720
    s_add_u32 m0, s34, 3072
    s_nop 0
    buffer_load_dwordx4 v12, s[16:19], s61 offen lds
    v_exp_f32 v36, v36
    v_exp_f32 v37, v37
    v_exp_f32 v38, v38
    v_exp_f32 v39, v39
    v_mfma_f32_32x32x8_bf16 v[48:63], v[146:147], v[26:27], v[48:63]
    ds_read_b128 v[148:151], v5 offset:31744
    s_add_u32 m0, s34, 4096
    s_add_u32 s61, s84, s87
    buffer_load_dwordx4 v12, s[16:19], s84 offen lds
    v_cvt_pk_bf16_f32 v64, v32, v33
    v_cvt_pk_bf16_f32 v65, v34, v35
    v_cvt_pk_bf16_f32 v66, v36, v37
    v_cvt_pk_bf16_f32 v67, v38, v39
    v_exp_f32 v40, v40
    v_exp_f32 v41, v41
    v_exp_f32 v42, v42
    v_exp_f32 v43, v43
    v_mfma_f32_32x32x16_bf16 v[72:87], v[156:159], v[64:67], v[72:87]
    ds_read_b128 v[152:155], v4 offset:32768
    s_add_u32 m0, s34, 5120
    s_nop 0
    buffer_load_dwordx4 v12, s[16:19], s61 offen lds
    v_exp_f32 v44, v44
    v_exp_f32 v45, v45
    v_exp_f32 v46, v46
    v_exp_f32 v47, v47
    v_cvt_pk_bf16_f32 v68, v40, v41
    v_cvt_pk_bf16_f32 v69, v42, v43
    v_cvt_pk_bf16_f32 v70, v44, v45
    v_cvt_pk_bf16_f32 v71, v46, v47
    s_setprio 0
    s_waitcnt lgkmcnt(0)
    v_mfma_f32_32x32x16_bf16 v[32:47], v[136:139], v[16:19], v[104:119]
    v_exp_f32 v48, v48
    v_exp_f32 v49, v49
    v_exp_f32 v50, v50
    v_exp_f32 v51, v51
    v_mfma_f32_32x32x16_bf16 v[72:87], v[160:163], v[68:71], v[72:87]
    s_add_u32 m0, s34, 6144
    s_add_u32 s61, s85, s87
    buffer_load_dwordx4 v12, s[16:19], s85 offen lds
    v_exp_f32 v52, v52
    v_exp_f32 v53, v53
    v_exp_f32 v54, v54
    v_exp_f32 v55, v55
    v_mfma_f32_32x32x8_bf16 v[32:47], v[140:141], v[20:21], v[32:47]
    s_add_u32 m0, s34, 7168
    s_nop 0
    buffer_load_dwordx4 v12, s[16:19], s61 offen lds
    v_cvt_pk_bf16_f32 v64, v48, v49
    v_cvt_pk_bf16_f32 v65, v50, v51
    v_cvt_pk_bf16_f32 v66, v52, v53
    v_cvt_pk_bf16_f32 v67, v54, v55
    v_exp_f32 v56, v56
    v_exp_f32 v57, v57
    v_exp_f32 v58, v58
    v_exp_f32 v59, v59
    v_mfma_f32_32x32x16_bf16 v[88:103], v[156:159], v[64:67], v[88:103]
    s_add_u32 m0, s34, 8192
    s_add_u32 s61, s86, s87
    buffer_load_dwordx4 v12, s[16:19], s86 offen lds
    v_exp_f32 v60, v60
    v_exp_f32 v61, v61
    v_exp_f32 v62, v62
    v_exp_f32 v63, v63
    v_cvt_pk_bf16_f32 v68, v56, v57
    v_cvt_pk_bf16_f32 v69, v58, v59
    v_cvt_pk_bf16_f32 v70, v60, v61
    v_cvt_pk_bf16_f32 v71, v62, v63
    s_setprio 1
    v_mfma_f32_32x32x16_bf16 v[48:63], v[136:139], v[22:25], v[120:135]
    v_exp_f32 v32, v32
    v_exp_f32 v33, v33
    v_exp_f32 v34, v34
    v_exp_f32 v35, v35
    v_mfma_f32_32x32x16_bf16 v[88:103], v[160:163], v[68:71], v[88:103]
    ds_read_b128 v[142:145], v4 offset:33792
    ds_read_b64 v[146:147], v6 offset:33792
    s_add_u32 m0, s34, 9216
    s_nop 0
    buffer_load_dwordx4 v12, s[16:19], s61 offen lds
    v_exp_f32 v36, v36
    v_exp_f32 v37, v37
    v_exp_f32 v38, v38
    v_exp_f32 v39, v39
    v_mfma_f32_32x32x8_bf16 v[48:63], v[140:141], v[26:27], v[48:63]
    ds_read_b128 v[156:159], v5 offset:34816
    v_cvt_pk_bf16_f32 v64, v32, v33
    v_cvt_pk_bf16_f32 v65, v34, v35
    v_cvt_pk_bf16_f32 v66, v36, v37
    v_cvt_pk_bf16_f32 v67, v38, v39
    v_exp_f32 v40, v40
    v_exp_f32 v41, v41
    v_exp_f32 v42, v42
    v_exp_f32 v43, v43
    v_mfma_f32_32x32x16_bf16 v[72:87], v[148:151], v[64:67], v[72:87]
    ds_read_b128 v[160:163], v4 offset:35840
    v_exp_f32 v44, v44
    v_exp_f32 v45, v45
    v_exp_f32 v46, v46
    v_exp_f32 v47, v47
    v_cvt_pk_bf16_f32 v68, v40, v41
    v_cvt_pk_bf16_f32 v69, v42, v43
    v_cvt_pk_bf16_f32 v70, v44, v45
    v_cvt_pk_bf16_f32 v71, v46, v47
    s_setprio 0
    s_waitcnt lgkmcnt(0)
    v_mfma_f32_32x32x16_bf16 v[32:47], v[142:145], v[16:19], v[104:119]
    v_exp_f32 v48, v48
    v_exp_f32 v49, v49
    v_exp_f32 v50, v50
    v_exp_f32 v51, v51
    v_mfma_f32_32x32x16_bf16 v[72:87], v[152:155], v[68:71], v[72:87]
    v_exp_f32 v52, v52
    v_exp_f32 v53, v53
    v_exp_f32 v54, v54
    v_exp_f32 v55, v55
    v_mfma_f32_32x32x8_bf16 v[32:47], v[146:147], v[20:21], v[32:47]
    v_cvt_pk_bf16_f32 v64, v48, v49
    v_cvt_pk_bf16_f32 v65, v50, v51
    v_cvt_pk_bf16_f32 v66, v52, v53
    v_cvt_pk_bf16_f32 v67, v54, v55
    v_exp_f32 v56, v56
    v_exp_f32 v57, v57
    v_exp_f32 v58, v58
    v_exp_f32 v59, v59
    v_mfma_f32_32x32x16_bf16 v[88:103], v[148:151], v[64:67], v[88:103]
    v_exp_f32 v60, v60
    v_exp_f32 v61, v61
    v_exp_f32 v62, v62
    v_exp_f32 v63, v63
    v_mov_b32 v188, 0x3f803f80
    v_mov_b32 v189, 0x3f803f80
    v_cvt_pk_bf16_f32 v68, v56, v57
    v_cvt_pk_bf16_f32 v69, v58, v59
    v_cvt_pk_bf16_f32 v70, v60, v61
    v_cvt_pk_bf16_f32 v71, v62, v63
    s_setprio 1
    v_mfma_f32_32x32x16_bf16 v[48:63], v[142:145], v[22:25], v[120:135]
    v_exp_f32 v32, v32
    v_exp_f32 v33, v33
    v_exp_f32 v34, v34
    v_exp_f32 v35, v35
    v_mfma_f32_32x32x16_bf16 v[88:103], v[152:155], v[68:71], v[88:103]
    s_barrier
    ds_read_b128 v[136:139], v28 offset:0
    ds_read_b64 v[140:141], v30 offset:0
    v_exp_f32 v36, v36
    v_exp_f32 v37, v37
    v_exp_f32 v38, v38
    v_exp_f32 v39, v39
    v_mfma_f32_32x32x8_bf16 v[48:63], v[146:147], v[26:27], v[48:63]
    ds_read_b128 v[148:151], v29 offset:1024
    s_waitcnt vmcnt(8)
    v_cvt_pk_bf16_f32 v64, v32, v33
    v_cvt_pk_bf16_f32 v65, v34, v35
    v_cvt_pk_bf16_f32 v66, v36, v37
    v_cvt_pk_bf16_f32 v67, v38, v39
    v_exp_f32 v40, v40
    v_exp_f32 v41, v41
    v_exp_f32 v42, v42
    v_exp_f32 v43, v43
    v_mfma_f32_32x32x16_bf16 v[72:87], v[156:159], v[64:67], v[72:87]
    ds_read_b128 v[152:155], v28 offset:2048
    ds_read_b64_tr_b16 v[164:165], v13 offset:0
    ds_read_b64_tr_b16 v[166:167], v13 offset:1024
    v_exp_f32 v44, v44
    v_exp_f32 v45, v45
    v_exp_f32 v46, v46
    v_exp_f32 v47, v47
    ds_read_b64_tr_b16 v[168:169], v13 offset:32
    ds_read_b64_tr_b16 v[170:171], v13 offset:1056
    v_cvt_pk_bf16_f32 v68, v40, v41
    v_cvt_pk_bf16_f32 v69, v42, v43
    v_cvt_pk_bf16_f32 v70, v44, v45
    v_cvt_pk_bf16_f32 v71, v46, v47
    s_setprio 0
    s_waitcnt lgkmcnt(0)
    v_mfma_f32_32x32x16_bf16 v[32:47], v[136:139], v[16:19], v[104:119]
    v_exp_f32 v48, v48
    v_exp_f32 v49, v49
    v_exp_f32 v50, v50
    v_exp_f32 v51, v51
    v_mfma_f32_32x32x16_bf16 v[72:87], v[160:163], v[68:71], v[72:87]
    v_mfma_f32_4x4x4_16b_bf16 v[180:183], v[188:189], v[164:165], 0
    buffer_store_dwordx4 v[164:167], v3, s[4:7], s72 offen sc1
    v_exp_f32 v52, v52
    v_exp_f32 v53, v53
    v_exp_f32 v54, v54
    v_exp_f32 v55, v55
    v_mfma_f32_32x32x8_bf16 v[32:47], v[140:141], v[20:21], v[32:47]
    v_mfma_f32_4x4x4_16b_bf16 v[180:183], v[188:189], v[166:167], v[180:183]
    v_cvt_pk_bf16_f32 v64, v48, v49
    v_cvt_pk_bf16_f32 v65, v50, v51
    v_cvt_pk_bf16_f32 v66, v52, v53
    v_cvt_pk_bf16_f32 v67, v54, v55
    v_exp_f32 v56, v56
    v_exp_f32 v57, v57
    v_exp_f32 v58, v58
    v_exp_f32 v59, v59
    v_mfma_f32_32x32x16_bf16 v[88:103], v[156:159], v[64:67], v[88:103]
    v_mfma_f32_4x4x4_16b_bf16 v[184:187], v[188:189], v[168:169], 0
    buffer_store_dwordx4 v[168:171], v3, s[4:7], s73 offen sc1
    v_exp_f32 v60, v60
    v_exp_f32 v61, v61
    v_exp_f32 v62, v62
    v_exp_f32 v63, v63
    v_mfma_f32_4x4x4_16b_bf16 v[184:187], v[188:189], v[170:171], v[184:187]
    v_cvt_pk_bf16_f32 v68, v56, v57
    v_cvt_pk_bf16_f32 v69, v58, v59
    v_cvt_pk_bf16_f32 v70, v60, v61
    v_cvt_pk_bf16_f32 v71, v62, v63
    s_setprio 1
    v_mfma_f32_32x32x16_bf16 v[48:63], v[136:139], v[22:25], v[120:135]
    v_exp_f32 v32, v32
    v_exp_f32 v33, v33
    v_exp_f32 v34, v34
    v_exp_f32 v35, v35
    v_mfma_f32_32x32x16_bf16 v[88:103], v[160:163], v[68:71], v[88:103]
    ds_read_b128 v[142:145], v28 offset:3072
    ds_read_b64 v[146:147], v30 offset:3072
    v_exp_f32 v36, v36
    v_exp_f32 v37, v37
    v_exp_f32 v38, v38
    v_exp_f32 v39, v39
    v_mfma_f32_32x32x8_bf16 v[48:63], v[140:141], v[26:27], v[48:63]
    ds_read_b128 v[156:159], v29 offset:4096
    s_waitcnt vmcnt(8)
    v_cvt_pk_bf16_f32 v64, v32, v33
    v_cvt_pk_bf16_f32 v65, v34, v35
    v_cvt_pk_bf16_f32 v66, v36, v37
    v_cvt_pk_bf16_f32 v67, v38, v39
    v_exp_f32 v40, v40
    v_exp_f32 v41, v41
    v_exp_f32 v42, v42
    v_exp_f32 v43, v43
    v_mfma_f32_32x32x16_bf16 v[72:87], v[148:151], v[64:67], v[72:87]
    ds_read_b128 v[160:163], v28 offset:5120
    ds_read_b64_tr_b16 v[172:173], v13 offset:2048
    ds_read_b64_tr_b16 v[174:175], v13 offset:3072
    v_exp_f32 v44, v44
    v_exp_f32 v45, v45
    v_exp_f32 v46, v46
    v_exp_f32 v47, v47
    ds_read_b64_tr_b16 v[176:177], v13 offset:2080
    ds_read_b64_tr_b16 v[178:179], v13 offset:3104
    v_cvt_pk_bf16_f32 v68, v40, v41
    v_cvt_pk_bf16_f32 v69, v42, v43
    v_cvt_pk_bf16_f32 v70, v44, v45
    v_cvt_pk_bf16_f32 v71, v46, v47
    s_setprio 0
    s_waitcnt lgkmcnt(0)
    v_mfma_f32_32x32x16_bf16 v[32:47], v[142:145], v[16:19], v[104:119]
    v_exp_f32 v48, v48
    v_exp_f32 v49, v49
    v_exp_f32 v50, v50
    v_exp_f32 v51, v51
    v_mfma_f32_32x32x16_bf16 v[72:87], v[152:155], v[68:71], v[72:87]
    v_mfma_f32_4x4x4_16b_bf16 v[180:183], v[188:189], v[172:173], v[180:183]
    buffer_store_dwordx4 v[172:175], v3, s[4:7], s74 offen sc1
    v_exp_f32 v52, v52
    v_exp_f32 v53, v53
    v_exp_f32 v54, v54
    v_exp_f32 v55, v55
    v_mfma_f32_32x32x8_bf16 v[32:47], v[146:147], v[20:21], v[32:47]
    v_mfma_f32_4x4x4_16b_bf16 v[180:183], v[188:189], v[174:175], v[180:183]
    v_cvt_pk_bf16_f32 v64, v48, v49
    v_cvt_pk_bf16_f32 v65, v50, v51
    v_cvt_pk_bf16_f32 v66, v52, v53
    v_cvt_pk_bf16_f32 v67, v54, v55
    v_exp_f32 v56, v56
    v_exp_f32 v57, v57
    v_exp_f32 v58, v58
    v_exp_f32 v59, v59
    v_mfma_f32_32x32x16_bf16 v[88:103], v[148:151], v[64:67], v[88:103]
    v_mfma_f32_4x4x4_16b_bf16 v[184:187], v[188:189], v[176:177], v[184:187]
    buffer_store_dwordx4 v[176:179], v3, s[4:7], s75 offen sc1
    v_exp_f32 v60, v60
    v_exp_f32 v61, v61
    v_exp_f32 v62, v62
    v_exp_f32 v63, v63
    v_mfma_f32_4x4x4_16b_bf16 v[184:187], v[188:189], v[178:179], v[184:187]
    v_cvt_pk_bf16_f32 v68, v56, v57
    v_cvt_pk_bf16_f32 v69, v58, v59
    v_cvt_pk_bf16_f32 v70, v60, v61
    v_cvt_pk_bf16_f32 v71, v62, v63
    s_setprio 1
    v_mfma_f32_32x32x16_bf16 v[48:63], v[142:145], v[22:25], v[120:135]
    v_exp_f32 v32, v32
    v_exp_f32 v33, v33
    v_exp_f32 v34, v34
    v_exp_f32 v35, v35
    v_mfma_f32_32x32x16_bf16 v[88:103], v[152:155], v[68:71], v[88:103]
    ds_read_b128 v[136:139], v28 offset:6144
    ds_read_b64 v[140:141], v30 offset:6144
    v_exp_f32 v36, v36
    v_exp_f32 v37, v37
    v_exp_f32 v38, v38
    v_exp_f32 v39, v39
    v_mfma_f32_32x32x8_bf16 v[48:63], v[146:147], v[26:27], v[48:63]
    ds_read_b128 v[148:151], v29 offset:7168
    s_waitcnt vmcnt(8)
    v_cvt_pk_bf16_f32 v64, v32, v33
    v_cvt_pk_bf16_f32 v65, v34, v35
    v_cvt_pk_bf16_f32 v66, v36, v37
    v_cvt_pk_bf16_f32 v67, v38, v39
    v_exp_f32 v40, v40
    v_exp_f32 v41, v41
    v_exp_f32 v42, v42
    v_exp_f32 v43, v43
    v_mfma_f32_32x32x16_bf16 v[72:87], v[156:159], v[64:67], v[72:87]
    ds_read_b128 v[152:155], v28 offset:8192
    ds_read_b64_tr_b16 v[164:165], v13 offset:4096
    ds_read_b64_tr_b16 v[166:167], v13 offset:5120
    v_exp_f32 v44, v44
    v_exp_f32 v45, v45
    v_exp_f32 v46, v46
    v_exp_f32 v47, v47
    ds_read_b64_tr_b16 v[168:169], v13 offset:4128
    ds_read_b64_tr_b16 v[170:171], v13 offset:5152
    v_cvt_pk_bf16_f32 v68, v40, v41
    v_cvt_pk_bf16_f32 v69, v42, v43
    v_cvt_pk_bf16_f32 v70, v44, v45
    v_cvt_pk_bf16_f32 v71, v46, v47
    s_setprio 0
    s_waitcnt lgkmcnt(0)
    v_mfma_f32_32x32x16_bf16 v[32:47], v[136:139], v[16:19], v[104:119]
    v_exp_f32 v48, v48
    v_exp_f32 v49, v49
    v_exp_f32 v50, v50
    v_exp_f32 v51, v51
    v_mfma_f32_32x32x16_bf16 v[72:87], v[160:163], v[68:71], v[72:87]
    v_mfma_f32_4x4x4_16b_bf16 v[180:183], v[188:189], v[164:165], v[180:183]
    buffer_store_dwordx4 v[164:167], v3, s[4:7], s76 offen sc1
    v_exp_f32 v52, v52
    v_exp_f32 v53, v53
    v_exp_f32 v54, v54
    v_exp_f32 v55, v55
    v_mfma_f32_32x32x8_bf16 v[32:47], v[140:141], v[20:21], v[32:47]
    v_mfma_f32_4x4x4_16b_bf16 v[180:183], v[188:189], v[166:167], v[180:183]
    v_cvt_pk_bf16_f32 v64, v48, v49
    v_cvt_pk_bf16_f32 v65, v50, v51
    v_cvt_pk_bf16_f32 v66, v52, v53
    v_cvt_pk_bf16_f32 v67, v54, v55
    v_exp_f32 v56, v56
    v_exp_f32 v57, v57
    v_exp_f32 v58, v58
    v_exp_f32 v59, v59
    v_mfma_f32_32x32x16_bf16 v[88:103], v[156:159], v[64:67], v[88:103]
    v_mfma_f32_4x4x4_16b_bf16 v[184:187], v[188:189], v[168:169], v[184:187]
    buffer_store_dwordx4 v[168:171], v3, s[4:7], s77 offen sc1
    v_exp_f32 v60, v60
    v_exp_f32 v61, v61
    v_exp_f32 v62, v62
    v_exp_f32 v63, v63
    v_mfma_f32_4x4x4_16b_bf16 v[184:187], v[188:189], v[170:171], v[184:187]
    v_cvt_pk_bf16_f32 v68, v56, v57
    v_cvt_pk_bf16_f32 v69, v58, v59
    v_cvt_pk_bf16_f32 v70, v60, v61
    v_cvt_pk_bf16_f32 v71, v62, v63
    s_setprio 1
    v_mfma_f32_32x32x16_bf16 v[48:63], v[136:139], v[22:25], v[120:135]
    v_exp_f32 v32, v32
    v_exp_f32 v33, v33
    v_exp_f32 v34, v34
    v_exp_f32 v35, v35
    v_mfma_f32_32x32x16_bf16 v[88:103], v[160:163], v[68:71], v[88:103]
    ds_read_b128 v[142:145], v28 offset:9216
    ds_read_b64 v[146:147], v30 offset:9216
    v_exp_f32 v36, v36
    v_exp_f32 v37, v37
    v_exp_f32 v38, v38
    v_exp_f32 v39, v39
    v_mfma_f32_32x32x8_bf16 v[48:63], v[140:141], v[26:27], v[48:63]
    ds_read_b128 v[156:159], v29 offset:10240
    s_waitcnt vmcnt(8)
    v_cvt_pk_bf16_f32 v64, v32, v33
    v_cvt_pk_bf16_f32 v65, v34, v35
    v_cvt_pk_bf16_f32 v66, v36, v37
    v_cvt_pk_bf16_f32 v67, v38, v39
    v_exp_f32 v40, v40
    v_exp_f32 v41, v41
    v_exp_f32 v42, v42
    v_exp_f32 v43, v43
    v_mfma_f32_32x32x16_bf16 v[72:87], v[148:151], v[64:67], v[72:87]
    ds_read_b128 v[160:163], v28 offset:11264
    ds_read_b64_tr_b16 v[172:173], v13 offset:6144
    ds_read_b64_tr_b16 v[174:175], v13 offset:7168
    v_exp_f32 v44, v44
    v_exp_f32 v45, v45
    v_exp_f32 v46, v46
    v_exp_f32 v47, v47
    ds_read_b64_tr_b16 v[176:177], v13 offset:6176
    ds_read_b64_tr_b16 v[178:179], v13 offset:7200
    v_cvt_pk_bf16_f32 v68, v40, v41
    v_cvt_pk_bf16_f32 v69, v42, v43
    v_cvt_pk_bf16_f32 v70, v44, v45
    v_cvt_pk_bf16_f32 v71, v46, v47
    s_setprio 0
    s_waitcnt lgkmcnt(0)
    v_mfma_f32_32x32x16_bf16 v[32:47], v[142:145], v[16:19], v[104:119]
    v_exp_f32 v48, v48
    v_exp_f32 v49, v49
    v_exp_f32 v50, v50
    v_exp_f32 v51, v51
    v_mfma_f32_32x32x16_bf16 v[72:87], v[152:155], v[68:71], v[72:87]
    v_mfma_f32_4x4x4_16b_bf16 v[180:183], v[188:189], v[172:173], v[180:183]
    buffer_store_dwordx4 v[172:175], v3, s[4:7], s78 offen sc1
    v_exp_f32 v52, v52
    v_exp_f32 v53, v53
    v_exp_f32 v54, v54
    v_exp_f32 v55, v55
    v_mfma_f32_32x32x8_bf16 v[32:47], v[146:147], v[20:21], v[32:47]
    v_mfma_f32_4x4x4_16b_bf16 v[180:183], v[188:189], v[174:175], v[180:183]
    v_cvt_pk_bf16_f32 v64, v48, v49
    v_cvt_pk_bf16_f32 v65, v50, v51
    v_cvt_pk_bf16_f32 v66, v52, v53
    v_cvt_pk_bf16_f32 v67, v54, v55
    v_exp_f32 v56, v56
    v_exp_f32 v57, v57
    v_exp_f32 v58, v58
    v_exp_f32 v59, v59
    v_mfma_f32_32x32x16_bf16 v[88:103], v[148:151], v[64:67], v[88:103]
    v_mfma_f32_4x4x4_16b_bf16 v[184:187], v[188:189], v[176:177], v[184:187]
    buffer_store_dwordx4 v[176:179], v3, s[4:7], s79 offen sc1
    v_exp_f32 v60, v60
    v_exp_f32 v61, v61
    v_exp_f32 v62, v62
    v_exp_f32 v63, v63
    v_mfma_f32_4x4x4_16b_bf16 v[184:187], v[188:189], v[178:179], v[184:187]
    v_cvt_pk_bf16_f32 v68, v56, v57
    v_cvt_pk_bf16_f32 v69, v58, v59
    v_cvt_pk_bf16_f32 v70, v60, v61
    v_cvt_pk_bf16_f32 v71, v62, v63
    s_setprio 1
    v_mfma_f32_32x32x16_bf16 v[48:63], v[142:145], v[22:25], v[120:135]
    v_exp_f32 v32, v32
    v_exp_f32 v33, v33
    v_exp_f32 v34, v34
    v_exp_f32 v35, v35
    v_mfma_f32_32x32x16_bf16 v[88:103], v[152:155], v[68:71], v[88:103]
    s_barrier
    ds_read_b128 v[136:139], v4 offset:0
    ds_read_b64 v[140:141], v6 offset:0
    v_exp_f32 v36, v36
    v_exp_f32 v37, v37
    v_exp_f32 v38, v38
    v_exp_f32 v39, v39
    v_mfma_f32_32x32x8_bf16 v[48:63], v[146:147], v[26:27], v[48:63]
    ds_read_b128 v[148:151], v5 offset:1024
    s_waitcnt vmcnt(8)
    v_cvt_pk_bf16_f32 v64, v32, v33
    v_cvt_pk_bf16_f32 v65, v34, v35
    v_cvt_pk_bf16_f32 v66, v36, v37
    v_cvt_pk_bf16_f32 v67, v38, v39
    v_exp_f32 v40, v40
    v_exp_f32 v41, v41
    v_exp_f32 v42, v42
    v_exp_f32 v43, v43
    v_mfma_f32_32x32x16_bf16 v[72:87], v[156:159], v[64:67], v[72:87]
    ds_read_b128 v[152:155], v4 offset:2048
    ds_read_b64_tr_b16 v[164:165], v13 offset:8192
    ds_read_b64_tr_b16 v[166:167], v13 offset:9216
    v_exp_f32 v44, v44
    v_exp_f32 v45, v45
    v_exp_f32 v46, v46
    v_exp_f32 v47, v47
    ds_read_b64_tr_b16 v[168:169], v13 offset:8224
    ds_read_b64_tr_b16 v[170:171], v13 offset:9248
    v_cvt_pk_bf16_f32 v68, v40, v41
    v_cvt_pk_bf16_f32 v69, v42, v43
    v_cvt_pk_bf16_f32 v70, v44, v45
    v_cvt_pk_bf16_f32 v71, v46, v47
    s_setprio 0
    s_waitcnt lgkmcnt(0)
    v_mfma_f32_32x32x16_bf16 v[32:47], v[136:139], v[16:19], v[104:119]
    v_exp_f32 v48, v48
    v_exp_f32 v49, v49
    v_exp_f32 v50, v50
    v_exp_f32 v51, v51
    v_mfma_f32_32x32x16_bf16 v[72:87], v[160:163], v[68:71], v[72:87]
    v_mfma_f32_4x4x4_16b_bf16 v[180:183], v[188:189], v[164:165], v[180:183]
    buffer_store_dwordx4 v[164:167], v3, s[4:7], s80 offen sc1
    v_exp_f32 v52, v52
    v_exp_f32 v53, v53
    v_exp_f32 v54, v54
    v_exp_f32 v55, v55
    v_mfma_f32_32x32x8_bf16 v[32:47], v[140:141], v[20:21], v[32:47]
    v_mfma_f32_4x4x4_16b_bf16 v[180:183], v[188:189], v[166:167], v[180:183]
    v_cvt_pk_bf16_f32 v64, v48, v49
    v_cvt_pk_bf16_f32 v65, v50, v51
    v_cvt_pk_bf16_f32 v66, v52, v53
    v_cvt_pk_bf16_f32 v67, v54, v55
    v_exp_f32 v56, v56
    v_exp_f32 v57, v57
    v_exp_f32 v58, v58
    v_exp_f32 v59, v59
    v_mfma_f32_32x32x16_bf16 v[88:103], v[156:159], v[64:67], v[88:103]
    v_mfma_f32_4x4x4_16b_bf16 v[184:187], v[188:189], v[168:169], v[184:187]
    buffer_store_dwordx4 v[168:171], v3, s[4:7], s81 offen sc1
    v_exp_f32 v60, v60
    v_exp_f32 v61, v61
    v_exp_f32 v62, v62
    v_exp_f32 v63, v63
    v_mfma_f32_4x4x4_16b_bf16 v[184:187], v[188:189], v[170:171], v[184:187]
    v_cvt_pk_bf16_f32 v68, v56, v57
    v_cvt_pk_bf16_f32 v69, v58, v59
    v_cvt_pk_bf16_f32 v70, v60, v61
    v_cvt_pk_bf16_f32 v71, v62, v63
    s_setprio 1
    v_mfma_f32_32x32x16_bf16 v[48:63], v[136:139], v[22:25], v[120:135]
    v_exp_f32 v32, v32
    v_exp_f32 v33, v33
    v_exp_f32 v34, v34
    v_exp_f32 v35, v35
    v_mfma_f32_32x32x16_bf16 v[88:103], v[160:163], v[68:71], v[88:103]
    ds_read_b128 v[142:145], v4 offset:3072
    ds_read_b64 v[146:147], v6 offset:3072
    v_mov_b32 v190, v180
    v_mov_b32 v191, v184
    v_exp_f32 v36, v36
    v_exp_f32 v37, v37
    v_exp_f32 v38, v38
    v_exp_f32 v39, v39
    v_mfma_f32_32x32x8_bf16 v[48:63], v[140:141], v[26:27], v[48:63]
    ds_read_b128 v[156:159], v5 offset:4096
    v_permlane32_swap_b32 v180, v190
    v_permlane32_swap_b32 v184, v191
    v_cvt_pk_bf16_f32 v64, v32, v33
    v_cvt_pk_bf16_f32 v65, v34, v35
    v_cvt_pk_bf16_f32 v66, v36, v37
    v_cvt_pk_bf16_f32 v67, v38, v39
    v_exp_f32 v40, v40
    v_exp_f32 v41, v41
    v_exp_f32 v42, v42
    v_exp_f32 v43, v43
    v_mfma_f32_32x32x16_bf16 v[72:87], v[148:151], v[64:67], v[72:87]
    ds_read_b128 v[160:163], v4 offset:5120
    v_add_f32 v180, v180, v190
    v_add_f32 v184, v184, v191
    v_exp_f32 v44, v44
    v_exp_f32 v45, v45
    v_exp_f32 v46, v46
    v_exp_f32 v47, v47
    v_mov_b32 v190, v180
    v_mov_b32 v191, v184
    v_cvt_pk_bf16_f32 v68, v40, v41
    v_cvt_pk_bf16_f32 v69, v42, v43
    v_cvt_pk_bf16_f32 v70, v44, v45
    v_cvt_pk_bf16_f32 v71, v46, v47
    s_setprio 0
    s_waitcnt lgkmcnt(0)
    v_mfma_f32_32x32x16_bf16 v[32:47], v[142:145], v[16:19], v[104:119]
    v_exp_f32 v48, v48
    v_exp_f32 v49, v49
    v_exp_f32 v50, v50
    v_exp_f32 v51, v51
    v_mfma_f32_32x32x16_bf16 v[72:87], v[152:155], v[68:71], v[72:87]
    v_permlane16_swap_b32 v180, v190
    v_permlane16_swap_b32 v184, v191
    v_exp_f32 v52, v52
    v_exp_f32 v53, v53
    v_exp_f32 v54, v54
    v_exp_f32 v55, v55
    v_mfma_f32_32x32x8_bf16 v[32:47], v[146:147], v[20:21], v[32:47]
    v_add_f32 v180, v180, v190
    v_add_f32 v184, v184, v191
    v_cvt_pk_bf16_f32 v64, v48, v49
    v_cvt_pk_bf16_f32 v65, v50, v51
    v_cvt_pk_bf16_f32 v66, v52, v53
    v_cvt_pk_bf16_f32 v67, v54, v55
    v_exp_f32 v56, v56
    v_exp_f32 v57, v57
    v_exp_f32 v58, v58
    v_exp_f32 v59, v59
    v_mfma_f32_32x32x16_bf16 v[88:103], v[148:151], v[64:67], v[88:103]
    v_cvt_pk_bf16_f32 v164, v180, v180
    v_mov_b32 v166, 0
    v_cvt_pk_bf16_f32 v168, v184, v184
    v_mov_b32 v170, 0
    v_exp_f32 v60, v60
    v_exp_f32 v61, v61
    v_exp_f32 v62, v62
    v_exp_f32 v63, v63
    v_and_b32 v190, 0xffff0000, v164
    v_sub_f32 v190, v180, v190
    v_and_b32 v191, 0xffff0000, v168
    v_sub_f32 v191, v184, v191
    v_cvt_pk_bf16_f32 v68, v56, v57
    v_cvt_pk_bf16_f32 v69, v58, v59
    v_cvt_pk_bf16_f32 v70, v60, v61
    v_cvt_pk_bf16_f32 v71, v62, v63
    s_setprio 1
    v_mfma_f32_32x32x16_bf16 v[48:63], v[142:145], v[22:25], v[120:135]
    v_exp_f32 v32, v32
    v_exp_f32 v33, v33
    v_exp_f32 v34, v34
    v_exp_f32 v35, v35
    v_mfma_f32_32x32x16_bf16 v[88:103], v[152:155], v[68:71], v[88:103]
    ds_read_b128 v[136:139], v4 offset:6144
    ds_read_b64 v[140:141], v6 offset:6144
    v_cvt_pk_bf16_f32 v165, v190, v166
    v_mov_b32 v167, 0
    v_cvt_pk_bf16_f32 v169, v191, v170
    v_mov_b32 v171, 0
    v_exp_f32 v36, v36
    v_exp_f32 v37, v37
    v_exp_f32 v38, v38
    v_exp_f32 v39, v39
    v_mfma_f32_32x32x8_bf16 v[48:63], v[146:147], v[26:27], v[48:63]
    ds_read_b128 v[148:151], v5 offset:7168
    v_lshrrev_b32 v10, 4, v2
    v_cmp_ne_u32 vcc, s29, v10
    v_cvt_pk_bf16_f32 v64, v32, v33
    v_cvt_pk_bf16_f32 v65, v34, v35
    v_cvt_pk_bf16_f32 v66, v36, v37
    v_cvt_pk_bf16_f32 v67, v38, v39
    v_exp_f32 v40, v40
    v_exp_f32 v41, v41
    v_exp_f32 v42, v42
    v_exp_f32 v43, v43
    v_mfma_f32_32x32x16_bf16 v[72:87], v[156:159], v[64:67], v[72:87]
    ds_read_b128 v[152:155], v4 offset:8192
    v_cndmask_b32 v10, 0, 1, vcc
    v_lshl_add_u32 v10, v10, 30, v3
    v_exp_f32 v44, v44
    v_exp_f32 v45, v45
    v_exp_f32 v46, v46
    v_exp_f32 v47, v47
    buffer_store_dwordx4 v[164:167], v10, s[4:7], s88 offen sc1
    buffer_store_dwordx4 v[168:171], v10, s[4:7], s89 offen sc1
    v_cvt_pk_bf16_f32 v68, v40, v41
    v_cvt_pk_bf16_f32 v69, v42, v43
    v_cvt_pk_bf16_f32 v70, v44, v45
    v_cvt_pk_bf16_f32 v71, v46, v47
    s_setprio 0
    s_waitcnt lgkmcnt(0)
    v_mfma_f32_32x32x16_bf16 v[32:47], v[136:139], v[16:19], v[104:119]
    v_exp_f32 v48, v48
    v_exp_f32 v49, v49
    v_exp_f32 v50, v50
    v_exp_f32 v51, v51
    v_mfma_f32_32x32x16_bf16 v[72:87], v[160:163], v[68:71], v[72:87]
    v_exp_f32 v52, v52
    v_exp_f32 v53, v53
    v_exp_f32 v54, v54
    v_exp_f32 v55, v55
    v_mfma_f32_32x32x8_bf16 v[32:47], v[140:141], v[20:21], v[32:47]
    v_cvt_pk_bf16_f32 v64, v48, v49
    v_cvt_pk_bf16_f32 v65, v50, v51
    v_cvt_pk_bf16_f32 v66, v52, v53
    v_cvt_pk_bf16_f32 v67, v54, v55
    v_exp_f32 v56, v56
    v_exp_f32 v57, v57
    v_exp_f32 v58, v58
    v_exp_f32 v59, v59
    v_mfma_f32_32x32x16_bf16 v[88:103], v[156:159], v[64:67], v[88:103]
    v_exp_f32 v60, v60
    v_exp_f32 v61, v61
    v_exp_f32 v62, v62
    v_exp_f32 v63, v63
    v_cvt_pk_bf16_f32 v68, v56, v57
    v_cvt_pk_bf16_f32 v69, v58, v59
    v_cvt_pk_bf16_f32 v70, v60, v61
    v_cvt_pk_bf16_f32 v71, v62, v63
    s_setprio 1
    v_mfma_f32_32x32x16_bf16 v[48:63], v[136:139], v[22:25], v[120:135]
    v_exp_f32 v32, v32
    v_exp_f32 v33, v33
    v_exp_f32 v34, v34
    v_exp_f32 v35, v35
    v_mfma_f32_32x32x16_bf16 v[88:103], v[160:163], v[68:71], v[88:103]
    ds_read_b128 v[142:145], v4 offset:9216
    ds_read_b64 v[146:147], v6 offset:9216
    v_exp_f32 v36, v36
    v_exp_f32 v37, v37
    v_exp_f32 v38, v38
    v_exp_f32 v39, v39
    v_mfma_f32_32x32x8_bf16 v[48:63], v[140:141], v[26:27], v[48:63]
    ds_read_b128 v[156:159], v5 offset:10240
    v_cvt_pk_bf16_f32 v64, v32, v33
    v_cvt_pk_bf16_f32 v65, v34, v35
    v_cvt_pk_bf16_f32 v66, v36, v37
    v_cvt_pk_bf16_f32 v67, v38, v39
    v_exp_f32 v40, v40
    v_exp_f32 v41, v41
    v_exp_f32 v42, v42
    v_exp_f32 v43, v43
    v_mfma_f32_32x32x16_bf16 v[72:87], v[148:151], v[64:67], v[72:87]
    ds_read_b128 v[160:163], v4 offset:11264
    v_exp_f32 v44, v44
    v_exp_f32 v45, v45
    v_exp_f32 v46, v46
    v_exp_f32 v47, v47
    v_cvt_pk_bf16_f32 v68, v40, v41
    v_cvt_pk_bf16_f32 v69, v42, v43
    v_cvt_pk_bf16_f32 v70, v44, v45
    v_cvt_pk_bf16_f32 v71, v46, v47
    s_setprio 0
    s_waitcnt lgkmcnt(0)
    v_mfma_f32_32x32x16_bf16 v[32:47], v[142:145], v[16:19], v[104:119]
    v_exp_f32 v48, v48
    v_exp_f32 v49, v49
    v_exp_f32 v50, v50
    v_exp_f32 v51, v51
    v_mfma_f32_32x32x16_bf16 v[72:87], v[152:155], v[68:71], v[72:87]
    v_exp_f32 v52, v52
    v_exp_f32 v53, v53
    v_exp_f32 v54, v54
    v_exp_f32 v55, v55
    v_mfma_f32_32x32x8_bf16 v[32:47], v[146:147], v[20:21], v[32:47]
    v_cvt_pk_bf16_f32 v64, v48, v49
    v_cvt_pk_bf16_f32 v65, v50, v51
    v_cvt_pk_bf16_f32 v66, v52, v53
    v_cvt_pk_bf16_f32 v67, v54, v55
    v_exp_f32 v56, v56
    v_exp_f32 v57, v57
    v_exp_f32 v58, v58
    v_exp_f32 v59, v59
    v_mfma_f32_32x32x16_bf16 v[88:103], v[148:151], v[64:67], v[88:103]
    v_exp_f32 v60, v60
    v_exp_f32 v61, v61
    v_exp_f32 v62, v62
    v_exp_f32 v63, v63
    v_cvt_pk_bf16_f32 v68, v56, v57
    v_cvt_pk_bf16_f32 v69, v58, v59
    v_cvt_pk_bf16_f32 v70, v60, v61
    v_cvt_pk_bf16_f32 v71, v62, v63
    s_setprio 1
    v_mfma_f32_32x32x16_bf16 v[48:63], v[142:145], v[22:25], v[120:135]
    v_exp_f32 v32, v32
    v_exp_f32 v33, v33
    v_exp_f32 v34, v34
    v_exp_f32 v35, v35
    v_mfma_f32_32x32x16_bf16 v[88:103], v[152:155], v[68:71], v[88:103]
    s_waitcnt vmcnt(0)
    s_barrier
    ds_read_b128 v[136:139], v4 offset:24576
    ds_read_b64 v[140:141], v6 offset:24576
    v_exp_f32 v36, v36
    v_exp_f32 v37, v37
    v_exp_f32 v38, v38
    v_exp_f32 v39, v39
    v_mfma_f32_32x32x8_bf16 v[48:63], v[146:147], v[26:27], v[48:63]
    ds_read_b128 v[148:151], v5 offset:25600
    v_cvt_pk_bf16_f32 v64, v32, v33
    v_cvt_pk_bf16_f32 v65, v34, v35
    v_cvt_pk_bf16_f32 v66, v36, v37
    v_cvt_pk_bf16_f32 v67, v38, v39
    v_exp_f32 v40, v40
    v_exp_f32 v41, v41
    v_exp_f32 v42, v42
    v_exp_f32 v43, v43
    v_mfma_f32_32x32x16_bf16 v[72:87], v[156:159], v[64:67], v[72:87]
    ds_read_b128 v[152:155], v4 offset:26624
    v_exp_f32 v44, v44
    v_exp_f32 v45, v45
    v_exp_f32 v46, v46
    v_exp_f32 v47, v47
    s_lshl_b32 s60, s27, 2
    s_add_u32 s60, s60, 339968
    v_mov_b32 v10, 0
    v_mov_b32 v14, 1
    s_cmp_eq_u32 s29, 0
    s_cselect_b32 exec_lo, 1, 0
    s_mov_b32 exec_hi, 0
    buffer_store_dword v14, v10, s[4:7], s60 offen sc1
    s_mov_b64 exec, -1
    v_cvt_pk_bf16_f32 v68, v40, v41
    v_cvt_pk_bf16_f32 v69, v42, v43
    v_cvt_pk_bf16_f32 v70, v44, v45
    v_cvt_pk_bf16_f32 v71, v46, v47
    s_setprio 0
    s_waitcnt lgkmcnt(0)
    v_mfma_f32_32x32x16_bf16 v[32:47], v[136:139], v[16:19], v[104:119]
    v_exp_f32 v48, v48
    v_exp_f32 v49, v49
    v_exp_f32 v50, v50
    v_exp_f32 v51, v51
    v_mfma_f32_32x32x16_bf16 v[72:87], v[160:163], v[68:71], v[72:87]
    v_exp_f32 v52, v52
    v_exp_f32 v53, v53
    v_exp_f32 v54, v54
    v_exp_f32 v55, v55
    v_mfma_f32_32x32x8_bf16 v[32:47], v[140:141], v[20:21], v[32:47]
    v_cvt_pk_bf16_f32 v64, v48, v49
    v_cvt_pk_bf16_f32 v65, v50, v51
    v_cvt_pk_bf16_f32 v66, v52, v53
    v_cvt_pk_bf16_f32 v67, v54, v55
    v_exp_f32 v56, v56
    v_exp_f32 v57, v57
    v_exp_f32 v58, v58
    v_exp_f32 v59, v59
    v_mfma_f32_32x32x16_bf16 v[88:103], v[156:159], v[64:67], v[88:103]
    v_exp_f32 v60, v60
    v_exp_f32 v61, v61
    v_exp_f32 v62, v62
    v_exp_f32 v63, v63
    v_cvt_pk_bf16_f32 v68, v56, v57
    v_cvt_pk_bf16_f32 v69, v58, v59
    v_cvt_pk_bf16_f32 v70, v60, v61
    v_cvt_pk_bf16_f32 v71, v62, v63
    s_setprio 1
    v_mfma_f32_32x32x16_bf16 v[48:63], v[136:139], v[22:25], v[120:135]
    v_exp_f32 v32, v32
    v_exp_f32 v33, v33
    v_exp_f32 v34, v34
    v_exp_f32 v35, v35
    v_mfma_f32_32x32x16_bf16 v[88:103], v[160:163], v[68:71], v[88:103]
    ds_read_b128 v[142:145], v4 offset:27648
    ds_read_b64 v[146:147], v6 offset:27648
    v_exp_f32 v36, v36
    v_exp_f32 v37, v37
    v_exp_f32 v38, v38
    v_exp_f32 v39, v39
    v_mfma_f32_32x32x8_bf16 v[48:63], v[140:141], v[26:27], v[48:63]
    ds_read_b128 v[156:159], v5 offset:28672
    v_cvt_pk_bf16_f32 v64, v32, v33
    v_cvt_pk_bf16_f32 v65, v34, v35
    v_cvt_pk_bf16_f32 v66, v36, v37
    v_cvt_pk_bf16_f32 v67, v38, v39
    v_exp_f32 v40, v40
    v_exp_f32 v41, v41
    v_exp_f32 v42, v42
    v_exp_f32 v43, v43
    v_mfma_f32_32x32x16_bf16 v[72:87], v[148:151], v[64:67], v[72:87]
    ds_read_b128 v[160:163], v4 offset:29696
    v_exp_f32 v44, v44
    v_exp_f32 v45, v45
    v_exp_f32 v46, v46
    v_exp_f32 v47, v47
    v_cvt_pk_bf16_f32 v68, v40, v41
    v_cvt_pk_bf16_f32 v69, v42, v43
    v_cvt_pk_bf16_f32 v70, v44, v45
    v_cvt_pk_bf16_f32 v71, v46, v47
    s_setprio 0
    s_waitcnt lgkmcnt(0)
    v_mfma_f32_32x32x16_bf16 v[32:47], v[142:145], v[16:19], v[104:119]
    v_exp_f32 v48, v48
    v_exp_f32 v49, v49
    v_exp_f32 v50, v50
    v_exp_f32 v51, v51
    v_mfma_f32_32x32x16_bf16 v[72:87], v[152:155], v[68:71], v[72:87]
    v_exp_f32 v52, v52
    v_exp_f32 v53, v53
    v_exp_f32 v54, v54
    v_exp_f32 v55, v55
    v_mfma_f32_32x32x8_bf16 v[32:47], v[146:147], v[20:21], v[32:47]
    v_cvt_pk_bf16_f32 v64, v48, v49
    v_cvt_pk_bf16_f32 v65, v50, v51
    v_cvt_pk_bf16_f32 v66, v52, v53
    v_cvt_pk_bf16_f32 v67, v54, v55
    v_exp_f32 v56, v56
    v_exp_f32 v57, v57
    v_exp_f32 v58, v58
    v_exp_f32 v59, v59
    v_mfma_f32_32x32x16_bf16 v[88:103], v[148:151], v[64:67], v[88:103]
    v_exp_f32 v60, v60
    v_exp_f32 v61, v61
    v_exp_f32 v62, v62
    v_exp_f32 v63, v63
    v_cvt_pk_bf16_f32 v68, v56, v57
    v_cvt_pk_bf16_f32 v69, v58, v59
    v_cvt_pk_bf16_f32 v70, v60, v61
    v_cvt_pk_bf16_f32 v71, v62, v63
    s_setprio 1
    v_mfma_f32_32x32x16_bf16 v[48:63], v[142:145], v[22:25], v[120:135]
    v_exp_f32 v32, v32
    v_exp_f32 v33, v33
    v_exp_f32 v34, v34
    v_exp_f32 v35, v35
    v_mfma_f32_32x32x16_bf16 v[88:103], v[152:155], v[68:71], v[88:103]
    ds_read_b128 v[136:139], v4 offset:30720
    ds_read_b64 v[140:141], v6 offset:30720
    v_exp_f32 v36, v36
    v_exp_f32 v37, v37
    v_exp_f32 v38, v38
    v_exp_f32 v39, v39
    v_mfma_f32_32x32x8_bf16 v[48:63], v[146:147], v[26:27], v[48:63]
    ds_read_b128 v[148:151], v5 offset:31744
    v_cvt_pk_bf16_f32 v64, v32, v33
    v_cvt_pk_bf16_f32 v65, v34, v35
    v_cvt_pk_bf16_f32 v66, v36, v37
    v_cvt_pk_bf16_f32 v67, v38, v39
    v_exp_f32 v40, v40
    v_exp_f32 v41, v41
    v_exp_f32 v42, v42
    v_exp_f32 v43, v43
    v_mfma_f32_32x32x16_bf16 v[72:87], v[156:159], v[64:67], v[72:87]
    ds_read_b128 v[152:155], v4 offset:32768
    v_exp_f32 v44, v44
    v_exp_f32 v45, v45
    v_exp_f32 v46, v46
    v_exp_f32 v47, v47
    v_cvt_pk_bf16_f32 v68, v40, v41
    v_cvt_pk_bf16_f32 v69, v42, v43
    v_cvt_pk_bf16_f32 v70, v44, v45
    v_cvt_pk_bf16_f32 v71, v46, v47
    s_setprio 0
    s_waitcnt lgkmcnt(0)
    v_mfma_f32_32x32x16_bf16 v[32:47], v[136:139], v[16:19], v[104:119]
    v_exp_f32 v48, v48
    v_exp_f32 v49, v49
    v_exp_f32 v50, v50
    v_exp_f32 v51, v51
    v_mfma_f32_32x32x16_bf16 v[72:87], v[160:163], v[68:71], v[72:87]
    v_exp_f32 v52, v52
    v_exp_f32 v53, v53
    v_exp_f32 v54, v54
    v_exp_f32 v55, v55
    v_mfma_f32_32x32x8_bf16 v[32:47], v[140:141], v[20:21], v[32:47]
    v_cvt_pk_bf16_f32 v64, v48, v49
    v_cvt_pk_bf16_f32 v65, v50, v51
    v_cvt_pk_bf16_f32 v66, v52, v53
    v_cvt_pk_bf16_f32 v67, v54, v55
    v_exp_f32 v56, v56
    v_exp_f32 v57, v57
    v_exp_f32 v58, v58
    v_exp_f32 v59, v59
    v_mfma_f32_32x32x16_bf16 v[88:103], v[156:159], v[64:67], v[88:103]
    v_exp_f32 v60, v60
    v_exp_f32 v61, v61
    v_exp_f32 v62, v62
    v_exp_f32 v63, v63
    s_mov_b32 s62, 339968
    buffer_load_dwordx4 v[164:167], v3, s[4:7], s62 offen sc1
    v_cvt_pk_bf16_f32 v68, v56, v57
    v_cvt_pk_bf16_f32 v69, v58, v59
    v_cvt_pk_bf16_f32 v70, v60, v61
    v_cvt_pk_bf16_f32 v71, v62, v63
    s_setprio 1
    v_mfma_f32_32x32x16_bf16 v[48:63], v[136:139], v[22:25], v[120:135]
    v_exp_f32 v32, v32
    v_exp_f32 v33, v33
    v_exp_f32 v34, v34
    v_exp_f32 v35, v35
    v_mfma_f32_32x32x16_bf16 v[88:103], v[160:163], v[68:71], v[88:103]
    ds_read_b128 v[142:145], v4 offset:33792
    ds_read_b64 v[146:147], v6 offset:33792
    v_exp_f32 v36, v36
    v_exp_f32 v37, v37
    v_exp_f32 v38, v38
    v_exp_f32 v39, v39
    v_mfma_f32_32x32x8_bf16 v[48:63], v[140:141], v[26:27], v[48:63]
    ds_read_b128 v[156:159], v5 offset:34816
    v_cvt_pk_bf16_f32 v64, v32, v33
    v_cvt_pk_bf16_f32 v65, v34, v35
    v_cvt_pk_bf16_f32 v66, v36, v37
    v_cvt_pk_bf16_f32 v67, v38, v39
    v_exp_f32 v40, v40
    v_exp_f32 v41, v41
    v_exp_f32 v42, v42
    v_exp_f32 v43, v43
    v_mfma_f32_32x32x16_bf16 v[72:87], v[148:151], v[64:67], v[72:87]
    ds_read_b128 v[160:163], v4 offset:35840
    v_exp_f32 v44, v44
    v_exp_f32 v45, v45
    v_exp_f32 v46, v46
    v_exp_f32 v47, v47
    v_cvt_pk_bf16_f32 v68, v40, v41
    v_cvt_pk_bf16_f32 v69, v42, v43
    v_cvt_pk_bf16_f32 v70, v44, v45
    v_cvt_pk_bf16_f32 v71, v46, v47
    s_setprio 0
    s_waitcnt lgkmcnt(0)
    v_mfma_f32_32x32x16_bf16 v[32:47], v[142:145], v[16:19], v[104:119]
    v_exp_f32 v48, v48
    v_exp_f32 v49, v49
    v_exp_f32 v50, v50
    v_exp_f32 v51, v51
    v_mfma_f32_32x32x16_bf16 v[72:87], v[152:155], v[68:71], v[72:87]
    v_exp_f32 v52, v52
    v_exp_f32 v53, v53
    v_exp_f32 v54, v54
    v_exp_f32 v55, v55
    v_mfma_f32_32x32x8_bf16 v[32:47], v[146:147], v[20:21], v[32:47]
    v_cvt_pk_bf16_f32 v64, v48, v49
    v_cvt_pk_bf16_f32 v65, v50, v51
    v_cvt_pk_bf16_f32 v66, v52, v53
    v_cvt_pk_bf16_f32 v67, v54, v55
    v_exp_f32 v56, v56
    v_exp_f32 v57, v57
    v_exp_f32 v58, v58
    v_exp_f32 v59, v59
    v_mfma_f32_32x32x16_bf16 v[88:103], v[148:151], v[64:67], v[88:103]
    v_exp_f32 v60, v60
    v_exp_f32 v61, v61
    v_exp_f32 v62, v62
    v_exp_f32 v63, v63
    v_cvt_pk_bf16_f32 v68, v56, v57
    v_cvt_pk_bf16_f32 v69, v58, v59
    v_cvt_pk_bf16_f32 v70, v60, v61
    v_cvt_pk_bf16_f32 v71, v62, v63
    s_setprio 1
    v_mfma_f32_32x32x16_bf16 v[48:63], v[142:145], v[22:25], v[120:135]
    v_exp_f32 v32, v32
    v_exp_f32 v33, v33
    v_exp_f32 v34, v34
    v_exp_f32 v35, v35
    v_mfma_f32_32x32x16_bf16 v[88:103], v[152:155], v[68:71], v[88:103]
    s_barrier
    ds_read_b128 v[136:139], v4 offset:0
    ds_read_b64 v[140:141], v6 offset:0
    v_exp_f32 v36, v36
    v_exp_f32 v37, v37
    v_exp_f32 v38, v38
    v_exp_f32 v39, v39
    v_mfma_f32_32x32x8_bf16 v[48:63], v[146:147], v[26:27], v[48:63]
    ds_read_b128 v[148:151], v5 offset:1024
    v_cvt_pk_bf16_f32 v64, v32, v33
    v_cvt_pk_bf16_f32 v65, v34, v35
    v_cvt_pk_bf16_f32 v66, v36, v37
    v_cvt_pk_bf16_f32 v67, v38, v39
    v_exp_f32 v40, v40
    v_exp_f32 v41, v41
    v_exp_f32 v42, v42
    v_exp_f32 v43, v43
    v_mfma_f32_32x32x16_bf16 v[72:87], v[156:159], v[64:67], v[72:87]
    ds_read_b128 v[152:155], v4 offset:2048
    v_exp_f32 v44, v44
    v_exp_f32 v45, v45
    v_exp_f32 v46, v46
    v_exp_f32 v47, v47
    s_waitcnt vmcnt(0)
    v_and_b32 v164, v164, v165
    v_and_b32 v166, v166, v167
    v_and_b32 v164, v164, v166
    v_cmp_ne_u32 vcc, 1, v164
    s_mul_i32 s60, s29, 25600
    s_mul_i32 s61, s26, 102400
    s_add_u32 s61, s61, s60
    s_add_u32 s63, s61, 8388608
    s_add_u32 s64, s60, 49152
    s_cbranch_vccnz L_ps_wait
L_ps_ready:
    v_cvt_pk_bf16_f32 v68, v40, v41
    v_cvt_pk_bf16_f32 v69, v42, v43
    v_cvt_pk_bf16_f32 v70, v44, v45
    v_cvt_pk_bf16_f32 v71, v46, v47
    s_setprio 0
    s_waitcnt lgkmcnt(0)
    v_mfma_f32_32x32x16_bf16 v[32:47], v[136:139], v[16:19], v[104:119]
    v_exp_f32 v48, v48
    v_exp_f32 v49, v49
    v_exp_f32 v50, v50
    v_exp_f32 v51, v51
    v_mfma_f32_32x32x16_bf16 v[72:87], v[160:163], v[68:71], v[72:87]
    s_add_u32 m0, s64, 0
    s_add_u32 s61, s63, 0
    buffer_load_dwordx4 v3, s[4:7], s61 offen sc1 lds
    v_exp_f32 v52, v52
    v_exp_f32 v53, v53
    v_exp_f32 v54, v54
    v_exp_f32 v55, v55
    v_mfma_f32_32x32x8_bf16 v[32:47], v[140:141], v[20:21], v[32:47]
    buffer_load_dwordx4 v3, s[4:7], s61 offen offset:1024 sc1 lds
    v_cvt_pk_bf16_f32 v64, v48, v49
    v_cvt_pk_bf16_f32 v65, v50, v51
    v_cvt_pk_bf16_f32 v66, v52, v53
    v_cvt_pk_bf16_f32 v67, v54, v55
    v_exp_f32 v56, v56
    v_exp_f32 v57, v57
    v_exp_f32 v58, v58
    v_exp_f32 v59, v59
    v_mfma_f32_32x32x16_bf16 v[88:103], v[156:159], v[64:67], v[88:103]
    buffer_load_dwordx4 v3, s[4:7], s61 offen offset:2048 sc1 lds
    v_exp_f32 v60, v60
    v_exp_f32 v61, v61
    v_exp_f32 v62, v62
    v_exp_f32 v63, v63
    v_cvt_pk_bf16_f32 v68, v56, v57
    v_cvt_pk_bf16_f32 v69, v58, v59
    v_cvt_pk_bf16_f32 v70, v60, v61
    v_cvt_pk_bf16_f32 v71, v62, v63
    s_setprio 1
    v_mfma_f32_32x32x16_bf16 v[48:63], v[136:139], v[22:25], v[120:135]
    v_exp_f32 v32, v32
    v_exp_f32 v33, v33
    v_exp_f32 v34, v34
    v_exp_f32 v35, v35
    v_mfma_f32_32x32x16_bf16 v[88:103], v[160:163], v[68:71], v[88:103]
    ds_read_b128 v[142:145], v4 offset:3072
    ds_read_b64 v[146:147], v6 offset:3072
    buffer_load_dwordx4 v3, s[4:7], s61 offen offset:3072 sc1 lds
    v_exp_f32 v36, v36
    v_exp_f32 v37, v37
    v_exp_f32 v38, v38
    v_exp_f32 v39, v39
    v_mfma_f32_32x32x8_bf16 v[48:63], v[140:141], v[26:27], v[48:63]
    ds_read_b128 v[156:159], v5 offset:4096
    s_add_u32 m0, s64, 4096
    s_add_u32 s61, s63, 4096
    buffer_load_dwordx4 v3, s[4:7], s61 offen sc1 lds
    v_cvt_pk_bf16_f32 v64, v32, v33
    v_cvt_pk_bf16_f32 v65, v34, v35
    v_cvt_pk_bf16_f32 v66, v36, v37
    v_cvt_pk_bf16_f32 v67, v38, v39
    v_exp_f32 v40, v40
    v_exp_f32 v41, v41
    v_exp_f32 v42, v42
    v_exp_f32 v43, v43
    v_mfma_f32_32x32x16_bf16 v[72:87], v[148:151], v[64:67], v[72:87]
    ds_read_b128 v[160:163], v4 offset:5120
    buffer_load_dwordx4 v3, s[4:7], s61 offen offset:1024 sc1 lds
    v_exp_f32 v44, v44
    v_exp_f32 v45, v45
    v_exp_f32 v46, v46
    v_exp_f32 v47, v47
    v_cvt_pk_bf16_f32 v68, v40, v41
    v_cvt_pk_bf16_f32 v69, v42, v43
    v_cvt_pk_bf16_f32 v70, v44, v45
    v_cvt_pk_bf16_f32 v71, v46, v47
    s_setprio 0
    s_waitcnt lgkmcnt(0)
    v_mfma_f32_32x32x16_bf16 v[32:47], v[142:145], v[16:19], v[104:119]
    v_exp_f32 v48, v48
    v_exp_f32 v49, v49
    v_exp_f32 v50, v50
    v_exp_f32 v51, v51
    v_mfma_f32_32x32x16_bf16 v[72:87], v[152:155], v[68:71], v[72:87]
    buffer_load_dwordx4 v3, s[4:7], s61 offen offset:2048 sc1 lds
    v_exp_f32 v52, v52
    v_exp_f32 v53, v53
    v_exp_f32 v54, v54
    v_exp_f32 v55, v55
    v_mfma_f32_32x32x8_bf16 v[32:47], v[146:147], v[20:21], v[32:47]
    buffer_load_dwordx4 v3, s[4:7], s61 offen offset:3072 sc1 lds
    v_cvt_pk_bf16_f32 v64, v48, v49
    v_cvt_pk_bf16_f32 v65, v50, v51
    v_cvt_pk_bf16_f32 v66, v52, v53
    v_cvt_pk_bf16_f32 v67, v54, v55
    v_exp_f32 v56, v56
    v_exp_f32 v57, v57
    v_exp_f32 v58, v58
    v_exp_f32 v59, v59
    v_mfma_f32_32x32x16_bf16 v[88:103], v[148:151], v[64:67], v[88:103]
    s_add_u32 m0, s64, 8192
    s_add_u32 s61, s63, 8192
    buffer_load_dwordx4 v3, s[4:7], s61 offen sc1 lds
    v_exp_f32 v60, v60
    v_exp_f32 v61, v61
    v_exp_f32 v62, v62
    v_exp_f32 v63, v63
    v_cvt_pk_bf16_f32 v68, v56, v57
    v_cvt_pk_bf16_f32 v69, v58, v59
    v_cvt_pk_bf16_f32 v70, v60, v61
    v_cvt_pk_bf16_f32 v71, v62, v63
    s_setprio 1
    v_mfma_f32_32x32x16_bf16 v[48:63], v[142:145], v[22:25], v[120:135]
    v_exp_f32 v32, v32
    v_exp_f32 v33, v33
    v_exp_f32 v34, v34
    v_exp_f32 v35, v35
    v_mfma_f32_32x32x16_bf16 v[88:103], v[152:155], v[68:71], v[88:103]
    ds_read_b128 v[136:139], v4 offset:6144
    ds_read_b64 v[140:141], v6 offset:6144
    buffer_load_dwordx4 v3, s[4:7], s61 offen offset:1024 sc1 lds
    v_exp_f32 v36, v36
    v_exp_f32 v37, v37
    v_exp_f32 v38, v38
    v_exp_f32 v39, v39
    v_mfma_f32_32x32x8_bf16 v[48:63], v[146:147], v[26:27], v[48:63]
    ds_read_b128 v[148:151], v5 offset:7168
    buffer_load_dwordx4 v3, s[4:7], s61 offen offset:2048 sc1 lds
    v_cvt_pk_bf16_f32 v64, v32, v33
    v_cvt_pk_bf16_f32 v65, v34, v35
    v_cvt_pk_bf16_f32 v66, v36, v37
    v_cvt_pk_bf16_f32 v67, v38, v39
    v_exp_f32 v40, v40
    v_exp_f32 v41, v41
    v_exp_f32 v42, v42
    v_exp_f32 v43, v43
    v_mfma_f32_32x32x16_bf16 v[72:87], v[156:159], v[64:67], v[72:87]
    ds_read_b128 v[152:155], v4 offset:8192
    buffer_load_dwordx4 v3, s[4:7], s61 offen offset:3072 sc1 lds
    v_exp_f32 v44, v44
    v_exp_f32 v45, v45
    v_exp_f32 v46, v46
    v_exp_f32 v47, v47
    v_cvt_pk_bf16_f32 v68, v40, v41
    v_cvt_pk_bf16_f32 v69, v42, v43
    v_cvt_pk_bf16_f32 v70, v44, v45
    v_cvt_pk_bf16_f32 v71, v46, v47
    s_setprio 0
    s_waitcnt lgkmcnt(0)
    v_mfma_f32_32x32x16_bf16 v[32:47], v[136:139], v[16:19], v[104:119]
    v_exp_f32 v48, v48
    v_exp_f32 v49, v49
    v_exp_f32 v50, v50
    v_exp_f32 v51, v51
    v_mfma_f32_32x32x16_bf16 v[72:87], v[160:163], v[68:71], v[72:87]
    s_add_u32 m0, s64, 12288
    s_add_u32 s61, s63, 12288
    buffer_load_dwordx4 v3, s[4:7], s61 offen sc1 lds
    v_exp_f32 v52, v52
    v_exp_f32 v53, v53
    v_exp_f32 v54, v54
    v_exp_f32 v55, v55
    v_mfma_f32_32x32x8_bf16 v[32:47], v[140:141], v[20:21], v[32:47]
    buffer_load_dwordx4 v3, s[4:7], s61 offen offset:1024 sc1 lds
    v_cvt_pk_bf16_f32 v64, v48, v49
    v_cvt_pk_bf16_f32 v65, v50, v51
    v_cvt_pk_bf16_f32 v66, v52, v53
    v_cvt_pk_bf16_f32 v67, v54, v55
    v_exp_f32 v56, v56
    v_exp_f32 v57, v57
    v_exp_f32 v58, v58
    v_exp_f32 v59, v59
    v_mfma_f32_32x32x16_bf16 v[88:103], v[156:159], v[64:67], v[88:103]
    buffer_load_dwordx4 v3, s[4:7], s61 offen offset:2048 sc1 lds
    v_exp_f32 v60, v60
    v_exp_f32 v61, v61
    v_exp_f32 v62, v62
    v_exp_f32 v63, v63
    v_cvt_pk_bf16_f32 v68, v56, v57
    v_cvt_pk_bf16_f32 v69, v58, v59
    v_cvt_pk_bf16_f32 v70, v60, v61
    v_cvt_pk_bf16_f32 v71, v62, v63
    s_setprio 1
    v_mfma_f32_32x32x16_bf16 v[48:63], v[136:139], v[22:25], v[120:135]
    v_exp_f32 v32, v32
    v_exp_f32 v33, v33
    v_exp_f32 v34, v34
    v_exp_f32 v35, v35
    v_mfma_f32_32x32x16_bf16 v[88:103], v[160:163], v[68:71], v[88:103]
    ds_read_b128 v[142:145], v4 offset:9216
    ds_read_b64 v[146:147], v6 offset:9216
    buffer_load_dwordx4 v3, s[4:7], s61 offen offset:3072 sc1 lds
    v_exp_f32 v36, v36
    v_exp_f32 v37, v37
    v_exp_f32 v38, v38
    v_exp_f32 v39, v39
    v_mfma_f32_32x32x8_bf16 v[48:63], v[140:141], v[26:27], v[48:63]
    ds_read_b128 v[156:159], v5 offset:10240
    s_add_u32 m0, s64, 16384
    s_add_u32 s61, s63, 16384
    buffer_load_dwordx4 v3, s[4:7], s61 offen sc1 lds
    v_cvt_pk_bf16_f32 v64, v32, v33
    v_cvt_pk_bf16_f32 v65, v34, v35
    v_cvt_pk_bf16_f32 v66, v36, v37
    v_cvt_pk_bf16_f32 v67, v38, v39
    v_exp_f32 v40, v40
    v_exp_f32 v41, v41
    v_exp_f32 v42, v42
    v_exp_f32 v43, v43
    v_mfma_f32_32x32x16_bf16 v[72:87], v[148:151], v[64:67], v[72:87]
    ds_read_b128 v[160:163], v4 offset:11264
    buffer_load_dwordx4 v3, s[4:7], s61 offen offset:1024 sc1 lds
    v_exp_f32 v44, v44
    v_exp_f32 v45, v45
    v_exp_f32 v46, v46
    v_exp_f32 v47, v47
    v_cvt_pk_bf16_f32 v68, v40, v41
    v_cvt_pk_bf16_f32 v69, v42, v43
    v_cvt_pk_bf16_f32 v70, v44, v45
    v_cvt_pk_bf16_f32 v71, v46, v47
    s_setprio 0
    s_waitcnt lgkmcnt(0)
    v_mfma_f32_32x32x16_bf16 v[32:47], v[142:145], v[16:19], v[104:119]
    v_exp_f32 v48, v48
    v_exp_f32 v49, v49
    v_exp_f32 v50, v50
    v_exp_f32 v51, v51
    v_mfma_f32_32x32x16_bf16 v[72:87], v[152:155], v[68:71], v[72:87]
    buffer_load_dwordx4 v3, s[4:7], s61 offen offset:2048 sc1 lds
    v_exp_f32 v52, v52
    v_exp_f32 v53, v53
    v_exp_f32 v54, v54
    v_exp_f32 v55, v55
    v_mfma_f32_32x32x8_bf16 v[32:47], v[146:147], v[20:21], v[32:47]
    buffer_load_dwordx4 v3, s[4:7], s61 offen offset:3072 sc1 lds
    v_cvt_pk_bf16_f32 v64, v48, v49
    v_cvt_pk_bf16_f32 v65, v50, v51
    v_cvt_pk_bf16_f32 v66, v52, v53
    v_cvt_pk_bf16_f32 v67, v54, v55
    v_exp_f32 v56, v56
    v_exp_f32 v57, v57
    v_exp_f32 v58, v58
    v_exp_f32 v59, v59
    v_mfma_f32_32x32x16_bf16 v[88:103], v[148:151], v[64:67], v[88:103]
    s_add_u32 m0, s64, 20480
    s_add_u32 s61, s63, 20480
    buffer_load_dwordx4 v3, s[4:7], s61 offen sc1 lds
    v_exp_f32 v60, v60
    v_exp_f32 v61, v61
    v_exp_f32 v62, v62
    v_exp_f32 v63, v63
    v_cvt_pk_bf16_f32 v68, v56, v57
    v_cvt_pk_bf16_f32 v69, v58, v59
    v_cvt_pk_bf16_f32 v70, v60, v61
    v_cvt_pk_bf16_f32 v71, v62, v63
    s_setprio 1
    v_mfma_f32_32x32x16_bf16 v[48:63], v[142:145], v[22:25], v[120:135]
    v_exp_f32 v32, v32
    v_exp_f32 v33, v33
    v_exp_f32 v34, v34
    v_exp_f32 v35, v35
    v_mfma_f32_32x32x16_bf16 v[88:103], v[152:155], v[68:71], v[88:103]
    s_barrier
    ds_read_b128 v[136:139], v4 offset:24576
    ds_read_b64 v[140:141], v6 offset:24576
    buffer_load_dwordx4 v3, s[4:7], s61 offen offset:1024 sc1 lds
    v_exp_f32 v36, v36
    v_exp_f32 v37, v37
    v_exp_f32 v38, v38
    v_exp_f32 v39, v39
    v_mfma_f32_32x32x8_bf16 v[48:63], v[146:147], v[26:27], v[48:63]
    ds_read_b128 v[148:151], v5 offset:25600
    buffer_load_dwordx4 v3, s[4:7], s61 offen offset:2048 sc1 lds
    v_cvt_pk_bf16_f32 v64, v32, v33
    v_cvt_pk_bf16_f32 v65, v34, v35
    v_cvt_pk_bf16_f32 v66, v36, v37
    v_cvt_pk_bf16_f32 v67, v38, v39
    v_exp_f32 v40, v40
    v_exp_f32 v41, v41
    v_exp_f32 v42, v42
    v_exp_f32 v43, v43
    v_mfma_f32_32x32x16_bf16 v[72:87], v[156:159], v[64:67], v[72:87]
    ds_read_b128 v[152:155], v4 offset:26624
    buffer_load_dwordx4 v3, s[4:7], s61 offen offset:3072 sc1 lds
    v_exp_f32 v44, v44
    v_exp_f32 v45, v45
    v_exp_f32 v46, v46
    v_exp_f32 v47, v47
    v_cvt_pk_bf16_f32 v68, v40, v41
    v_cvt_pk_bf16_f32 v69, v42, v43
    v_cvt_pk_bf16_f32 v70, v44, v45
    v_cvt_pk_bf16_f32 v71, v46, v47
    s_setprio 0
    s_waitcnt lgkmcnt(0)
    v_mfma_f32_32x32x16_bf16 v[32:47], v[136:139], v[16:19], v[104:119]
    v_exp_f32 v48, v48
    v_exp_f32 v49, v49
    v_exp_f32 v50, v50
    v_exp_f32 v51, v51
    v_mfma_f32_32x32x16_bf16 v[72:87], v[160:163], v[68:71], v[72:87]
    s_add_u32 m0, s64, 24576
    s_add_u32 s61, s63, 24576
    buffer_load_dwordx4 v3, s[4:7], s61 offen sc1 lds
    v_exp_f32 v52, v52
    v_exp_f32 v53, v53
    v_exp_f32 v54, v54
    v_exp_f32 v55, v55
    v_mfma_f32_32x32x8_bf16 v[32:47], v[140:141], v[20:21], v[32:47]
    v_cvt_pk_bf16_f32 v64, v48, v49
    v_cvt_pk_bf16_f32 v65, v50, v51
    v_cvt_pk_bf16_f32 v66, v52, v53
    v_cvt_pk_bf16_f32 v67, v54, v55
    v_exp_f32 v56, v56
    v_exp_f32 v57, v57
    v_exp_f32 v58, v58
    v_exp_f32 v59, v59
    v_mfma_f32_32x32x16_bf16 v[88:103], v[156:159], v[64:67], v[88:103]
    v_exp_f32 v60, v60
    v_exp_f32 v61, v61
    v_exp_f32 v62, v62
    v_exp_f32 v63, v63
    v_cvt_pk_bf16_f32 v68, v56, v57
    v_cvt_pk_bf16_f32 v69, v58, v59
    v_cvt_pk_bf16_f32 v70, v60, v61
    v_cvt_pk_bf16_f32 v71, v62, v63
    s_setprio 1
    v_mfma_f32_32x32x16_bf16 v[48:63], v[136:139], v[22:25], v[120:135]
    v_exp_f32 v32, v32
    v_exp_f32 v33, v33
    v_exp_f32 v34, v34
    v_exp_f32 v35, v35
    v_mfma_f32_32x32x16_bf16 v[88:103], v[160:163], v[68:71], v[88:103]
    ds_read_b128 v[142:145], v4 offset:27648
    ds_read_b64 v[146:147], v6 offset:27648
    v_exp_f32 v36, v36
    v_exp_f32 v37, v37
    v_exp_f32 v38, v38
    v_exp_f32 v39, v39
    v_mfma_f32_32x32x8_bf16 v[48:63], v[140:141], v[26:27], v[48:63]
    ds_read_b128 v[156:159], v5 offset:28672
    v_cvt_pk_bf16_f32 v64, v32, v33
    v_cvt_pk_bf16_f32 v65, v34, v35
    v_cvt_pk_bf16_f32 v66, v36, v37
    v_cvt_pk_bf16_f32 v67, v38, v39
    v_exp_f32 v40, v40
    v_exp_f32 v41, v41
    v_exp_f32 v42, v42
    v_exp_f32 v43, v43
    v_mfma_f32_32x32x16_bf16 v[72:87], v[148:151], v[64:67], v[72:87]
    ds_read_b128 v[160:163], v4 offset:29696
    v_exp_f32 v44, v44
    v_exp_f32 v45, v45
    v_exp_f32 v46, v46
    v_exp_f32 v47, v47
    s_lshr_b32 s60, s71, 2
    s_mul_i32 s60, s60, 1032192
    s_and_b32 s61, s27, 31
    s_lshl_b32 s61, s61, 2
    s_add_u32 s61, s61, s29
    s_mul_i32 s61, s61, 8064
    s_add_u32 s60, s60, s61
    s_add_u32 s60, s60, 9437184
    v_lshlrev_b32 v10, 7, v2
    buffer_load_dword v172, v10, s[4:7], s60 offen sc1
    v_cvt_pk_bf16_f32 v68, v40, v41
    v_cvt_pk_bf16_f32 v69, v42, v43
    v_cvt_pk_bf16_f32 v70, v44, v45
    v_cvt_pk_bf16_f32 v71, v46, v47
    s_setprio 0
    s_waitcnt lgkmcnt(0)
    v_mfma_f32_32x32x16_bf16 v[32:47], v[142:145], v[16:19], v[104:119]
    v_exp_f32 v48, v48
    v_exp_f32 v49, v49
    v_exp_f32 v50, v50
    v_exp_f32 v51, v51
    v_mfma_f32_32x32x16_bf16 v[72:87], v[152:155], v[68:71], v[72:87]
    v_exp_f32 v52, v52
    v_exp_f32 v53, v53
    v_exp_f32 v54, v54
    v_exp_f32 v55, v55
    v_mfma_f32_32x32x8_bf16 v[32:47], v[146:147], v[20:21], v[32:47]
    v_cvt_pk_bf16_f32 v64, v48, v49
    v_cvt_pk_bf16_f32 v65, v50, v51
    v_cvt_pk_bf16_f32 v66, v52, v53
    v_cvt_pk_bf16_f32 v67, v54, v55
    v_exp_f32 v56, v56
    v_exp_f32 v57, v57
    v_exp_f32 v58, v58
    v_exp_f32 v59, v59
    v_mfma_f32_32x32x16_bf16 v[88:103], v[148:151], v[64:67], v[88:103]
    v_exp_f32 v60, v60
    v_exp_f32 v61, v61
    v_exp_f32 v62, v62
    v_exp_f32 v63, v63
    v_cvt_pk_bf16_f32 v68, v56, v57
    v_cvt_pk_bf16_f32 v69, v58, v59
    v_cvt_pk_bf16_f32 v70, v60, v61
    v_cvt_pk_bf16_f32 v71, v62, v63
    s_setprio 1
    v_mfma_f32_32x32x16_bf16 v[48:63], v[142:145], v[22:25], v[120:135]
    v_exp_f32 v32, v32
    v_exp_f32 v33, v33
    v_exp_f32 v34, v34
    v_exp_f32 v35, v35
    v_mfma_f32_32x32x16_bf16 v[88:103], v[152:155], v[68:71], v[88:103]
    ds_read_b128 v[136:139], v4 offset:30720
    ds_read_b64 v[140:141], v6 offset:30720
    v_exp_f32 v36, v36
    v_exp_f32 v37, v37
    v_exp_f32 v38, v38
    v_exp_f32 v39, v39
    v_mfma_f32_32x32x8_bf16 v[48:63], v[146:147], v[26:27], v[48:63]
    ds_read_b128 v[148:151], v5 offset:31744
    v_cvt_pk_bf16_f32 v64, v32, v33
    v_cvt_pk_bf16_f32 v65, v34, v35
    v_cvt_pk_bf16_f32 v66, v36, v37
    v_cvt_pk_bf16_f32 v67, v38, v39
    v_exp_f32 v40, v40
    v_exp_f32 v41, v41
    v_exp_f32 v42, v42
    v_exp_f32 v43, v43
    v_mfma_f32_32x32x16_bf16 v[72:87], v[156:159], v[64:67], v[72:87]
    ds_read_b128 v[152:155], v4 offset:32768
    v_exp_f32 v44, v44
    v_exp_f32 v45, v45
    v_exp_f32 v46, v46
    v_exp_f32 v47, v47
    v_cvt_pk_bf16_f32 v68, v40, v41
    v_cvt_pk_bf16_f32 v69, v42, v43
    v_cvt_pk_bf16_f32 v70, v44, v45
    v_cvt_pk_bf16_f32 v71, v46, v47
    s_setprio 0
    s_waitcnt lgkmcnt(0)
    v_mfma_f32_32x32x16_bf16 v[32:47], v[136:139], v[16:19], v[104:119]
    v_exp_f32 v48, v48
    v_exp_f32 v49, v49
    v_exp_f32 v50, v50
    v_exp_f32 v51, v51
    v_mfma_f32_32x32x16_bf16 v[72:87], v[160:163], v[68:71], v[72:87]
    v_exp_f32 v52, v52
    v_exp_f32 v53, v53
    v_exp_f32 v54, v54
    v_exp_f32 v55, v55
    v_mfma_f32_32x32x8_bf16 v[32:47], v[140:141], v[20:21], v[32:47]
    v_cvt_pk_bf16_f32 v64, v48, v49
    v_cvt_pk_bf16_f32 v65, v50, v51
    v_cvt_pk_bf16_f32 v66, v52, v53
    v_cvt_pk_bf16_f32 v67, v54, v55
    v_exp_f32 v56, v56
    v_exp_f32 v57, v57
    v_exp_f32 v58, v58
    v_exp_f32 v59, v59
    v_mfma_f32_32x32x16_bf16 v[88:103], v[156:159], v[64:67], v[88:103]
    v_exp_f32 v60, v60
    v_exp_f32 v61, v61
    v_exp_f32 v62, v62
    v_exp_f32 v63, v63
    v_cvt_pk_bf16_f32 v68, v56, v57
    v_cvt_pk_bf16_f32 v69, v58, v59
    v_cvt_pk_bf16_f32 v70, v60, v61
    v_cvt_pk_bf16_f32 v71, v62, v63
    s_setprio 1
    v_mfma_f32_32x32x16_bf16 v[48:63], v[136:139], v[22:25], v[120:135]
    v_exp_f32 v32, v32
    v_exp_f32 v33, v33
    v_exp_f32 v34, v34
    v_exp_f32 v35, v35
    v_mfma_f32_32x32x16_bf16 v[88:103], v[160:163], v[68:71], v[88:103]
    ds_read_b128 v[142:145], v4 offset:33792
    ds_read_b64 v[146:147], v6 offset:33792
    v_exp_f32 v36, v36
    v_exp_f32 v37, v37
    v_exp_f32 v38, v38
    v_exp_f32 v39, v39
    v_mfma_f32_32x32x8_bf16 v[48:63], v[140:141], v[26:27], v[48:63]
    ds_read_b128 v[156:159], v5 offset:34816
    v_cvt_pk_bf16_f32 v64, v32, v33
    v_cvt_pk_bf16_f32 v65, v34, v35
    v_cvt_pk_bf16_f32 v66, v36, v37
    v_cvt_pk_bf16_f32 v67, v38, v39
    v_exp_f32 v40, v40
    v_exp_f32 v41, v41
    v_exp_f32 v42, v42
    v_exp_f32 v43, v43
    v_mfma_f32_32x32x16_bf16 v[72:87], v[148:151], v[64:67], v[72:87]
    ds_read_b128 v[160:163], v4 offset:35840
    v_exp_f32 v44, v44
    v_exp_f32 v45, v45
    v_exp_f32 v46, v46
    v_exp_f32 v47, v47
    v_cvt_pk_bf16_f32 v68, v40, v41
    v_cvt_pk_bf16_f32 v69, v42, v43
    v_cvt_pk_bf16_f32 v70, v44, v45
    v_cvt_pk_bf16_f32 v71, v46, v47
    s_setprio 0
    s_waitcnt lgkmcnt(0)
    v_mfma_f32_32x32x16_bf16 v[32:47], v[142:145], v[16:19], v[104:119]
    v_exp_f32 v48, v48
    v_exp_f32 v49, v49
    v_exp_f32 v50, v50
    v_exp_f32 v51, v51
    v_mfma_f32_32x32x16_bf16 v[72:87], v[152:155], v[68:71], v[72:87]
    v_exp_f32 v52, v52
    v_exp_f32 v53, v53
    v_exp_f32 v54, v54
    v_exp_f32 v55, v55
    v_mfma_f32_32x32x8_bf16 v[32:47], v[146:147], v[20:21], v[32:47]
    v_cvt_pk_bf16_f32 v64, v48, v49
    v_cvt_pk_bf16_f32 v65, v50, v51
    v_cvt_pk_bf16_f32 v66, v52, v53
    v_cvt_pk_bf16_f32 v67, v54, v55
    v_exp_f32 v56, v56
    v_exp_f32 v57, v57
    v_exp_f32 v58, v58
    v_exp_f32 v59, v59
    v_mfma_f32_32x32x16_bf16 v[88:103], v[148:151], v[64:67], v[88:103]
    v_exp_f32 v60, v60
    v_exp_f32 v61, v61
    v_exp_f32 v62, v62
    v_exp_f32 v63, v63
    v_cvt_pk_bf16_f32 v68, v56, v57
    v_cvt_pk_bf16_f32 v69, v58, v59
    v_cvt_pk_bf16_f32 v70, v60, v61
    v_cvt_pk_bf16_f32 v71, v62, v63
    s_setprio 1
    v_mfma_f32_32x32x16_bf16 v[48:63], v[142:145], v[22:25], v[120:135]
    v_exp_f32 v32, v32
    v_exp_f32 v33, v33
    v_exp_f32 v34, v34
    v_exp_f32 v35, v35
    v_mfma_f32_32x32x16_bf16 v[88:103], v[152:155], v[68:71], v[88:103]
    v_exp_f32 v36, v36
    v_exp_f32 v37, v37
    v_exp_f32 v38, v38
    v_exp_f32 v39, v39
    v_mfma_f32_32x32x8_bf16 v[48:63], v[146:147], v[26:27], v[48:63]
    v_cvt_pk_bf16_f32 v64, v32, v33
    v_cvt_pk_bf16_f32 v65, v34, v35
    v_cvt_pk_bf16_f32 v66, v36, v37
    v_cvt_pk_bf16_f32 v67, v38, v39
    v_exp_f32 v40, v40
    v_exp_f32 v41, v41
    v_exp_f32 v42, v42
    v_exp_f32 v43, v43
    v_mfma_f32_32x32x16_bf16 v[72:87], v[156:159], v[64:67], v[72:87]
    v_exp_f32 v44, v44
    v_exp_f32 v45, v45
    v_exp_f32 v46, v46
    v_exp_f32 v47, v47
    v_cvt_pk_bf16_f32 v68, v40, v41
    v_cvt_pk_bf16_f32 v69, v42, v43
    v_cvt_pk_bf16_f32 v70, v44, v45
    v_cvt_pk_bf16_f32 v71, v46, v47
    s_setprio 0
    v_exp_f32 v48, v48
    v_exp_f32 v49, v49
    v_exp_f32 v50, v50
    v_exp_f32 v51, v51
    v_mfma_f32_32x32x16_bf16 v[72:87], v[160:163], v[68:71], v[72:87]
    v_exp_f32 v52, v52
    v_exp_f32 v53, v53
    v_exp_f32 v54, v54
    v_exp_f32 v55, v55
    s_nop 0
    v_cvt_pk_bf16_f32 v64, v48, v49
    v_cvt_pk_bf16_f32 v65, v50, v51
    v_cvt_pk_bf16_f32 v66, v52, v53
    v_cvt_pk_bf16_f32 v67, v54, v55
    v_exp_f32 v56, v56
    v_exp_f32 v57, v57
    v_exp_f32 v58, v58
    v_exp_f32 v59, v59
    v_mfma_f32_32x32x16_bf16 v[88:103], v[156:159], v[64:67], v[88:103]
    v_exp_f32 v60, v60
    v_exp_f32 v61, v61
    v_exp_f32 v62, v62
    v_exp_f32 v63, v63
    v_cvt_pk_bf16_f32 v68, v56, v57
    v_cvt_pk_bf16_f32 v69, v58, v59
    v_cvt_pk_bf16_f32 v70, v60, v61
    v_cvt_pk_bf16_f32 v71, v62, v63
    s_nop 0
    v_mfma_f32_32x32x16_bf16 v[88:103], v[160:163], v[68:71], v[88:103]
L_att_done:
    s_setprio 0
    s_mul_i32 s60, s24, 3072
    s_xor_b32 s61, s24, 4
    s_mul_i32 s61, s61, 3072
    v_add_u32 v10, s60, v3
    v_add_u32 v11, s61, v3
    s_lshl_b32 s62, s25, 1
    s_add_u32 s62, s62, s28
    s_lshl_b32 s35, s25, 7
    s_lshl_b32 s63, s26, 2
    s_add_u32 s35, s35, s63
    s_add_u32 s35, s35, 335872
    s_mul_i32 s62, s62, 40960
    s_add_u32 s62, s62, 1048576
    s_lshl_b32 s63, s30, 9
    s_add_u32 s63, s63, s62
    s_lshr_b32 s64, s30, 3
    s_add_u32 s64, s64, 16
    s_lshl_b32 s64, s64, 10
    s_add_u32 s64, s64, s62
    s_bfe_u32 s65, s30, 0x20001
    s_lshl_b32 s65, s65, 8
    s_add_u32 s64, s64, s65
    s_and_b32 s65, s30, 1
    s_lshl_b32 s65, s65, 3
    s_add_u32 s64, s64, s65
    v_lshrrev_b32 v12, 4, v9
    v_mul_u32_u24 v12, 20480, v12
    v_and_b32 v13, 15, v9
    v_lshl_add_u32 v12, v13, 4, v12
    v_lshl_add_u32 v13, v8, 8, v12
    v_lshl_add_u32 v12, v8, 30, v12
    ds_write_b128 v10, v[88:91] offset:0
    ds_write_b128 v10, v[92:95] offset:1024
    ds_write_b128 v10, v[96:99] offset:2048
    s_waitcnt lgkmcnt(0)
    s_barrier
    ds_read_b128 v[176:179], v11 offset:0
    ds_read_b128 v[180:183], v11 offset:1024
    ds_read_b128 v[184:187], v11 offset:2048
    s_waitcnt lgkmcnt(0)
    v_add_f32 v72, v72, v176
    v_add_f32 v73, v73, v177
    v_add_f32 v74, v74, v178
    v_add_f32 v75, v75, v179
    v_add_f32 v76, v76, v180
    v_add_f32 v77, v77, v181
    v_add_f32 v78, v78, v182
    v_add_f32 v79, v79, v183
    v_add_f32 v80, v80, v184
    v_add_f32 v81, v81, v185
    v_add_f32 v82, v82, v186
    v_add_f32 v83, v83, v187
    v_mov_b32 v14, v80
    v_mov_b32 v15, v80
    s_nop 1
    v_permlane32_swap_b32 v14, v15
    s_nop 1
    v_rcp_f32 v15, v15
    s_nop 0
    v_mul_f32 v72, v72, v15
    v_mul_f32 v73, v73, v15
    v_mul_f32 v74, v74, v15
    v_mul_f32 v75, v75, v15
    v_mul_f32 v76, v76, v15
    v_mul_f32 v77, v77, v15
    v_mul_f32 v78, v78, v15
    v_mul_f32 v79, v79, v15
    v_mul_f32 v80, v80, v15
    v_mul_f32 v81, v81, v15
    v_mul_f32 v82, v82, v15
    v_mul_f32 v83, v83, v15
    v_cvt_pk_bf16_f32 v164, v72, v73
    v_cvt_pk_bf16_f32 v165, v74, v75
    v_cvt_pk_bf16_f32 v166, v76, v77
    v_cvt_pk_bf16_f32 v167, v78, v79
    v_cvt_pk_bf16_f32 v168, v80, v81
    v_cvt_pk_bf16_f32 v169, v82, v83
    buffer_store_dwordx4 v[164:167], v13, s[4:7], s63 offen sc1
    buffer_store_dwordx2 v[168:169], v12, s[4:7], s64 offen sc1
    s_waitcnt vmcnt(0)
    s_cmp_lg_u32 s24, 0
    v_mov_b32 v10, 0
    v_mov_b32 v12, 1
    s_cselect_b32 s60, 0, 1
    s_barrier
    s_mov_b32 exec_lo, s60
    s_mov_b32 exec_hi, 0
    buffer_store_dword v12, v10, s[4:7], s35 offen sc1
    s_mov_b64 exec, -1
    s_cmp_ge_u32 s24, 4
    s_cbranch_scc1 L_loader
    v_lshrrev_b32 v4, 4, v2
    v_and_b32 v5, 15, v2
    v_lshlrev_b32 v6, 2, v2
    s_lshl_b32 s34, s25, 2
    s_add_u32 s34, s34, s24
    s_lshl_b32 s62, s25, 7
    s_add_u32 s62, s62, 335872
    s_mul_i32 s63, s34, 20480
    s_add_u32 s46, s63, 1048576
    v_add_u32 v7, 49152, v3
    v_add_u32 v8, 100352, v3
    s_barrier
    s_mov_b32 s69, s46
    buffer_load_dwordx4 v[16:19], v3, s[4:7], s46 offen sc1
    buffer_load_dwordx4 v[20:23], v3, s[4:7], s46 offen offset:1024 sc1
    buffer_load_dwordx4 v[24:27], v3, s[4:7], s46 offen offset:2048 sc1
    buffer_load_dwordx4 v[28:31], v3, s[4:7], s46 offen offset:3072 sc1
    s_add_u32 s46, s46, 4096
    buffer_load_dwordx4 v[32:35], v3, s[4:7], s46 offen sc1
    buffer_load_dwordx4 v[36:39], v3, s[4:7], s46 offen offset:1024 sc1
    ds_read_b128 v[96:99], v7 offset:0
    ds_read_b128 v[100:103], v7 offset:1024
    ds_read_b128 v[104:107], v7 offset:2048
    ds_read_b128 v[108:111], v7 offset:3072
    ds_read_b128 v[112:115], v7 offset:4096
    ds_read_b128 v[116:119], v7 offset:5120
    ds_read_b128 v[120:123], v7 offset:6144
    ds_read_b128 v[124:127], v7 offset:7168
    ds_read_b128 v[128:131], v7 offset:8192
    s_waitcnt vmcnt(5)
    s_waitcnt lgkmcnt(7)
    v_mfma_f32_16x16x32_bf16 v[148:151], v[96:99], v[16:19], 0
    ds_read_b128 v[132:135], v7 offset:9216
    v_mfma_f32_16x16x32_bf16 v[152:155], v[100:103], v[16:19], 0
    ds_read_b128 v[96:99], v7 offset:10240
    buffer_load_dwordx4 v[40:43], v3, s[4:7], s46 offen offset:2048 sc1
    s_waitcnt lgkmcnt(7)
    v_mfma_f32_16x16x32_bf16 v[156:159], v[104:107], v[16:19], 0
    ds_read_b128 v[100:103], v7 offset:11264
    v_mfma_f32_16x16x32_bf16 v[160:163], v[108:111], v[16:19], 0
    ds_read_b128 v[104:107], v7 offset:12288
    s_waitcnt lgkmcnt(7)
    v_mfma_f32_16x16x32_bf16 v[164:167], v[112:115], v[16:19], 0
    ds_read_b128 v[108:111], v7 offset:13312
    buffer_load_dwordx4 v[44:47], v3, s[4:7], s46 offen offset:3072 sc1
    s_waitcnt vmcnt(6)
    v_mfma_f32_16x16x32_bf16 v[148:151], v[116:119], v[20:23], v[148:151]
    ds_read_b128 v[112:115], v7 offset:14336
    s_waitcnt lgkmcnt(7)
    v_mfma_f32_16x16x32_bf16 v[152:155], v[120:123], v[20:23], v[152:155]
    ds_read_b128 v[116:119], v7 offset:15360
    s_add_u32 s46, s46, 4096
    buffer_load_dwordx4 v[48:51], v3, s[4:7], s46 offen sc1
    v_mfma_f32_16x16x32_bf16 v[156:159], v[124:127], v[20:23], v[156:159]
    ds_read_b128 v[120:123], v7 offset:16384
    s_waitcnt lgkmcnt(7)
    v_mfma_f32_16x16x32_bf16 v[160:163], v[128:131], v[20:23], v[160:163]
    ds_read_b128 v[124:127], v7 offset:17408
    v_mfma_f32_16x16x32_bf16 v[164:167], v[132:135], v[20:23], v[164:167]
    ds_read_b128 v[128:131], v7 offset:18432
    buffer_load_dwordx4 v[52:55], v3, s[4:7], s46 offen offset:1024 sc1
    s_waitcnt vmcnt(7)
    s_waitcnt lgkmcnt(7)
    v_mfma_f32_16x16x32_bf16 v[148:151], v[96:99], v[24:27], v[148:151]
    ds_read_b128 v[132:135], v7 offset:19456
    v_mfma_f32_16x16x32_bf16 v[152:155], v[100:103], v[24:27], v[152:155]
    ds_read_b128 v[96:99], v7 offset:20480
    buffer_load_dwordx4 v[56:59], v3, s[4:7], s46 offen offset:2048 sc1
    s_waitcnt lgkmcnt(7)
    v_mfma_f32_16x16x32_bf16 v[156:159], v[104:107], v[24:27], v[156:159]
    ds_read_b128 v[100:103], v7 offset:21504
    v_mfma_f32_16x16x32_bf16 v[160:163], v[108:111], v[24:27], v[160:163]
    ds_read_b128 v[104:107], v7 offset:22528
    s_waitcnt lgkmcnt(7)
    v_mfma_f32_16x16x32_bf16 v[164:167], v[112:115], v[24:27], v[164:167]
    ds_read_b128 v[108:111], v7 offset:23552
    buffer_load_dwordx4 v[60:63], v3, s[4:7], s46 offen offset:3072 sc1
    s_waitcnt vmcnt(8)
    v_mfma_f32_16x16x32_bf16 v[148:151], v[116:119], v[28:31], v[148:151]
    ds_read_b128 v[112:115], v7 offset:24576
    s_waitcnt lgkmcnt(7)
    v_mfma_f32_16x16x32_bf16 v[152:155], v[120:123], v[28:31], v[152:155]
    ds_read_b128 v[116:119], v7 offset:25600
    s_add_u32 s46, s46, 4096
    buffer_load_dwordx4 v[64:67], v3, s[4:7], s46 offen sc1
    v_mfma_f32_16x16x32_bf16 v[156:159], v[124:127], v[28:31], v[156:159]
    ds_read_b128 v[120:123], v7 offset:26624
    s_waitcnt lgkmcnt(7)
    v_mfma_f32_16x16x32_bf16 v[160:163], v[128:131], v[28:31], v[160:163]
    ds_read_b128 v[124:127], v7 offset:27648
    v_mfma_f32_16x16x32_bf16 v[164:167], v[132:135], v[28:31], v[164:167]
    ds_read_b128 v[128:131], v7 offset:28672
    buffer_load_dwordx4 v[68:71], v3, s[4:7], s46 offen offset:1024 sc1
    s_waitcnt vmcnt(9)
    s_waitcnt lgkmcnt(7)
    v_mfma_f32_16x16x32_bf16 v[148:151], v[96:99], v[32:35], v[148:151]
    ds_read_b128 v[132:135], v7 offset:29696
    v_mfma_f32_16x16x32_bf16 v[152:155], v[100:103], v[32:35], v[152:155]
    ds_read_b128 v[96:99], v7 offset:30720
    buffer_load_dwordx4 v[72:75], v3, s[4:7], s46 offen offset:2048 sc1
    s_waitcnt lgkmcnt(7)
    v_mfma_f32_16x16x32_bf16 v[156:159], v[104:107], v[32:35], v[156:159]
    ds_read_b128 v[100:103], v7 offset:31744
    v_mfma_f32_16x16x32_bf16 v[160:163], v[108:111], v[32:35], v[160:163]
    ds_read_b128 v[104:107], v7 offset:32768
    s_waitcnt lgkmcnt(7)
    v_mfma_f32_16x16x32_bf16 v[164:167], v[112:115], v[32:35], v[164:167]
    ds_read_b128 v[108:111], v7 offset:33792
    buffer_load_dwordx4 v[76:79], v3, s[4:7], s46 offen offset:3072 sc1
    s_waitcnt vmcnt(10)
    v_mfma_f32_16x16x32_bf16 v[148:151], v[116:119], v[36:39], v[148:151]
    ds_read_b128 v[112:115], v7 offset:34816
    s_waitcnt lgkmcnt(7)
    v_mfma_f32_16x16x32_bf16 v[152:155], v[120:123], v[36:39], v[152:155]
    ds_read_b128 v[116:119], v7 offset:35840
    s_add_u32 s46, s46, 4096
    buffer_load_dwordx4 v[80:83], v3, s[4:7], s46 offen sc1
    v_mfma_f32_16x16x32_bf16 v[156:159], v[124:127], v[36:39], v[156:159]
    ds_read_b128 v[120:123], v7 offset:36864
    s_waitcnt lgkmcnt(7)
    v_mfma_f32_16x16x32_bf16 v[160:163], v[128:131], v[36:39], v[160:163]
    ds_read_b128 v[124:127], v7 offset:37888
    v_mfma_f32_16x16x32_bf16 v[164:167], v[132:135], v[36:39], v[164:167]
    ds_read_b128 v[128:131], v7 offset:38912
    buffer_load_dwordx4 v[84:87], v3, s[4:7], s46 offen offset:1024 sc1
    s_waitcnt vmcnt(11)
    s_waitcnt lgkmcnt(7)
    v_mfma_f32_16x16x32_bf16 v[148:151], v[96:99], v[40:43], v[148:151]
    ds_read_b128 v[132:135], v7 offset:39936
    v_mfma_f32_16x16x32_bf16 v[152:155], v[100:103], v[40:43], v[152:155]
    ds_read_b128 v[96:99], v7 offset:40960
    buffer_load_dwordx4 v[88:91], v3, s[4:7], s46 offen offset:2048 sc1
    s_waitcnt lgkmcnt(7)
    v_mfma_f32_16x16x32_bf16 v[156:159], v[104:107], v[40:43], v[156:159]
    ds_read_b128 v[100:103], v7 offset:41984
    v_mfma_f32_16x16x32_bf16 v[160:163], v[108:111], v[40:43], v[160:163]
    ds_read_b128 v[104:107], v7 offset:43008
    s_waitcnt lgkmcnt(7)
    v_mfma_f32_16x16x32_bf16 v[164:167], v[112:115], v[40:43], v[164:167]
    ds_read_b128 v[108:111], v7 offset:44032
    buffer_load_dwordx4 v[92:95], v3, s[4:7], s46 offen offset:3072 sc1
    s_waitcnt vmcnt(12)
    v_mfma_f32_16x16x32_bf16 v[148:151], v[116:119], v[44:47], v[148:151]
    ds_read_b128 v[112:115], v7 offset:45056
    s_waitcnt lgkmcnt(7)
    v_mfma_f32_16x16x32_bf16 v[152:155], v[120:123], v[44:47], v[152:155]
    ds_read_b128 v[116:119], v7 offset:46080
    v_mfma_f32_16x16x32_bf16 v[156:159], v[124:127], v[44:47], v[156:159]
    ds_read_b128 v[120:123], v7 offset:47104
    s_waitcnt lgkmcnt(7)
    v_mfma_f32_16x16x32_bf16 v[160:163], v[128:131], v[44:47], v[160:163]
    ds_read_b128 v[124:127], v7 offset:48128
    v_mfma_f32_16x16x32_bf16 v[164:167], v[132:135], v[44:47], v[164:167]
    ds_read_b128 v[128:131], v7 offset:49152
    s_waitcnt vmcnt(11)
    s_waitcnt lgkmcnt(7)
    v_mfma_f32_16x16x32_bf16 v[148:151], v[96:99], v[48:51], v[148:151]
    ds_read_b128 v[132:135], v7 offset:50176
    v_mfma_f32_16x16x32_bf16 v[152:155], v[100:103], v[48:51], v[152:155]
    ds_read_b128 v[96:99], v8 offset:0
    s_waitcnt lgkmcnt(7)
    v_mfma_f32_16x16x32_bf16 v[156:159], v[104:107], v[48:51], v[156:159]
    ds_read_b128 v[100:103], v8 offset:1024
    v_mfma_f32_16x16x32_bf16 v[160:163], v[108:111], v[48:51], v[160:163]
    ds_read_b128 v[104:107], v8 offset:2048
    s_waitcnt lgkmcnt(7)
    v_mfma_f32_16x16x32_bf16 v[164:167], v[112:115], v[48:51], v[164:167]
    ds_read_b128 v[108:111], v8 offset:3072
    s_waitcnt vmcnt(10)
    v_mfma_f32_16x16x32_bf16 v[148:151], v[116:119], v[52:55], v[148:151]
    ds_read_b128 v[112:115], v8 offset:4096
    s_waitcnt lgkmcnt(7)
    v_mfma_f32_16x16x32_bf16 v[152:155], v[120:123], v[52:55], v[152:155]
    ds_read_b128 v[116:119], v8 offset:5120
    v_mfma_f32_16x16x32_bf16 v[156:159], v[124:127], v[52:55], v[156:159]
    ds_read_b128 v[120:123], v8 offset:6144
    s_waitcnt lgkmcnt(7)
    v_mfma_f32_16x16x32_bf16 v[160:163], v[128:131], v[52:55], v[160:163]
    ds_read_b128 v[124:127], v8 offset:7168
    v_mfma_f32_16x16x32_bf16 v[164:167], v[132:135], v[52:55], v[164:167]
    ds_read_b128 v[128:131], v8 offset:8192
    s_waitcnt vmcnt(9)
    s_waitcnt lgkmcnt(7)
    v_mfma_f32_16x16x32_bf16 v[148:151], v[96:99], v[56:59], v[148:151]
    ds_read_b128 v[132:135], v8 offset:9216
    v_mfma_f32_16x16x32_bf16 v[152:155], v[100:103], v[56:59], v[152:155]
    ds_read_b128 v[96:99], v8 offset:10240
    s_waitcnt lgkmcnt(7)
    v_mfma_f32_16x16x32_bf16 v[156:159], v[104:107], v[56:59], v[156:159]
    ds_read_b128 v[100:103], v8 offset:11264
    v_mfma_f32_16x16x32_bf16 v[160:163], v[108:111], v[56:59], v[160:163]
    ds_read_b128 v[104:107], v8 offset:12288
    s_waitcnt lgkmcnt(7)
    v_mfma_f32_16x16x32_bf16 v[164:167], v[112:115], v[56:59], v[164:167]
    ds_read_b128 v[108:111], v8 offset:13312
    s_waitcnt vmcnt(8)
    v_mfma_f32_16x16x32_bf16 v[148:151], v[116:119], v[60:63], v[148:151]
    ds_read_b128 v[112:115], v8 offset:14336
    s_waitcnt lgkmcnt(7)
    v_mfma_f32_16x16x32_bf16 v[152:155], v[120:123], v[60:63], v[152:155]
    ds_read_b128 v[116:119], v8 offset:15360
    v_mfma_f32_16x16x32_bf16 v[156:159], v[124:127], v[60:63], v[156:159]
    ds_read_b128 v[120:123], v8 offset:16384
    s_waitcnt lgkmcnt(7)
    v_mfma_f32_16x16x32_bf16 v[160:163], v[128:131], v[60:63], v[160:163]
    ds_read_b128 v[124:127], v8 offset:17408
    v_mfma_f32_16x16x32_bf16 v[164:167], v[132:135], v[60:63], v[164:167]
    ds_read_b128 v[128:131], v8 offset:18432
    s_waitcnt vmcnt(7)
    s_waitcnt lgkmcnt(7)
    v_mfma_f32_16x16x32_bf16 v[148:151], v[96:99], v[64:67], v[148:151]
    ds_read_b128 v[132:135], v8 offset:19456
    v_mfma_f32_16x16x32_bf16 v[152:155], v[100:103], v[64:67], v[152:155]
    ds_read_b128 v[96:99], v8 offset:20480
    s_waitcnt lgkmcnt(7)
    v_mfma_f32_16x16x32_bf16 v[156:159], v[104:107], v[64:67], v[156:159]
    ds_read_b128 v[100:103], v8 offset:21504
    v_mfma_f32_16x16x32_bf16 v[160:163], v[108:111], v[64:67], v[160:163]
    ds_read_b128 v[104:107], v8 offset:22528
    s_waitcnt lgkmcnt(7)
    v_mfma_f32_16x16x32_bf16 v[164:167], v[112:115], v[64:67], v[164:167]
    ds_read_b128 v[108:111], v8 offset:23552
    s_waitcnt vmcnt(6)
    v_mfma_f32_16x16x32_bf16 v[148:151], v[116:119], v[68:71], v[148:151]
    ds_read_b128 v[112:115], v8 offset:24576
    s_waitcnt lgkmcnt(7)
    v_mfma_f32_16x16x32_bf16 v[152:155], v[120:123], v[68:71], v[152:155]
    ds_read_b128 v[116:119], v8 offset:25600
    v_mfma_f32_16x16x32_bf16 v[156:159], v[124:127], v[68:71], v[156:159]
    ds_read_b128 v[120:123], v8 offset:26624
    s_waitcnt lgkmcnt(7)
    v_mfma_f32_16x16x32_bf16 v[160:163], v[128:131], v[68:71], v[160:163]
    ds_read_b128 v[124:127], v8 offset:27648
    v_mfma_f32_16x16x32_bf16 v[164:167], v[132:135], v[68:71], v[164:167]
    ds_read_b128 v[128:131], v8 offset:28672
    s_waitcnt vmcnt(5)
    s_waitcnt lgkmcnt(7)
    v_mfma_f32_16x16x32_bf16 v[148:151], v[96:99], v[72:75], v[148:151]
    ds_read_b128 v[132:135], v8 offset:29696
    v_mfma_f32_16x16x32_bf16 v[152:155], v[100:103], v[72:75], v[152:155]
    ds_read_b128 v[96:99], v8 offset:30720
    s_waitcnt lgkmcnt(7)
    v_mfma_f32_16x16x32_bf16 v[156:159], v[104:107], v[72:75], v[156:159]
    ds_read_b128 v[100:103], v8 offset:31744
    v_mfma_f32_16x16x32_bf16 v[160:163], v[108:111], v[72:75], v[160:163]
    ds_read_b128 v[104:107], v8 offset:32768
    s_waitcnt lgkmcnt(7)
    v_mfma_f32_16x16x32_bf16 v[164:167], v[112:115], v[72:75], v[164:167]
    ds_read_b128 v[108:111], v8 offset:33792
    s_waitcnt vmcnt(4)
    v_mfma_f32_16x16x32_bf16 v[148:151], v[116:119], v[76:79], v[148:151]
    ds_read_b128 v[112:115], v8 offset:34816
    s_waitcnt lgkmcnt(7)
    v_mfma_f32_16x16x32_bf16 v[152:155], v[120:123], v[76:79], v[152:155]
    ds_read_b128 v[116:119], v8 offset:35840
    v_mfma_f32_16x16x32_bf16 v[156:159], v[124:127], v[76:79], v[156:159]
    ds_read_b128 v[120:123], v8 offset:36864
    s_waitcnt lgkmcnt(7)
    v_mfma_f32_16x16x32_bf16 v[160:163], v[128:131], v[76:79], v[160:163]
    ds_read_b128 v[124:127], v8 offset:37888
    v_mfma_f32_16x16x32_bf16 v[164:167], v[132:135], v[76:79], v[164:167]
    ds_read_b128 v[128:131], v8 offset:38912
    s_waitcnt vmcnt(3)
    s_waitcnt lgkmcnt(7)
    v_mfma_f32_16x16x32_bf16 v[148:151], v[96:99], v[80:83], v[148:151]
    ds_read_b128 v[132:135], v8 offset:39936
    v_mfma_f32_16x16x32_bf16 v[152:155], v[100:103], v[80:83], v[152:155]
    ds_read_b128 v[96:99], v8 offset:40960
    s_waitcnt lgkmcnt(7)
    v_mfma_f32_16x16x32_bf16 v[156:159], v[104:107], v[80:83], v[156:159]
    ds_read_b128 v[100:103], v8 offset:41984
    v_mfma_f32_16x16x32_bf16 v[160:163], v[108:111], v[80:83], v[160:163]
    ds_read_b128 v[104:107], v8 offset:43008
    s_waitcnt lgkmcnt(7)
    v_mfma_f32_16x16x32_bf16 v[164:167], v[112:115], v[80:83], v[164:167]
    ds_read_b128 v[108:111], v8 offset:44032
    s_waitcnt vmcnt(2)
    v_mfma_f32_16x16x32_bf16 v[148:151], v[116:119], v[84:87], v[148:151]
    ds_read_b128 v[112:115], v8 offset:45056
    s_waitcnt lgkmcnt(7)
    v_mfma_f32_16x16x32_bf16 v[152:155], v[120:123], v[84:87], v[152:155]
    ds_read_b128 v[116:119], v8 offset:46080
    v_mfma_f32_16x16x32_bf16 v[156:159], v[124:127], v[84:87], v[156:159]
    ds_read_b128 v[120:123], v8 offset:47104
    s_waitcnt lgkmcnt(7)
    v_mfma_f32_16x16x32_bf16 v[160:163], v[128:131], v[84:87], v[160:163]
    ds_read_b128 v[124:127], v8 offset:48128
    v_mfma_f32_16x16x32_bf16 v[164:167], v[132:135], v[84:87], v[164:167]
    ds_read_b128 v[128:131], v8 offset:49152
    s_waitcnt vmcnt(1)
    s_waitcnt lgkmcnt(7)
    v_mfma_f32_16x16x32_bf16 v[148:151], v[96:99], v[88:91], v[148:151]
    ds_read_b128 v[132:135], v8 offset:50176
    v_mfma_f32_16x16x32_bf16 v[152:155], v[100:103], v[88:91], v[152:155]
    s_waitcnt lgkmcnt(6)
    v_mfma_f32_16x16x32_bf16 v[156:159], v[104:107], v[88:91], v[156:159]
    v_mfma_f32_16x16x32_bf16 v[160:163], v[108:111], v[88:91], v[160:163]
    s_waitcnt lgkmcnt(4)
    v_mfma_f32_16x16x32_bf16 v[164:167], v[112:115], v[88:91], v[164:167]
    s_waitcnt vmcnt(0)
    v_mfma_f32_16x16x32_bf16 v[148:151], v[116:119], v[92:95], v[148:151]
    s_waitcnt lgkmcnt(2)
    v_mfma_f32_16x16x32_bf16 v[152:155], v[120:123], v[92:95], v[152:155]
    v_mfma_f32_16x16x32_bf16 v[156:159], v[124:127], v[92:95], v[156:159]
    s_waitcnt lgkmcnt(0)
    v_mfma_f32_16x16x32_bf16 v[160:163], v[128:131], v[92:95], v[160:163]
    v_mfma_f32_16x16x32_bf16 v[164:167], v[132:135], v[92:95], v[164:167]
    s_nop 7
    v_lshlrev_b32 v12, 16, v230
    v_and_b32 v13, 0xffff0000, v230
    v_pk_add_f32 v[148:149], v[148:149], v[12:13]
    v_lshlrev_b32 v14, 16, v231
    v_and_b32 v15, 0xffff0000, v231
    v_pk_add_f32 v[150:151], v[150:151], v[14:15]
    v_lshlrev_b32 v12, 16, v232
    v_and_b32 v13, 0xffff0000, v232
    v_pk_add_f32 v[152:153], v[152:153], v[12:13]
    v_lshlrev_b32 v14, 16, v233
    v_and_b32 v15, 0xffff0000, v233
    v_pk_add_f32 v[154:155], v[154:155], v[14:15]
    v_lshlrev_b32 v12, 16, v234
    v_and_b32 v13, 0xffff0000, v234
    v_pk_add_f32 v[156:157], v[156:157], v[12:13]
    v_lshlrev_b32 v14, 16, v235
    v_and_b32 v15, 0xffff0000, v235
    v_pk_add_f32 v[158:159], v[158:159], v[14:15]
    v_lshlrev_b32 v12, 16, v236
    v_and_b32 v13, 0xffff0000, v236
    v_pk_add_f32 v[160:161], v[160:161], v[12:13]
    v_lshlrev_b32 v14, 16, v237
    v_and_b32 v15, 0xffff0000, v237
    v_pk_add_f32 v[162:163], v[162:163], v[14:15]
    v_lshlrev_b32 v12, 16, v238
    v_and_b32 v13, 0xffff0000, v238
    v_pk_add_f32 v[164:165], v[164:165], v[12:13]
    v_lshlrev_b32 v14, 16, v239
    v_and_b32 v15, 0xffff0000, v239
    v_pk_add_f32 v[166:167], v[166:167], v[14:15]
    v_cvt_pk_bf16_f32 v240, v148, v149
    v_cvt_pk_bf16_f32 v241, v150, v151
    v_cvt_pk_bf16_f32 v242, v152, v153
    v_cvt_pk_bf16_f32 v243, v154, v155
    v_cvt_pk_bf16_f32 v244, v156, v157
    v_cvt_pk_bf16_f32 v245, v158, v159
    v_cvt_pk_bf16_f32 v246, v160, v161
    v_cvt_pk_bf16_f32 v247, v162, v163
    v_cvt_pk_bf16_f32 v248, v164, v165
    v_cvt_pk_bf16_f32 v249, v166, v167
    s_mov_b32 s60, s34
    s_mul_i32 s61, s60, 20480
    s_mul_i32 s62, s26, 5
    s_lshr_b32 s62, s62, 1
    s_lshl_b32 s62, s62, 10
    s_add_u32 s61, s61, s62
    s_add_u32 s61, s61, 4194304
    s_bitcmp1_b32 s26, 0
    s_cbranch_scc1 L_p3_odd
    buffer_store_dwordx4 v[240:243], v3, s[4:7], s61 offen sc1
    buffer_store_dwordx4 v[244:247], v3, s[4:7], s61 offen offset:1024 sc1
    buffer_store_dwordx2 v[248:249], v3, s[4:7], s61 offen offset:2048 sc1
    s_branch L_p3_st
L_p3_odd:
    buffer_store_dwordx2 v[240:241], v3, s[4:7], s61 offen offset:8 sc1
    buffer_store_dwordx4 v[242:245], v3, s[4:7], s61 offen offset:1024 sc1
    buffer_store_dwordx4 v[246:249], v3, s[4:7], s61 offen offset:2048 sc1
L_p3_st:
    v_pk_mul_f32 v[12:13], v[148:149], v[148:149]
    v_mov_b32 v14, v148
    v_mov_b32 v15, v149
    v_pk_fma_f32 v[12:13], v[150:151], v[150:151], v[12:13]
    v_pk_add_f32 v[14:15], v[14:15], v[150:151]
    v_pk_fma_f32 v[12:13], v[152:153], v[152:153], v[12:13]
    v_pk_add_f32 v[14:15], v[14:15], v[152:153]
    v_pk_fma_f32 v[12:13], v[154:155], v[154:155], v[12:13]
    v_pk_add_f32 v[14:15], v[14:15], v[154:155]
    v_pk_fma_f32 v[12:13], v[156:157], v[156:157], v[12:13]
    v_pk_add_f32 v[14:15], v[14:15], v[156:157]
    v_pk_fma_f32 v[12:13], v[158:159], v[158:159], v[12:13]
    v_pk_add_f32 v[14:15], v[14:15], v[158:159]
    v_pk_fma_f32 v[12:13], v[160:161], v[160:161], v[12:13]
    v_pk_add_f32 v[14:15], v[14:15], v[160:161]
    v_pk_fma_f32 v[12:13], v[162:163], v[162:163], v[12:13]
    v_pk_add_f32 v[14:15], v[14:15], v[162:163]
    v_pk_fma_f32 v[12:13], v[164:165], v[164:165], v[12:13]
    v_pk_add_f32 v[14:15], v[14:15], v[164:165]
    v_pk_fma_f32 v[12:13], v[166:167], v[166:167], v[12:13]
    v_pk_add_f32 v[14:15], v[14:15], v[166:167]
    v_add_f32 v11, v12, v13
    v_add_f32 v10, v14, v15
    s_lshl_b32 s60, s60, 10
    s_lshl_b32 s61, s26, 3
    s_add_u32 s60, s60, s61
    s_add_u32 s60, s60, 7340032
    v_mov_b32 v12, v10
    s_nop 1
    v_permlane32_swap_b32 v10, v12
    s_nop 1
    v_add_f32 v10, v10, v12
    v_mov_b32 v12, v10
    s_nop 1
    v_permlane16_swap_b32 v10, v12
    s_nop 1
    v_add_f32 v10, v10, v12
    v_mov_b32 v12, v11
    s_nop 1
    v_permlane32_swap_b32 v11, v12
    s_nop 1
    v_add_f32 v11, v11, v12
    v_mov_b32 v12, v11
    s_nop 1
    v_permlane16_swap_b32 v11, v12
    s_nop 1
    v_add_f32 v11, v11, v12
    v_lshlrev_b32 v13, 6, v5
    v_lshl_add_u32 v13, v4, 28, v13
    s_lshl_b32 s61, s34, 7
    s_lshl_b32 s62, s26, 2
    s_add_u32 s61, s61, s62
    s_add_u32 s61, s61, 344064
    buffer_store_dwordx2 v[10:11], v13, s[4:7], s60 offen sc1
    s_barrier
    s_waitcnt vmcnt(0)
    v_mov_b32 v10, 0
    v_mov_b32 v12, 1
    s_mov_b64 exec, 1
    buffer_store_dword v12, v10, s[4:7], s61 offen sc1
    s_mov_b64 exec, -1
    s_lshl_b32 s60, s70, 2
    s_add_u32 s31, s60, s24
    s_lshl_b32 s63, s31, 11
    s_add_u32 s63, s63, 7340032
    v_lshlrev_b32 v13, 6, v5
    v_lshl_add_u32 v13, v4, 4, v13
    s_lshl_b32 s64, s24, 11
    s_add_u32 s64, s64, 12288
    v_add_u32 v7, 0, v3
    v_add_u32 v220, s64, v7
    v_add_u32 v8, 61440, v3
    v_add_u32 v221, s64, v8
    v_add_u32 v9, 122880, v3
    v_add_u32 v222, s64, v9
    s_barrier
    s_barrier
    buffer_load_dwordx4 v[224:227], v13, s[4:7], s63 offen sc1
    buffer_load_dwordx4 v[228:231], v13, s[4:7], s63 offen offset:1024 sc1
    ds_read_b128 v[112:115], v220 offset:0
    ds_read_b128 v[116:119], v220 offset:1024
    ds_read_b128 v[192:195], v7 offset:0
    ds_read_b128 v[196:199], v7 offset:1024
    ds_read_b128 v[200:203], v7 offset:2048
    ds_read_b128 v[204:207], v7 offset:3072
    ds_read_b128 v[208:211], v7 offset:4096
    ds_read_b128 v[212:215], v7 offset:5120
    s_waitcnt lgkmcnt(4)
    v_mfma_f32_16x16x32_bf16 v[16:19], v[192:195], v[112:115], 0
    ds_read_b128 v[216:219], v7 offset:6144
    v_mfma_f32_16x16x32_bf16 v[20:23], v[192:195], v[116:119], 0
    v_mfma_f32_16x16x32_bf16 v[24:27], v[196:199], v[112:115], 0
    ds_read_b128 v[192:195], v7 offset:7168
    v_mfma_f32_16x16x32_bf16 v[28:31], v[196:199], v[116:119], 0
    s_waitcnt lgkmcnt(4)
    v_mfma_f32_16x16x32_bf16 v[32:35], v[200:203], v[112:115], 0
    ds_read_b128 v[196:199], v7 offset:8192
    v_mfma_f32_16x16x32_bf16 v[36:39], v[200:203], v[116:119], 0
    v_mfma_f32_16x16x32_bf16 v[40:43], v[204:207], v[112:115], 0
    ds_read_b128 v[200:203], v7 offset:9216
    v_mfma_f32_16x16x32_bf16 v[44:47], v[204:207], v[116:119], 0
    s_waitcnt lgkmcnt(4)
    v_mfma_f32_16x16x32_bf16 v[48:51], v[208:211], v[112:115], 0
    ds_read_b128 v[204:207], v7 offset:10240
    v_mfma_f32_16x16x32_bf16 v[52:55], v[208:211], v[116:119], 0
    v_mfma_f32_16x16x32_bf16 v[56:59], v[212:215], v[112:115], 0
    ds_read_b128 v[208:211], v7 offset:11264
    v_mfma_f32_16x16x32_bf16 v[60:63], v[212:215], v[116:119], 0
    s_waitcnt lgkmcnt(4)
    v_mfma_f32_16x16x32_bf16 v[64:67], v[216:219], v[112:115], 0
    s_barrier
    ds_read_b128 v[120:123], v220 offset:20480
    ds_read_b128 v[124:127], v220 offset:21504
    ds_read_b128 v[212:215], v7 offset:20480
    v_mfma_f32_16x16x32_bf16 v[68:71], v[216:219], v[116:119], 0
    v_mfma_f32_16x16x32_bf16 v[72:75], v[192:195], v[112:115], 0
    ds_read_b128 v[216:219], v7 offset:21504
    v_mfma_f32_16x16x32_bf16 v[76:79], v[192:195], v[116:119], 0
    s_waitcnt lgkmcnt(6)
    v_mfma_f32_16x16x32_bf16 v[80:83], v[196:199], v[112:115], 0
    ds_read_b128 v[192:195], v7 offset:22528
    v_mfma_f32_16x16x32_bf16 v[84:87], v[196:199], v[116:119], 0
    v_mfma_f32_16x16x32_bf16 v[88:91], v[200:203], v[112:115], 0
    ds_read_b128 v[196:199], v7 offset:23552
    v_mfma_f32_16x16x32_bf16 v[92:95], v[200:203], v[116:119], 0
    s_waitcnt lgkmcnt(6)
    v_mfma_f32_16x16x32_bf16 v[96:99], v[204:207], v[112:115], 0
    ds_read_b128 v[200:203], v7 offset:24576
    v_mfma_f32_16x16x32_bf16 v[100:103], v[204:207], v[116:119], 0
    v_mfma_f32_16x16x32_bf16 v[104:107], v[208:211], v[112:115], 0
    ds_read_b128 v[204:207], v7 offset:25600
    v_mfma_f32_16x16x32_bf16 v[108:111], v[208:211], v[116:119], 0
    s_waitcnt lgkmcnt(4)
    v_mfma_f32_16x16x32_bf16 v[16:19], v[212:215], v[120:123], v[16:19]
    ds_read_b128 v[208:211], v7 offset:26624
    v_mfma_f32_16x16x32_bf16 v[20:23], v[212:215], v[124:127], v[20:23]
    v_mfma_f32_16x16x32_bf16 v[24:27], v[216:219], v[120:123], v[24:27]
    ds_read_b128 v[212:215], v7 offset:27648
    v_mfma_f32_16x16x32_bf16 v[28:31], v[216:219], v[124:127], v[28:31]
    s_waitcnt lgkmcnt(4)
    v_mfma_f32_16x16x32_bf16 v[32:35], v[192:195], v[120:123], v[32:35]
    ds_read_b128 v[216:219], v7 offset:28672
    v_mfma_f32_16x16x32_bf16 v[36:39], v[192:195], v[124:127], v[36:39]
    v_mfma_f32_16x16x32_bf16 v[40:43], v[196:199], v[120:123], v[40:43]
    ds_read_b128 v[192:195], v7 offset:29696
    v_mfma_f32_16x16x32_bf16 v[44:47], v[196:199], v[124:127], v[44:47]
    s_waitcnt lgkmcnt(4)
    v_mfma_f32_16x16x32_bf16 v[48:51], v[200:203], v[120:123], v[48:51]
    ds_read_b128 v[196:199], v7 offset:30720
    v_mfma_f32_16x16x32_bf16 v[52:55], v[200:203], v[124:127], v[52:55]
    v_mfma_f32_16x16x32_bf16 v[56:59], v[204:207], v[120:123], v[56:59]
    ds_read_b128 v[200:203], v7 offset:31744
    v_mfma_f32_16x16x32_bf16 v[60:63], v[204:207], v[124:127], v[60:63]
    s_waitcnt lgkmcnt(4)
    v_mfma_f32_16x16x32_bf16 v[64:67], v[208:211], v[120:123], v[64:67]
    s_barrier
    ds_read_b128 v[112:115], v220 offset:40960
    ds_read_b128 v[116:119], v220 offset:41984
    ds_read_b128 v[204:207], v7 offset:40960
    v_mfma_f32_16x16x32_bf16 v[68:71], v[208:211], v[124:127], v[68:71]
    v_mfma_f32_16x16x32_bf16 v[72:75], v[212:215], v[120:123], v[72:75]
    ds_read_b128 v[208:211], v7 offset:41984
    v_mfma_f32_16x16x32_bf16 v[76:79], v[212:215], v[124:127], v[76:79]
    s_waitcnt lgkmcnt(6)
    v_mfma_f32_16x16x32_bf16 v[80:83], v[216:219], v[120:123], v[80:83]
    ds_read_b128 v[212:215], v7 offset:43008
    v_mfma_f32_16x16x32_bf16 v[84:87], v[216:219], v[124:127], v[84:87]
    v_mfma_f32_16x16x32_bf16 v[88:91], v[192:195], v[120:123], v[88:91]
    ds_read_b128 v[216:219], v7 offset:44032
    v_mfma_f32_16x16x32_bf16 v[92:95], v[192:195], v[124:127], v[92:95]
    s_waitcnt lgkmcnt(6)
    v_mfma_f32_16x16x32_bf16 v[96:99], v[196:199], v[120:123], v[96:99]
    ds_read_b128 v[192:195], v7 offset:45056
    v_mfma_f32_16x16x32_bf16 v[100:103], v[196:199], v[124:127], v[100:103]
    v_mfma_f32_16x16x32_bf16 v[104:107], v[200:203], v[120:123], v[104:107]
    ds_read_b128 v[196:199], v7 offset:46080
    v_mfma_f32_16x16x32_bf16 v[108:111], v[200:203], v[124:127], v[108:111]
    s_waitcnt lgkmcnt(4)
    v_mfma_f32_16x16x32_bf16 v[16:19], v[204:207], v[112:115], v[16:19]
    ds_read_b128 v[200:203], v7 offset:47104
    v_mfma_f32_16x16x32_bf16 v[20:23], v[204:207], v[116:119], v[20:23]
    v_mfma_f32_16x16x32_bf16 v[24:27], v[208:211], v[112:115], v[24:27]
    ds_read_b128 v[204:207], v7 offset:48128
    v_mfma_f32_16x16x32_bf16 v[28:31], v[208:211], v[116:119], v[28:31]
    s_waitcnt lgkmcnt(4)
    v_mfma_f32_16x16x32_bf16 v[32:35], v[212:215], v[112:115], v[32:35]
    ds_read_b128 v[208:211], v7 offset:49152
    v_mfma_f32_16x16x32_bf16 v[36:39], v[212:215], v[116:119], v[36:39]
    v_mfma_f32_16x16x32_bf16 v[40:43], v[216:219], v[112:115], v[40:43]
    ds_read_b128 v[212:215], v7 offset:50176
    v_mfma_f32_16x16x32_bf16 v[44:47], v[216:219], v[116:119], v[44:47]
    s_waitcnt lgkmcnt(4)
    v_mfma_f32_16x16x32_bf16 v[48:51], v[192:195], v[112:115], v[48:51]
    ds_read_b128 v[216:219], v7 offset:51200
    v_mfma_f32_16x16x32_bf16 v[52:55], v[192:195], v[116:119], v[52:55]
    v_mfma_f32_16x16x32_bf16 v[56:59], v[196:199], v[112:115], v[56:59]
    ds_read_b128 v[192:195], v7 offset:52224
    v_mfma_f32_16x16x32_bf16 v[60:63], v[196:199], v[116:119], v[60:63]
    s_waitcnt lgkmcnt(4)
    v_mfma_f32_16x16x32_bf16 v[64:67], v[200:203], v[112:115], v[64:67]
    s_barrier
    ds_read_b128 v[120:123], v221 offset:0
    ds_read_b128 v[124:127], v221 offset:1024
    ds_read_b128 v[196:199], v8 offset:0
    v_mfma_f32_16x16x32_bf16 v[68:71], v[200:203], v[116:119], v[68:71]
    v_mfma_f32_16x16x32_bf16 v[72:75], v[204:207], v[112:115], v[72:75]
    ds_read_b128 v[200:203], v8 offset:1024
    v_mfma_f32_16x16x32_bf16 v[76:79], v[204:207], v[116:119], v[76:79]
    s_waitcnt lgkmcnt(6)
    v_mfma_f32_16x16x32_bf16 v[80:83], v[208:211], v[112:115], v[80:83]
    ds_read_b128 v[204:207], v8 offset:2048
    v_mfma_f32_16x16x32_bf16 v[84:87], v[208:211], v[116:119], v[84:87]
    v_mfma_f32_16x16x32_bf16 v[88:91], v[212:215], v[112:115], v[88:91]
    ds_read_b128 v[208:211], v8 offset:3072
    v_mfma_f32_16x16x32_bf16 v[92:95], v[212:215], v[116:119], v[92:95]
    s_waitcnt lgkmcnt(6)
    v_mfma_f32_16x16x32_bf16 v[96:99], v[216:219], v[112:115], v[96:99]
    ds_read_b128 v[212:215], v8 offset:4096
    v_mfma_f32_16x16x32_bf16 v[100:103], v[216:219], v[116:119], v[100:103]
    v_mfma_f32_16x16x32_bf16 v[104:107], v[192:195], v[112:115], v[104:107]
    ds_read_b128 v[216:219], v8 offset:5120
    v_mfma_f32_16x16x32_bf16 v[108:111], v[192:195], v[116:119], v[108:111]
    s_waitcnt vmcnt(0)
    s_waitcnt lgkmcnt(4)
    v_mfma_f32_16x16x32_bf16 v[16:19], v[196:199], v[120:123], v[16:19]
    ds_read_b128 v[192:195], v8 offset:6144
    v_mfma_f32_16x16x32_bf16 v[20:23], v[196:199], v[124:127], v[20:23]
    v_add_f32 v224, v224, v226
    v_add_f32 v225, v225, v227
    v_mfma_f32_16x16x32_bf16 v[24:27], v[200:203], v[120:123], v[24:27]
    ds_read_b128 v[196:199], v8 offset:7168
    v_mfma_f32_16x16x32_bf16 v[28:31], v[200:203], v[124:127], v[28:31]
    v_add_f32 v228, v228, v230
    v_add_f32 v229, v229, v231
    s_waitcnt lgkmcnt(4)
    v_mfma_f32_16x16x32_bf16 v[32:35], v[204:207], v[120:123], v[32:35]
    ds_read_b128 v[200:203], v8 offset:8192
    v_mfma_f32_16x16x32_bf16 v[36:39], v[204:207], v[124:127], v[36:39]
    v_mov_b32 v12, v224
    s_nop 1
    v_mfma_f32_16x16x32_bf16 v[40:43], v[208:211], v[120:123], v[40:43]
    ds_read_b128 v[204:207], v8 offset:9216
    v_mfma_f32_16x16x32_bf16 v[44:47], v[208:211], v[124:127], v[44:47]
    v_permlane32_swap_b32 v224, v12
    s_nop 1
    s_waitcnt lgkmcnt(4)
    v_mfma_f32_16x16x32_bf16 v[48:51], v[212:215], v[120:123], v[48:51]
    ds_read_b128 v[208:211], v8 offset:10240
    v_mfma_f32_16x16x32_bf16 v[52:55], v[212:215], v[124:127], v[52:55]
    v_add_f32 v224, v224, v12
    v_mov_b32 v12, v224
    v_mfma_f32_16x16x32_bf16 v[56:59], v[216:219], v[120:123], v[56:59]
    ds_read_b128 v[212:215], v8 offset:11264
    v_mfma_f32_16x16x32_bf16 v[60:63], v[216:219], v[124:127], v[60:63]
    s_nop 1
    v_permlane16_swap_b32 v224, v12
    s_waitcnt lgkmcnt(4)
    v_mfma_f32_16x16x32_bf16 v[64:67], v[192:195], v[120:123], v[64:67]
    s_barrier
    ds_read_b128 v[112:115], v221 offset:20480
    ds_read_b128 v[116:119], v221 offset:21504
    ds_read_b128 v[216:219], v8 offset:20480
    v_mfma_f32_16x16x32_bf16 v[68:71], v[192:195], v[124:127], v[68:71]
    s_nop 1
    v_add_f32 v224, v224, v12
    v_mfma_f32_16x16x32_bf16 v[72:75], v[196:199], v[120:123], v[72:75]
    ds_read_b128 v[192:195], v8 offset:21504
    v_mfma_f32_16x16x32_bf16 v[76:79], v[196:199], v[124:127], v[76:79]
    v_mov_b32 v12, v225
    s_nop 1
    s_waitcnt lgkmcnt(6)
    v_mfma_f32_16x16x32_bf16 v[80:83], v[200:203], v[120:123], v[80:83]
    ds_read_b128 v[196:199], v8 offset:22528
    v_mfma_f32_16x16x32_bf16 v[84:87], v[200:203], v[124:127], v[84:87]
    v_permlane32_swap_b32 v225, v12
    s_nop 1
    v_mfma_f32_16x16x32_bf16 v[88:91], v[204:207], v[120:123], v[88:91]
    ds_read_b128 v[200:203], v8 offset:23552
    v_mfma_f32_16x16x32_bf16 v[92:95], v[204:207], v[124:127], v[92:95]
    v_add_f32 v225, v225, v12
    v_mov_b32 v12, v225
    s_waitcnt lgkmcnt(6)
    v_mfma_f32_16x16x32_bf16 v[96:99], v[208:211], v[120:123], v[96:99]
    ds_read_b128 v[204:207], v8 offset:24576
    v_mfma_f32_16x16x32_bf16 v[100:103], v[208:211], v[124:127], v[100:103]
    s_nop 1
    v_permlane16_swap_b32 v225, v12
    v_mfma_f32_16x16x32_bf16 v[104:107], v[212:215], v[120:123], v[104:107]
    ds_read_b128 v[208:211], v8 offset:25600
    v_mfma_f32_16x16x32_bf16 v[108:111], v[212:215], v[124:127], v[108:111]
    s_nop 1
    v_add_f32 v225, v225, v12
    s_waitcnt lgkmcnt(4)
    v_mfma_f32_16x16x32_bf16 v[16:19], v[216:219], v[112:115], v[16:19]
    ds_read_b128 v[212:215], v8 offset:26624
    v_mfma_f32_16x16x32_bf16 v[20:23], v[216:219], v[116:119], v[20:23]
    v_mul_f32 v224, 0x3acccccd, v224
    v_mul_f32 v225, 0x3acccccd, v225
    v_mfma_f32_16x16x32_bf16 v[24:27], v[192:195], v[112:115], v[24:27]
    ds_read_b128 v[216:219], v8 offset:27648
    v_mfma_f32_16x16x32_bf16 v[28:31], v[192:195], v[116:119], v[28:31]
    v_fma_f32 v225, -v224, v224, v225
    v_max_f32 v225, 0, v225
    s_waitcnt lgkmcnt(4)
    v_mfma_f32_16x16x32_bf16 v[32:35], v[196:199], v[112:115], v[32:35]
    ds_read_b128 v[192:195], v8 offset:28672
    v_mfma_f32_16x16x32_bf16 v[36:39], v[196:199], v[116:119], v[36:39]
    v_add_f32 v225, 0x3727c5ac, v225
    v_rsq_f32 v225, v225
    v_mfma_f32_16x16x32_bf16 v[40:43], v[200:203], v[112:115], v[40:43]
    ds_read_b128 v[196:199], v8 offset:29696
    v_mfma_f32_16x16x32_bf16 v[44:47], v[200:203], v[116:119], v[44:47]
    v_mov_b32 v12, v228
    s_nop 1
    s_waitcnt lgkmcnt(4)
    v_mfma_f32_16x16x32_bf16 v[48:51], v[204:207], v[112:115], v[48:51]
    ds_read_b128 v[200:203], v8 offset:30720
    v_mfma_f32_16x16x32_bf16 v[52:55], v[204:207], v[116:119], v[52:55]
    v_permlane32_swap_b32 v228, v12
    s_nop 1
    v_mfma_f32_16x16x32_bf16 v[56:59], v[208:211], v[112:115], v[56:59]
    ds_read_b128 v[204:207], v8 offset:31744
    v_mfma_f32_16x16x32_bf16 v[60:63], v[208:211], v[116:119], v[60:63]
    v_add_f32 v228, v228, v12
    v_mov_b32 v12, v228
    s_waitcnt lgkmcnt(4)
    v_mfma_f32_16x16x32_bf16 v[64:67], v[212:215], v[112:115], v[64:67]
    s_barrier
    ds_read_b128 v[120:123], v221 offset:40960
    ds_read_b128 v[124:127], v221 offset:41984
    ds_read_b128 v[208:211], v8 offset:40960
    v_mfma_f32_16x16x32_bf16 v[68:71], v[212:215], v[116:119], v[68:71]
    s_nop 1
    v_permlane16_swap_b32 v228, v12
    v_mfma_f32_16x16x32_bf16 v[72:75], v[216:219], v[112:115], v[72:75]
    ds_read_b128 v[212:215], v8 offset:41984
    v_mfma_f32_16x16x32_bf16 v[76:79], v[216:219], v[116:119], v[76:79]
    s_nop 1
    v_add_f32 v228, v228, v12
    s_waitcnt lgkmcnt(6)
    v_mfma_f32_16x16x32_bf16 v[80:83], v[192:195], v[112:115], v[80:83]
    ds_read_b128 v[216:219], v8 offset:43008
    v_mfma_f32_16x16x32_bf16 v[84:87], v[192:195], v[116:119], v[84:87]
    v_mov_b32 v12, v229
    s_nop 1
    v_mfma_f32_16x16x32_bf16 v[88:91], v[196:199], v[112:115], v[88:91]
    ds_read_b128 v[192:195], v8 offset:44032
    v_mfma_f32_16x16x32_bf16 v[92:95], v[196:199], v[116:119], v[92:95]
    v_permlane32_swap_b32 v229, v12
    s_nop 1
    s_waitcnt lgkmcnt(6)
    v_mfma_f32_16x16x32_bf16 v[96:99], v[200:203], v[112:115], v[96:99]
    ds_read_b128 v[196:199], v8 offset:45056
    v_mfma_f32_16x16x32_bf16 v[100:103], v[200:203], v[116:119], v[100:103]
    v_add_f32 v229, v229, v12
    v_mov_b32 v12, v229
    v_mfma_f32_16x16x32_bf16 v[104:107], v[204:207], v[112:115], v[104:107]
    ds_read_b128 v[200:203], v8 offset:46080
    v_mfma_f32_16x16x32_bf16 v[108:111], v[204:207], v[116:119], v[108:111]
    s_nop 1
    v_permlane16_swap_b32 v229, v12
    s_waitcnt lgkmcnt(4)
    v_mfma_f32_16x16x32_bf16 v[16:19], v[208:211], v[120:123], v[16:19]
    ds_read_b128 v[204:207], v8 offset:47104
    v_mfma_f32_16x16x32_bf16 v[20:23], v[208:211], v[124:127], v[20:23]
    s_nop 1
    v_add_f32 v229, v229, v12
    v_mfma_f32_16x16x32_bf16 v[24:27], v[212:215], v[120:123], v[24:27]
    ds_read_b128 v[208:211], v8 offset:48128
    v_mfma_f32_16x16x32_bf16 v[28:31], v[212:215], v[124:127], v[28:31]
    v_mul_f32 v228, 0x3acccccd, v228
    v_mul_f32 v229, 0x3acccccd, v229
    s_waitcnt lgkmcnt(4)
    v_mfma_f32_16x16x32_bf16 v[32:35], v[216:219], v[120:123], v[32:35]
    ds_read_b128 v[212:215], v8 offset:49152
    v_mfma_f32_16x16x32_bf16 v[36:39], v[216:219], v[124:127], v[36:39]
    v_fma_f32 v229, -v228, v228, v229
    v_max_f32 v229, 0, v229
    v_mfma_f32_16x16x32_bf16 v[40:43], v[192:195], v[120:123], v[40:43]
    ds_read_b128 v[216:219], v8 offset:50176
    v_mfma_f32_16x16x32_bf16 v[44:47], v[192:195], v[124:127], v[44:47]
    v_add_f32 v229, 0x3727c5ac, v229
    v_rsq_f32 v229, v229
    s_waitcnt lgkmcnt(4)
    v_mfma_f32_16x16x32_bf16 v[48:51], v[196:199], v[120:123], v[48:51]
    ds_read_b128 v[192:195], v8 offset:51200
    v_mfma_f32_16x16x32_bf16 v[52:55], v[196:199], v[124:127], v[52:55]
    v_mfma_f32_16x16x32_bf16 v[56:59], v[200:203], v[120:123], v[56:59]
    ds_read_b128 v[196:199], v8 offset:52224
    v_mfma_f32_16x16x32_bf16 v[60:63], v[200:203], v[124:127], v[60:63]
    s_waitcnt lgkmcnt(4)
    v_mfma_f32_16x16x32_bf16 v[64:67], v[204:207], v[120:123], v[64:67]
    s_barrier
    ds_read_b128 v[112:115], v222 offset:0
    ds_read_b128 v[116:119], v222 offset:1024
    ds_read_b128 v[200:203], v9 offset:0
    v_mfma_f32_16x16x32_bf16 v[68:71], v[204:207], v[124:127], v[68:71]
    v_mfma_f32_16x16x32_bf16 v[72:75], v[208:211], v[120:123], v[72:75]
    ds_read_b128 v[204:207], v9 offset:1024
    v_mfma_f32_16x16x32_bf16 v[76:79], v[208:211], v[124:127], v[76:79]
    s_waitcnt lgkmcnt(6)
    v_mfma_f32_16x16x32_bf16 v[80:83], v[212:215], v[120:123], v[80:83]
    ds_read_b128 v[208:211], v9 offset:2048
    v_mfma_f32_16x16x32_bf16 v[84:87], v[212:215], v[124:127], v[84:87]
    v_mfma_f32_16x16x32_bf16 v[88:91], v[216:219], v[120:123], v[88:91]
    ds_read_b128 v[212:215], v9 offset:3072
    v_mfma_f32_16x16x32_bf16 v[92:95], v[216:219], v[124:127], v[92:95]
    s_waitcnt lgkmcnt(6)
    v_mfma_f32_16x16x32_bf16 v[96:99], v[192:195], v[120:123], v[96:99]
    ds_read_b128 v[216:219], v9 offset:4096
    v_mfma_f32_16x16x32_bf16 v[100:103], v[192:195], v[124:127], v[100:103]
    v_mfma_f32_16x16x32_bf16 v[104:107], v[196:199], v[120:123], v[104:107]
    ds_read_b128 v[192:195], v9 offset:5120
    v_mfma_f32_16x16x32_bf16 v[108:111], v[196:199], v[124:127], v[108:111]
    s_waitcnt lgkmcnt(4)
    v_mfma_f32_16x16x32_bf16 v[16:19], v[200:203], v[112:115], v[16:19]
    ds_read_b128 v[196:199], v9 offset:6144
    v_mfma_f32_16x16x32_bf16 v[20:23], v[200:203], v[116:119], v[20:23]
    v_mfma_f32_16x16x32_bf16 v[24:27], v[204:207], v[112:115], v[24:27]
    ds_read_b128 v[200:203], v9 offset:7168
    v_mfma_f32_16x16x32_bf16 v[28:31], v[204:207], v[116:119], v[28:31]
    s_waitcnt lgkmcnt(4)
    v_mfma_f32_16x16x32_bf16 v[32:35], v[208:211], v[112:115], v[32:35]
    ds_read_b128 v[204:207], v9 offset:8192
    v_mfma_f32_16x16x32_bf16 v[36:39], v[208:211], v[116:119], v[36:39]
    v_mfma_f32_16x16x32_bf16 v[40:43], v[212:215], v[112:115], v[40:43]
    ds_read_b128 v[208:211], v9 offset:9216
    v_mfma_f32_16x16x32_bf16 v[44:47], v[212:215], v[116:119], v[44:47]
    s_waitcnt lgkmcnt(4)
    v_mfma_f32_16x16x32_bf16 v[48:51], v[216:219], v[112:115], v[48:51]
    ds_read_b128 v[212:215], v9 offset:10240
    v_mfma_f32_16x16x32_bf16 v[52:55], v[216:219], v[116:119], v[52:55]
    v_mfma_f32_16x16x32_bf16 v[56:59], v[192:195], v[112:115], v[56:59]
    ds_read_b128 v[216:219], v9 offset:11264
    v_mfma_f32_16x16x32_bf16 v[60:63], v[192:195], v[116:119], v[60:63]
    s_waitcnt lgkmcnt(4)
    v_mfma_f32_16x16x32_bf16 v[64:67], v[196:199], v[112:115], v[64:67]
    s_barrier
    ds_read_b128 v[120:123], v222 offset:20480
    ds_read_b128 v[124:127], v222 offset:21504
    ds_read_b128 v[192:195], v9 offset:20480
    v_mfma_f32_16x16x32_bf16 v[68:71], v[196:199], v[116:119], v[68:71]
    v_mfma_f32_16x16x32_bf16 v[72:75], v[200:203], v[112:115], v[72:75]
    ds_read_b128 v[196:199], v9 offset:21504
    v_mfma_f32_16x16x32_bf16 v[76:79], v[200:203], v[116:119], v[76:79]
    s_waitcnt lgkmcnt(6)
    v_mfma_f32_16x16x32_bf16 v[80:83], v[204:207], v[112:115], v[80:83]
    ds_read_b128 v[200:203], v9 offset:22528
    v_mfma_f32_16x16x32_bf16 v[84:87], v[204:207], v[116:119], v[84:87]
    v_mfma_f32_16x16x32_bf16 v[88:91], v[208:211], v[112:115], v[88:91]
    ds_read_b128 v[204:207], v9 offset:23552
    v_mfma_f32_16x16x32_bf16 v[92:95], v[208:211], v[116:119], v[92:95]
    s_waitcnt lgkmcnt(6)
    v_mfma_f32_16x16x32_bf16 v[96:99], v[212:215], v[112:115], v[96:99]
    ds_read_b128 v[208:211], v9 offset:24576
    v_mfma_f32_16x16x32_bf16 v[100:103], v[212:215], v[116:119], v[100:103]
    v_mfma_f32_16x16x32_bf16 v[104:107], v[216:219], v[112:115], v[104:107]
    ds_read_b128 v[212:215], v9 offset:25600
    v_mfma_f32_16x16x32_bf16 v[108:111], v[216:219], v[116:119], v[108:111]
    s_waitcnt lgkmcnt(4)
    v_mfma_f32_16x16x32_bf16 v[16:19], v[192:195], v[120:123], v[16:19]
    ds_read_b128 v[216:219], v9 offset:26624
    v_mfma_f32_16x16x32_bf16 v[20:23], v[192:195], v[124:127], v[20:23]
    v_mfma_f32_16x16x32_bf16 v[24:27], v[196:199], v[120:123], v[24:27]
    ds_read_b128 v[192:195], v9 offset:27648
    v_mfma_f32_16x16x32_bf16 v[28:31], v[196:199], v[124:127], v[28:31]
    s_waitcnt lgkmcnt(4)
    v_mfma_f32_16x16x32_bf16 v[32:35], v[200:203], v[120:123], v[32:35]
    ds_read_b128 v[196:199], v9 offset:28672
    v_mfma_f32_16x16x32_bf16 v[36:39], v[200:203], v[124:127], v[36:39]
    v_mfma_f32_16x16x32_bf16 v[40:43], v[204:207], v[120:123], v[40:43]
    ds_read_b128 v[200:203], v9 offset:29696
    v_mfma_f32_16x16x32_bf16 v[44:47], v[204:207], v[124:127], v[44:47]
    s_waitcnt lgkmcnt(4)
    v_mfma_f32_16x16x32_bf16 v[48:51], v[208:211], v[120:123], v[48:51]
    ds_read_b128 v[204:207], v9 offset:30720
    v_mfma_f32_16x16x32_bf16 v[52:55], v[208:211], v[124:127], v[52:55]
    v_mfma_f32_16x16x32_bf16 v[56:59], v[212:215], v[120:123], v[56:59]
    ds_read_b128 v[208:211], v9 offset:31744
    v_mfma_f32_16x16x32_bf16 v[60:63], v[212:215], v[124:127], v[60:63]
    s_waitcnt lgkmcnt(4)
    v_mfma_f32_16x16x32_bf16 v[64:67], v[216:219], v[120:123], v[64:67]
    s_barrier
    ds_read_b128 v[112:115], v220 offset:0
    ds_read_b128 v[116:119], v220 offset:1024
    ds_read_b128 v[212:215], v7 offset:0
    v_mfma_f32_16x16x32_bf16 v[68:71], v[216:219], v[124:127], v[68:71]
    v_mfma_f32_16x16x32_bf16 v[72:75], v[192:195], v[120:123], v[72:75]
    ds_read_b128 v[216:219], v7 offset:1024
    v_mfma_f32_16x16x32_bf16 v[76:79], v[192:195], v[124:127], v[76:79]
    s_waitcnt lgkmcnt(6)
    v_mfma_f32_16x16x32_bf16 v[80:83], v[196:199], v[120:123], v[80:83]
    ds_read_b128 v[192:195], v7 offset:2048
    v_mfma_f32_16x16x32_bf16 v[84:87], v[196:199], v[124:127], v[84:87]
    v_mfma_f32_16x16x32_bf16 v[88:91], v[200:203], v[120:123], v[88:91]
    ds_read_b128 v[196:199], v7 offset:3072
    v_mfma_f32_16x16x32_bf16 v[92:95], v[200:203], v[124:127], v[92:95]
    s_waitcnt lgkmcnt(6)
    v_mfma_f32_16x16x32_bf16 v[96:99], v[204:207], v[120:123], v[96:99]
    ds_read_b128 v[200:203], v7 offset:4096
    v_mfma_f32_16x16x32_bf16 v[100:103], v[204:207], v[124:127], v[100:103]
    v_mfma_f32_16x16x32_bf16 v[104:107], v[208:211], v[120:123], v[104:107]
    ds_read_b128 v[204:207], v7 offset:5120
    v_mfma_f32_16x16x32_bf16 v[108:111], v[208:211], v[124:127], v[108:111]
    s_waitcnt lgkmcnt(4)
    v_mfma_f32_16x16x32_bf16 v[16:19], v[212:215], v[112:115], v[16:19]
    ds_read_b128 v[208:211], v7 offset:6144
    v_mfma_f32_16x16x32_bf16 v[20:23], v[212:215], v[116:119], v[20:23]
    v_mfma_f32_16x16x32_bf16 v[24:27], v[216:219], v[112:115], v[24:27]
    ds_read_b128 v[212:215], v7 offset:7168
    v_mfma_f32_16x16x32_bf16 v[28:31], v[216:219], v[116:119], v[28:31]
    s_waitcnt lgkmcnt(4)
    v_mfma_f32_16x16x32_bf16 v[32:35], v[192:195], v[112:115], v[32:35]
    ds_read_b128 v[216:219], v7 offset:8192
    v_mfma_f32_16x16x32_bf16 v[36:39], v[192:195], v[116:119], v[36:39]
    v_mfma_f32_16x16x32_bf16 v[40:43], v[196:199], v[112:115], v[40:43]
    ds_read_b128 v[192:195], v7 offset:9216
    v_mfma_f32_16x16x32_bf16 v[44:47], v[196:199], v[116:119], v[44:47]
    s_waitcnt lgkmcnt(4)
    v_mfma_f32_16x16x32_bf16 v[48:51], v[200:203], v[112:115], v[48:51]
    ds_read_b128 v[196:199], v7 offset:10240
    v_mfma_f32_16x16x32_bf16 v[52:55], v[200:203], v[116:119], v[52:55]
    v_mfma_f32_16x16x32_bf16 v[56:59], v[204:207], v[112:115], v[56:59]
    ds_read_b128 v[200:203], v7 offset:11264
    v_mfma_f32_16x16x32_bf16 v[60:63], v[204:207], v[116:119], v[60:63]
    s_waitcnt lgkmcnt(4)
    v_mfma_f32_16x16x32_bf16 v[64:67], v[208:211], v[112:115], v[64:67]
    s_barrier
    ds_read_b128 v[120:123], v220 offset:20480
    ds_read_b128 v[124:127], v220 offset:21504
    ds_read_b128 v[204:207], v7 offset:20480
    v_mfma_f32_16x16x32_bf16 v[68:71], v[208:211], v[116:119], v[68:71]
    v_mfma_f32_16x16x32_bf16 v[72:75], v[212:215], v[112:115], v[72:75]
    ds_read_b128 v[208:211], v7 offset:21504
    v_mfma_f32_16x16x32_bf16 v[76:79], v[212:215], v[116:119], v[76:79]
    s_waitcnt lgkmcnt(6)
    v_mfma_f32_16x16x32_bf16 v[80:83], v[216:219], v[112:115], v[80:83]
    ds_read_b128 v[212:215], v7 offset:22528
    v_mfma_f32_16x16x32_bf16 v[84:87], v[216:219], v[116:119], v[84:87]
    v_mfma_f32_16x16x32_bf16 v[88:91], v[192:195], v[112:115], v[88:91]
    ds_read_b128 v[216:219], v7 offset:23552
    v_mfma_f32_16x16x32_bf16 v[92:95], v[192:195], v[116:119], v[92:95]
    s_waitcnt lgkmcnt(6)
    v_mfma_f32_16x16x32_bf16 v[96:99], v[196:199], v[112:115], v[96:99]
    ds_read_b128 v[192:195], v7 offset:24576
    v_mfma_f32_16x16x32_bf16 v[100:103], v[196:199], v[116:119], v[100:103]
    v_mfma_f32_16x16x32_bf16 v[104:107], v[200:203], v[112:115], v[104:107]
    ds_read_b128 v[196:199], v7 offset:25600
    v_mfma_f32_16x16x32_bf16 v[108:111], v[200:203], v[116:119], v[108:111]
    s_waitcnt lgkmcnt(4)
    v_mfma_f32_16x16x32_bf16 v[16:19], v[204:207], v[120:123], v[16:19]
    ds_read_b128 v[200:203], v7 offset:26624
    v_mfma_f32_16x16x32_bf16 v[20:23], v[204:207], v[124:127], v[20:23]
    v_mfma_f32_16x16x32_bf16 v[24:27], v[208:211], v[120:123], v[24:27]
    ds_read_b128 v[204:207], v7 offset:27648
    v_mfma_f32_16x16x32_bf16 v[28:31], v[208:211], v[124:127], v[28:31]
    s_waitcnt lgkmcnt(4)
    v_mfma_f32_16x16x32_bf16 v[32:35], v[212:215], v[120:123], v[32:35]
    ds_read_b128 v[208:211], v7 offset:28672
    v_mfma_f32_16x16x32_bf16 v[36:39], v[212:215], v[124:127], v[36:39]
    v_mfma_f32_16x16x32_bf16 v[40:43], v[216:219], v[120:123], v[40:43]
    ds_read_b128 v[212:215], v7 offset:29696
    v_mfma_f32_16x16x32_bf16 v[44:47], v[216:219], v[124:127], v[44:47]
    s_waitcnt lgkmcnt(4)
    v_mfma_f32_16x16x32_bf16 v[48:51], v[192:195], v[120:123], v[48:51]
    ds_read_b128 v[216:219], v7 offset:30720
    v_mfma_f32_16x16x32_bf16 v[52:55], v[192:195], v[124:127], v[52:55]
    v_mfma_f32_16x16x32_bf16 v[56:59], v[196:199], v[120:123], v[56:59]
    ds_read_b128 v[192:195], v7 offset:31744
    v_mfma_f32_16x16x32_bf16 v[60:63], v[196:199], v[124:127], v[60:63]
    s_waitcnt lgkmcnt(4)
    v_mfma_f32_16x16x32_bf16 v[64:67], v[200:203], v[120:123], v[64:67]
    s_barrier
    ds_read_b128 v[112:115], v220 offset:40960
    ds_read_b128 v[116:119], v220 offset:41984
    ds_read_b128 v[196:199], v7 offset:40960
    v_mfma_f32_16x16x32_bf16 v[68:71], v[200:203], v[124:127], v[68:71]
    v_mfma_f32_16x16x32_bf16 v[72:75], v[204:207], v[120:123], v[72:75]
    ds_read_b128 v[200:203], v7 offset:41984
    v_mfma_f32_16x16x32_bf16 v[76:79], v[204:207], v[124:127], v[76:79]
    s_waitcnt lgkmcnt(6)
    v_mfma_f32_16x16x32_bf16 v[80:83], v[208:211], v[120:123], v[80:83]
    ds_read_b128 v[204:207], v7 offset:43008
    v_mfma_f32_16x16x32_bf16 v[84:87], v[208:211], v[124:127], v[84:87]
    v_mfma_f32_16x16x32_bf16 v[88:91], v[212:215], v[120:123], v[88:91]
    ds_read_b128 v[208:211], v7 offset:44032
    v_mfma_f32_16x16x32_bf16 v[92:95], v[212:215], v[124:127], v[92:95]
    s_waitcnt lgkmcnt(6)
    v_mfma_f32_16x16x32_bf16 v[96:99], v[216:219], v[120:123], v[96:99]
    ds_read_b128 v[212:215], v7 offset:45056
    v_mfma_f32_16x16x32_bf16 v[100:103], v[216:219], v[124:127], v[100:103]
    v_mfma_f32_16x16x32_bf16 v[104:107], v[192:195], v[120:123], v[104:107]
    ds_read_b128 v[216:219], v7 offset:46080
    v_mfma_f32_16x16x32_bf16 v[108:111], v[192:195], v[124:127], v[108:111]
    s_waitcnt lgkmcnt(4)
    v_mfma_f32_16x16x32_bf16 v[16:19], v[196:199], v[112:115], v[16:19]
    ds_read_b128 v[192:195], v7 offset:47104
    v_mfma_f32_16x16x32_bf16 v[20:23], v[196:199], v[116:119], v[20:23]
    v_mfma_f32_16x16x32_bf16 v[24:27], v[200:203], v[112:115], v[24:27]
    ds_read_b128 v[196:199], v7 offset:48128
    v_mfma_f32_16x16x32_bf16 v[28:31], v[200:203], v[116:119], v[28:31]
    s_waitcnt lgkmcnt(4)
    v_mfma_f32_16x16x32_bf16 v[32:35], v[204:207], v[112:115], v[32:35]
    ds_read_b128 v[200:203], v7 offset:49152
    v_mfma_f32_16x16x32_bf16 v[36:39], v[204:207], v[116:119], v[36:39]
    v_mfma_f32_16x16x32_bf16 v[40:43], v[208:211], v[112:115], v[40:43]
    ds_read_b128 v[204:207], v7 offset:50176
    v_mfma_f32_16x16x32_bf16 v[44:47], v[208:211], v[116:119], v[44:47]
    s_waitcnt lgkmcnt(4)
    v_mfma_f32_16x16x32_bf16 v[48:51], v[212:215], v[112:115], v[48:51]
    ds_read_b128 v[208:211], v7 offset:51200
    v_mfma_f32_16x16x32_bf16 v[52:55], v[212:215], v[116:119], v[52:55]
    v_mfma_f32_16x16x32_bf16 v[56:59], v[216:219], v[112:115], v[56:59]
    ds_read_b128 v[212:215], v7 offset:52224
    v_mfma_f32_16x16x32_bf16 v[60:63], v[216:219], v[116:119], v[60:63]
    s_waitcnt lgkmcnt(4)
    v_mfma_f32_16x16x32_bf16 v[64:67], v[192:195], v[112:115], v[64:67]
    s_barrier
    ds_read_b128 v[120:123], v221 offset:0
    ds_read_b128 v[124:127], v221 offset:1024
    ds_read_b128 v[216:219], v8 offset:0
    v_mfma_f32_16x16x32_bf16 v[68:71], v[192:195], v[116:119], v[68:71]
    v_mfma_f32_16x16x32_bf16 v[72:75], v[196:199], v[112:115], v[72:75]
    ds_read_b128 v[192:195], v8 offset:1024
    v_mfma_f32_16x16x32_bf16 v[76:79], v[196:199], v[116:119], v[76:79]
    s_waitcnt lgkmcnt(6)
    v_mfma_f32_16x16x32_bf16 v[80:83], v[200:203], v[112:115], v[80:83]
    ds_read_b128 v[196:199], v8 offset:2048
    v_mfma_f32_16x16x32_bf16 v[84:87], v[200:203], v[116:119], v[84:87]
    v_mfma_f32_16x16x32_bf16 v[88:91], v[204:207], v[112:115], v[88:91]
    ds_read_b128 v[200:203], v8 offset:3072
    v_mfma_f32_16x16x32_bf16 v[92:95], v[204:207], v[116:119], v[92:95]
    s_waitcnt lgkmcnt(6)
    v_mfma_f32_16x16x32_bf16 v[96:99], v[208:211], v[112:115], v[96:99]
    ds_read_b128 v[204:207], v8 offset:4096
    v_mfma_f32_16x16x32_bf16 v[100:103], v[208:211], v[116:119], v[100:103]
    v_mfma_f32_16x16x32_bf16 v[104:107], v[212:215], v[112:115], v[104:107]
    ds_read_b128 v[208:211], v8 offset:5120
    v_mfma_f32_16x16x32_bf16 v[108:111], v[212:215], v[116:119], v[108:111]
    s_waitcnt lgkmcnt(4)
    v_mfma_f32_16x16x32_bf16 v[16:19], v[216:219], v[120:123], v[16:19]
    ds_read_b128 v[212:215], v8 offset:6144
    v_mfma_f32_16x16x32_bf16 v[20:23], v[216:219], v[124:127], v[20:23]
    v_mfma_f32_16x16x32_bf16 v[24:27], v[192:195], v[120:123], v[24:27]
    ds_read_b128 v[216:219], v8 offset:7168
    v_mfma_f32_16x16x32_bf16 v[28:31], v[192:195], v[124:127], v[28:31]
    s_waitcnt lgkmcnt(4)
    v_mfma_f32_16x16x32_bf16 v[32:35], v[196:199], v[120:123], v[32:35]
    ds_read_b128 v[192:195], v8 offset:8192
    v_mfma_f32_16x16x32_bf16 v[36:39], v[196:199], v[124:127], v[36:39]
    v_mfma_f32_16x16x32_bf16 v[40:43], v[200:203], v[120:123], v[40:43]
    ds_read_b128 v[196:199], v8 offset:9216
    v_mfma_f32_16x16x32_bf16 v[44:47], v[200:203], v[124:127], v[44:47]
    s_waitcnt lgkmcnt(4)
    v_mfma_f32_16x16x32_bf16 v[48:51], v[204:207], v[120:123], v[48:51]
    ds_read_b128 v[200:203], v8 offset:10240
    v_mfma_f32_16x16x32_bf16 v[52:55], v[204:207], v[124:127], v[52:55]
    v_mfma_f32_16x16x32_bf16 v[56:59], v[208:211], v[120:123], v[56:59]
    ds_read_b128 v[204:207], v8 offset:11264
    v_mfma_f32_16x16x32_bf16 v[60:63], v[208:211], v[124:127], v[60:63]
    s_waitcnt lgkmcnt(4)
    v_mfma_f32_16x16x32_bf16 v[64:67], v[212:215], v[120:123], v[64:67]
    s_barrier
    ds_read_b128 v[112:115], v221 offset:20480
    ds_read_b128 v[116:119], v221 offset:21504
    ds_read_b128 v[208:211], v8 offset:20480
    v_mfma_f32_16x16x32_bf16 v[68:71], v[212:215], v[124:127], v[68:71]
    v_mfma_f32_16x16x32_bf16 v[72:75], v[216:219], v[120:123], v[72:75]
    ds_read_b128 v[212:215], v8 offset:21504
    v_mfma_f32_16x16x32_bf16 v[76:79], v[216:219], v[124:127], v[76:79]
    s_waitcnt lgkmcnt(6)
    v_mfma_f32_16x16x32_bf16 v[80:83], v[192:195], v[120:123], v[80:83]
    ds_read_b128 v[216:219], v8 offset:22528
    v_mfma_f32_16x16x32_bf16 v[84:87], v[192:195], v[124:127], v[84:87]
    v_mfma_f32_16x16x32_bf16 v[88:91], v[196:199], v[120:123], v[88:91]
    ds_read_b128 v[192:195], v8 offset:23552
    v_mfma_f32_16x16x32_bf16 v[92:95], v[196:199], v[124:127], v[92:95]
    s_waitcnt lgkmcnt(6)
    v_mfma_f32_16x16x32_bf16 v[96:99], v[200:203], v[120:123], v[96:99]
    ds_read_b128 v[196:199], v8 offset:24576
    v_mfma_f32_16x16x32_bf16 v[100:103], v[200:203], v[124:127], v[100:103]
    v_mfma_f32_16x16x32_bf16 v[104:107], v[204:207], v[120:123], v[104:107]
    ds_read_b128 v[200:203], v8 offset:25600
    v_mfma_f32_16x16x32_bf16 v[108:111], v[204:207], v[124:127], v[108:111]
    s_waitcnt lgkmcnt(4)
    v_mfma_f32_16x16x32_bf16 v[16:19], v[208:211], v[112:115], v[16:19]
    ds_read_b128 v[204:207], v8 offset:26624
    v_mfma_f32_16x16x32_bf16 v[20:23], v[208:211], v[116:119], v[20:23]
    v_mfma_f32_16x16x32_bf16 v[24:27], v[212:215], v[112:115], v[24:27]
    ds_read_b128 v[208:211], v8 offset:27648
    v_mfma_f32_16x16x32_bf16 v[28:31], v[212:215], v[116:119], v[28:31]
    s_waitcnt lgkmcnt(4)
    v_mfma_f32_16x16x32_bf16 v[32:35], v[216:219], v[112:115], v[32:35]
    ds_read_b128 v[212:215], v8 offset:28672
    v_mfma_f32_16x16x32_bf16 v[36:39], v[216:219], v[116:119], v[36:39]
    v_mfma_f32_16x16x32_bf16 v[40:43], v[192:195], v[112:115], v[40:43]
    ds_read_b128 v[216:219], v8 offset:29696
    v_mfma_f32_16x16x32_bf16 v[44:47], v[192:195], v[116:119], v[44:47]
    s_waitcnt lgkmcnt(4)
    v_mfma_f32_16x16x32_bf16 v[48:51], v[196:199], v[112:115], v[48:51]
    ds_read_b128 v[192:195], v8 offset:30720
    v_mfma_f32_16x16x32_bf16 v[52:55], v[196:199], v[116:119], v[52:55]
    v_mfma_f32_16x16x32_bf16 v[56:59], v[200:203], v[112:115], v[56:59]
    ds_read_b128 v[196:199], v8 offset:31744
    v_mfma_f32_16x16x32_bf16 v[60:63], v[200:203], v[116:119], v[60:63]
    s_waitcnt lgkmcnt(4)
    v_mfma_f32_16x16x32_bf16 v[64:67], v[204:207], v[112:115], v[64:67]
    s_barrier
    ds_read_b128 v[120:123], v221 offset:40960
    ds_read_b128 v[124:127], v221 offset:41984
    ds_read_b128 v[200:203], v8 offset:40960
    v_mfma_f32_16x16x32_bf16 v[68:71], v[204:207], v[116:119], v[68:71]
    v_mfma_f32_16x16x32_bf16 v[72:75], v[208:211], v[112:115], v[72:75]
    ds_read_b128 v[204:207], v8 offset:41984
    v_mfma_f32_16x16x32_bf16 v[76:79], v[208:211], v[116:119], v[76:79]
    s_waitcnt lgkmcnt(6)
    v_mfma_f32_16x16x32_bf16 v[80:83], v[212:215], v[112:115], v[80:83]
    ds_read_b128 v[208:211], v8 offset:43008
    v_mfma_f32_16x16x32_bf16 v[84:87], v[212:215], v[116:119], v[84:87]
    v_mfma_f32_16x16x32_bf16 v[88:91], v[216:219], v[112:115], v[88:91]
    ds_read_b128 v[212:215], v8 offset:44032
    v_mfma_f32_16x16x32_bf16 v[92:95], v[216:219], v[116:119], v[92:95]
    s_waitcnt lgkmcnt(6)
    v_mfma_f32_16x16x32_bf16 v[96:99], v[192:195], v[112:115], v[96:99]
    ds_read_b128 v[216:219], v8 offset:45056
    v_mfma_f32_16x16x32_bf16 v[100:103], v[192:195], v[116:119], v[100:103]
    v_mfma_f32_16x16x32_bf16 v[104:107], v[196:199], v[112:115], v[104:107]
    ds_read_b128 v[192:195], v8 offset:46080
    v_mfma_f32_16x16x32_bf16 v[108:111], v[196:199], v[116:119], v[108:111]
    s_waitcnt lgkmcnt(4)
    v_mfma_f32_16x16x32_bf16 v[16:19], v[200:203], v[120:123], v[16:19]
    ds_read_b128 v[196:199], v8 offset:47104
    v_mfma_f32_16x16x32_bf16 v[20:23], v[200:203], v[124:127], v[20:23]
    v_mfma_f32_16x16x32_bf16 v[24:27], v[204:207], v[120:123], v[24:27]
    ds_read_b128 v[200:203], v8 offset:48128
    v_mfma_f32_16x16x32_bf16 v[28:31], v[204:207], v[124:127], v[28:31]
    s_waitcnt lgkmcnt(4)
    v_mfma_f32_16x16x32_bf16 v[32:35], v[208:211], v[120:123], v[32:35]
    ds_read_b128 v[204:207], v8 offset:49152
    v_mfma_f32_16x16x32_bf16 v[36:39], v[208:211], v[124:127], v[36:39]
    v_mfma_f32_16x16x32_bf16 v[40:43], v[212:215], v[120:123], v[40:43]
    ds_read_b128 v[208:211], v8 offset:50176
    v_mfma_f32_16x16x32_bf16 v[44:47], v[212:215], v[124:127], v[44:47]
    s_waitcnt lgkmcnt(4)
    v_mfma_f32_16x16x32_bf16 v[48:51], v[216:219], v[120:123], v[48:51]
    ds_read_b128 v[212:215], v8 offset:51200
    v_mfma_f32_16x16x32_bf16 v[52:55], v[216:219], v[124:127], v[52:55]
    v_mfma_f32_16x16x32_bf16 v[56:59], v[192:195], v[120:123], v[56:59]
    ds_read_b128 v[216:219], v8 offset:52224
    v_mfma_f32_16x16x32_bf16 v[60:63], v[192:195], v[124:127], v[60:63]
    s_waitcnt lgkmcnt(4)
    v_mfma_f32_16x16x32_bf16 v[64:67], v[196:199], v[120:123], v[64:67]
    s_barrier
    ds_read_b128 v[112:115], v222 offset:0
    ds_read_b128 v[116:119], v222 offset:1024
    ds_read_b128 v[192:195], v9 offset:0
    v_mfma_f32_16x16x32_bf16 v[68:71], v[196:199], v[124:127], v[68:71]
    v_mfma_f32_16x16x32_bf16 v[72:75], v[200:203], v[120:123], v[72:75]
    ds_read_b128 v[196:199], v9 offset:1024
    v_mfma_f32_16x16x32_bf16 v[76:79], v[200:203], v[124:127], v[76:79]
    s_waitcnt lgkmcnt(6)
    v_mfma_f32_16x16x32_bf16 v[80:83], v[204:207], v[120:123], v[80:83]
    ds_read_b128 v[200:203], v9 offset:2048
    v_mfma_f32_16x16x32_bf16 v[84:87], v[204:207], v[124:127], v[84:87]
    v_mfma_f32_16x16x32_bf16 v[88:91], v[208:211], v[120:123], v[88:91]
    ds_read_b128 v[204:207], v9 offset:3072
    v_mfma_f32_16x16x32_bf16 v[92:95], v[208:211], v[124:127], v[92:95]
    s_waitcnt lgkmcnt(6)
    v_mfma_f32_16x16x32_bf16 v[96:99], v[212:215], v[120:123], v[96:99]
    ds_read_b128 v[208:211], v9 offset:4096
    v_mfma_f32_16x16x32_bf16 v[100:103], v[212:215], v[124:127], v[100:103]
    v_mfma_f32_16x16x32_bf16 v[104:107], v[216:219], v[120:123], v[104:107]
    ds_read_b128 v[212:215], v9 offset:5120
    v_mfma_f32_16x16x32_bf16 v[108:111], v[216:219], v[124:127], v[108:111]
    s_waitcnt lgkmcnt(4)
    v_mfma_f32_16x16x32_bf16 v[16:19], v[192:195], v[112:115], v[16:19]
    ds_read_b128 v[216:219], v9 offset:6144
    v_mfma_f32_16x16x32_bf16 v[20:23], v[192:195], v[116:119], v[20:23]
    v_mfma_f32_16x16x32_bf16 v[24:27], v[196:199], v[112:115], v[24:27]
    ds_read_b128 v[192:195], v9 offset:7168
    v_mfma_f32_16x16x32_bf16 v[28:31], v[196:199], v[116:119], v[28:31]
    s_waitcnt lgkmcnt(4)
    v_mfma_f32_16x16x32_bf16 v[32:35], v[200:203], v[112:115], v[32:35]
    ds_read_b128 v[196:199], v9 offset:8192
    v_mfma_f32_16x16x32_bf16 v[36:39], v[200:203], v[116:119], v[36:39]
    v_mfma_f32_16x16x32_bf16 v[40:43], v[204:207], v[112:115], v[40:43]
    ds_read_b128 v[200:203], v9 offset:9216
    v_mfma_f32_16x16x32_bf16 v[44:47], v[204:207], v[116:119], v[44:47]
    s_waitcnt lgkmcnt(4)
    v_mfma_f32_16x16x32_bf16 v[48:51], v[208:211], v[112:115], v[48:51]
    ds_read_b128 v[204:207], v9 offset:10240
    v_mfma_f32_16x16x32_bf16 v[52:55], v[208:211], v[116:119], v[52:55]
    v_mfma_f32_16x16x32_bf16 v[56:59], v[212:215], v[112:115], v[56:59]
    ds_read_b128 v[208:211], v9 offset:11264
    v_mfma_f32_16x16x32_bf16 v[60:63], v[212:215], v[116:119], v[60:63]
    s_waitcnt lgkmcnt(4)
    v_mfma_f32_16x16x32_bf16 v[64:67], v[216:219], v[112:115], v[64:67]
    s_barrier
    ds_read_b128 v[120:123], v222 offset:20480
    ds_read_b128 v[124:127], v222 offset:21504
    ds_read_b128 v[212:215], v9 offset:20480
    v_mfma_f32_16x16x32_bf16 v[68:71], v[216:219], v[116:119], v[68:71]
    v_mfma_f32_16x16x32_bf16 v[72:75], v[192:195], v[112:115], v[72:75]
    ds_read_b128 v[216:219], v9 offset:21504
    v_mfma_f32_16x16x32_bf16 v[76:79], v[192:195], v[116:119], v[76:79]
    s_waitcnt lgkmcnt(6)
    v_mfma_f32_16x16x32_bf16 v[80:83], v[196:199], v[112:115], v[80:83]
    ds_read_b128 v[192:195], v9 offset:22528
    v_mfma_f32_16x16x32_bf16 v[84:87], v[196:199], v[116:119], v[84:87]
    v_mfma_f32_16x16x32_bf16 v[88:91], v[200:203], v[112:115], v[88:91]
    ds_read_b128 v[196:199], v9 offset:23552
    v_mfma_f32_16x16x32_bf16 v[92:95], v[200:203], v[116:119], v[92:95]
    s_waitcnt lgkmcnt(6)
    v_mfma_f32_16x16x32_bf16 v[96:99], v[204:207], v[112:115], v[96:99]
    ds_read_b128 v[200:203], v9 offset:24576
    v_mfma_f32_16x16x32_bf16 v[100:103], v[204:207], v[116:119], v[100:103]
    v_mfma_f32_16x16x32_bf16 v[104:107], v[208:211], v[112:115], v[104:107]
    ds_read_b128 v[204:207], v9 offset:25600
    v_mfma_f32_16x16x32_bf16 v[108:111], v[208:211], v[116:119], v[108:111]
    s_waitcnt lgkmcnt(4)
    v_mfma_f32_16x16x32_bf16 v[16:19], v[212:215], v[120:123], v[16:19]
    ds_read_b128 v[208:211], v9 offset:26624
    v_mfma_f32_16x16x32_bf16 v[20:23], v[212:215], v[124:127], v[20:23]
    v_cvt_pk_bf16_f32 v12, v224, v224
    v_and_b32 v13, 0xffff0000, v12
    v_mfma_f32_16x16x32_bf16 v[24:27], v[216:219], v[120:123], v[24:27]
    ds_read_b128 v[212:215], v9 offset:27648
    v_mfma_f32_16x16x32_bf16 v[28:31], v[216:219], v[124:127], v[28:31]
    v_sub_f32 v13, v13, v224
    v_xor_b32 v177, 0x80008000, v12
    s_waitcnt lgkmcnt(4)
    v_mfma_f32_16x16x32_bf16 v[32:35], v[192:195], v[120:123], v[32:35]
    ds_read_b128 v[216:219], v9 offset:28672
    v_mfma_f32_16x16x32_bf16 v[36:39], v[192:195], v[124:127], v[36:39]
    v_cvt_pk_bf16_f32 v13, v13, v13
    v_mov_b32 v178, 0
    v_mfma_f32_16x16x32_bf16 v[40:43], v[196:199], v[120:123], v[40:43]
    ds_read_b128 v[192:195], v9 offset:29696
    v_mfma_f32_16x16x32_bf16 v[44:47], v[196:199], v[124:127], v[44:47]
    v_mov_b32 v179, 0
    v_and_b32 v12, 0xffff, v177
    s_waitcnt lgkmcnt(4)
    v_mfma_f32_16x16x32_bf16 v[48:51], v[200:203], v[120:123], v[48:51]
    ds_read_b128 v[196:199], v9 offset:30720
    v_mfma_f32_16x16x32_bf16 v[52:55], v[200:203], v[124:127], v[52:55]
    v_lshlrev_b32 v13, 16, v13
    v_or_b32 v176, v12, v13
    v_mfma_f32_16x16x32_bf16 v[56:59], v[204:207], v[120:123], v[56:59]
    ds_read_b128 v[200:203], v9 offset:31744
    v_mfma_f32_16x16x32_bf16 v[60:63], v[204:207], v[124:127], v[60:63]
    v_cvt_pk_bf16_f32 v12, v228, v228
    v_and_b32 v13, 0xffff0000, v12
    s_waitcnt lgkmcnt(4)
    v_mfma_f32_16x16x32_bf16 v[64:67], v[208:211], v[120:123], v[64:67]
    s_barrier
    ds_read_b128 v[112:115], v220 offset:0
    ds_read_b128 v[116:119], v220 offset:1024
    ds_read_b128 v[204:207], v7 offset:0
    v_mfma_f32_16x16x32_bf16 v[68:71], v[208:211], v[124:127], v[68:71]
    v_sub_f32 v13, v13, v228
    v_xor_b32 v181, 0x80008000, v12
    v_mfma_f32_16x16x32_bf16 v[72:75], v[212:215], v[120:123], v[72:75]
    ds_read_b128 v[208:211], v7 offset:1024
    v_mfma_f32_16x16x32_bf16 v[76:79], v[212:215], v[124:127], v[76:79]
    v_cvt_pk_bf16_f32 v13, v13, v13
    v_mov_b32 v182, 0
    s_waitcnt lgkmcnt(6)
    v_mfma_f32_16x16x32_bf16 v[80:83], v[216:219], v[120:123], v[80:83]
    ds_read_b128 v[212:215], v7 offset:2048
    v_mfma_f32_16x16x32_bf16 v[84:87], v[216:219], v[124:127], v[84:87]
    v_mov_b32 v183, 0
    v_and_b32 v12, 0xffff, v181
    v_mfma_f32_16x16x32_bf16 v[88:91], v[192:195], v[120:123], v[88:91]
    ds_read_b128 v[216:219], v7 offset:3072
    v_mfma_f32_16x16x32_bf16 v[92:95], v[192:195], v[124:127], v[92:95]
    v_lshlrev_b32 v13, 16, v13
    v_or_b32 v180, v12, v13
    s_waitcnt lgkmcnt(6)
    v_mfma_f32_16x16x32_bf16 v[96:99], v[196:199], v[120:123], v[96:99]
    ds_read_b128 v[192:195], v7 offset:4096
    v_mfma_f32_16x16x32_bf16 v[100:103], v[196:199], v[124:127], v[100:103]
    v_mfma_f32_16x16x32_bf16 v[104:107], v[200:203], v[120:123], v[104:107]
    ds_read_b128 v[196:199], v7 offset:5120
    v_mfma_f32_16x16x32_bf16 v[108:111], v[200:203], v[124:127], v[108:111]
    s_waitcnt lgkmcnt(4)
    v_mfma_f32_16x16x32_bf16 v[16:19], v[204:207], v[112:115], v[16:19]
    ds_read_b128 v[200:203], v7 offset:6144
    v_mfma_f32_16x16x32_bf16 v[20:23], v[204:207], v[116:119], v[20:23]
    v_mfma_f32_16x16x32_bf16 v[24:27], v[208:211], v[112:115], v[24:27]
    ds_read_b128 v[204:207], v7 offset:7168
    v_mfma_f32_16x16x32_bf16 v[28:31], v[208:211], v[116:119], v[28:31]
    s_waitcnt lgkmcnt(4)
    v_mfma_f32_16x16x32_bf16 v[32:35], v[212:215], v[112:115], v[32:35]
    ds_read_b128 v[208:211], v7 offset:8192
    v_mfma_f32_16x16x32_bf16 v[36:39], v[212:215], v[116:119], v[36:39]
    v_mfma_f32_16x16x32_bf16 v[40:43], v[216:219], v[112:115], v[40:43]
    ds_read_b128 v[212:215], v7 offset:9216
    v_mfma_f32_16x16x32_bf16 v[44:47], v[216:219], v[116:119], v[44:47]
    s_waitcnt lgkmcnt(4)
    v_mfma_f32_16x16x32_bf16 v[48:51], v[192:195], v[112:115], v[48:51]
    ds_read_b128 v[216:219], v7 offset:10240
    v_mfma_f32_16x16x32_bf16 v[52:55], v[192:195], v[116:119], v[52:55]
    v_mfma_f32_16x16x32_bf16 v[56:59], v[196:199], v[112:115], v[56:59]
    ds_read_b128 v[192:195], v7 offset:11264
    v_mfma_f32_16x16x32_bf16 v[60:63], v[196:199], v[116:119], v[60:63]
    s_waitcnt lgkmcnt(4)
    v_mfma_f32_16x16x32_bf16 v[64:67], v[200:203], v[112:115], v[64:67]
    s_barrier
    ds_read_b128 v[120:123], v220 offset:20480
    ds_read_b128 v[124:127], v220 offset:21504
    ds_read_b128 v[196:199], v7 offset:20480
    v_mfma_f32_16x16x32_bf16 v[68:71], v[200:203], v[116:119], v[68:71]
    v_mfma_f32_16x16x32_bf16 v[72:75], v[204:207], v[112:115], v[72:75]
    ds_read_b128 v[200:203], v7 offset:21504
    v_mfma_f32_16x16x32_bf16 v[76:79], v[204:207], v[116:119], v[76:79]
    s_waitcnt lgkmcnt(6)
    v_mfma_f32_16x16x32_bf16 v[80:83], v[208:211], v[112:115], v[80:83]
    ds_read_b128 v[204:207], v7 offset:22528
    v_mfma_f32_16x16x32_bf16 v[84:87], v[208:211], v[116:119], v[84:87]
    v_mfma_f32_16x16x32_bf16 v[88:91], v[212:215], v[112:115], v[88:91]
    ds_read_b128 v[208:211], v7 offset:23552
    v_mfma_f32_16x16x32_bf16 v[92:95], v[212:215], v[116:119], v[92:95]
    s_waitcnt lgkmcnt(6)
    v_mfma_f32_16x16x32_bf16 v[96:99], v[216:219], v[112:115], v[96:99]
    ds_read_b128 v[212:215], v7 offset:24576
    v_mfma_f32_16x16x32_bf16 v[100:103], v[216:219], v[116:119], v[100:103]
    v_mfma_f32_16x16x32_bf16 v[104:107], v[192:195], v[112:115], v[104:107]
    ds_read_b128 v[216:219], v7 offset:25600
    v_mfma_f32_16x16x32_bf16 v[108:111], v[192:195], v[116:119], v[108:111]
    s_waitcnt lgkmcnt(4)
    v_mfma_f32_16x16x32_bf16 v[16:19], v[196:199], v[120:123], v[16:19]
    ds_read_b128 v[192:195], v7 offset:26624
    v_mfma_f32_16x16x32_bf16 v[20:23], v[196:199], v[124:127], v[20:23]
    v_mfma_f32_16x16x32_bf16 v[24:27], v[200:203], v[120:123], v[24:27]
    ds_read_b128 v[196:199], v7 offset:27648
    v_mfma_f32_16x16x32_bf16 v[28:31], v[200:203], v[124:127], v[28:31]
    s_waitcnt lgkmcnt(4)
    v_mfma_f32_16x16x32_bf16 v[32:35], v[204:207], v[120:123], v[32:35]
    ds_read_b128 v[200:203], v7 offset:28672
    v_mfma_f32_16x16x32_bf16 v[36:39], v[204:207], v[124:127], v[36:39]
    v_mfma_f32_16x16x32_bf16 v[40:43], v[208:211], v[120:123], v[40:43]
    ds_read_b128 v[204:207], v7 offset:29696
    v_mfma_f32_16x16x32_bf16 v[44:47], v[208:211], v[124:127], v[44:47]
    s_waitcnt lgkmcnt(4)
    v_mfma_f32_16x16x32_bf16 v[48:51], v[212:215], v[120:123], v[48:51]
    ds_read_b128 v[208:211], v7 offset:30720
    v_mfma_f32_16x16x32_bf16 v[52:55], v[212:215], v[124:127], v[52:55]
    v_mfma_f32_16x16x32_bf16 v[56:59], v[216:219], v[120:123], v[56:59]
    ds_read_b128 v[212:215], v7 offset:31744
    v_mfma_f32_16x16x32_bf16 v[60:63], v[216:219], v[124:127], v[60:63]
    s_waitcnt lgkmcnt(4)
    v_mfma_f32_16x16x32_bf16 v[64:67], v[192:195], v[120:123], v[64:67]
    s_barrier
    ds_read_b128 v[112:115], v220 offset:40960
    ds_read_b128 v[116:119], v220 offset:41984
    ds_read_b128 v[216:219], v7 offset:40960
    v_mfma_f32_16x16x32_bf16 v[68:71], v[192:195], v[124:127], v[68:71]
    v_mfma_f32_16x16x32_bf16 v[72:75], v[196:199], v[120:123], v[72:75]
    ds_read_b128 v[192:195], v7 offset:41984
    v_mfma_f32_16x16x32_bf16 v[76:79], v[196:199], v[124:127], v[76:79]
    s_waitcnt lgkmcnt(6)
    v_mfma_f32_16x16x32_bf16 v[80:83], v[200:203], v[120:123], v[80:83]
    ds_read_b128 v[196:199], v7 offset:43008
    v_mfma_f32_16x16x32_bf16 v[84:87], v[200:203], v[124:127], v[84:87]
    v_mfma_f32_16x16x32_bf16 v[88:91], v[204:207], v[120:123], v[88:91]
    ds_read_b128 v[200:203], v7 offset:44032
    v_mfma_f32_16x16x32_bf16 v[92:95], v[204:207], v[124:127], v[92:95]
    s_waitcnt lgkmcnt(6)
    v_mfma_f32_16x16x32_bf16 v[96:99], v[208:211], v[120:123], v[96:99]
    ds_read_b128 v[204:207], v7 offset:45056
    v_mfma_f32_16x16x32_bf16 v[100:103], v[208:211], v[124:127], v[100:103]
    v_mfma_f32_16x16x32_bf16 v[104:107], v[212:215], v[120:123], v[104:107]
    ds_read_b128 v[208:211], v7 offset:46080
    v_mfma_f32_16x16x32_bf16 v[108:111], v[212:215], v[124:127], v[108:111]
    s_waitcnt lgkmcnt(4)
    v_mfma_f32_16x16x32_bf16 v[16:19], v[216:219], v[112:115], v[16:19]
    ds_read_b128 v[212:215], v7 offset:47104
    v_mfma_f32_16x16x32_bf16 v[20:23], v[216:219], v[116:119], v[20:23]
    v_mfma_f32_16x16x32_bf16 v[24:27], v[192:195], v[112:115], v[24:27]
    ds_read_b128 v[216:219], v7 offset:48128
    v_mfma_f32_16x16x32_bf16 v[28:31], v[192:195], v[116:119], v[28:31]
    s_waitcnt lgkmcnt(4)
    v_mfma_f32_16x16x32_bf16 v[32:35], v[196:199], v[112:115], v[32:35]
    ds_read_b128 v[192:195], v7 offset:49152
    v_mfma_f32_16x16x32_bf16 v[36:39], v[196:199], v[116:119], v[36:39]
    v_mfma_f32_16x16x32_bf16 v[40:43], v[200:203], v[112:115], v[40:43]
    ds_read_b128 v[196:199], v7 offset:50176
    v_mfma_f32_16x16x32_bf16 v[44:47], v[200:203], v[116:119], v[44:47]
    s_waitcnt lgkmcnt(4)
    v_mfma_f32_16x16x32_bf16 v[48:51], v[204:207], v[112:115], v[48:51]
    ds_read_b128 v[200:203], v7 offset:51200
    v_mfma_f32_16x16x32_bf16 v[52:55], v[204:207], v[116:119], v[52:55]
    v_mfma_f32_16x16x32_bf16 v[56:59], v[208:211], v[112:115], v[56:59]
    ds_read_b128 v[204:207], v7 offset:52224
    v_mfma_f32_16x16x32_bf16 v[60:63], v[208:211], v[116:119], v[60:63]
    s_waitcnt lgkmcnt(4)
    v_mfma_f32_16x16x32_bf16 v[64:67], v[212:215], v[112:115], v[64:67]
    s_barrier
    ds_read_b128 v[120:123], v221 offset:0
    ds_read_b128 v[124:127], v221 offset:1024
    ds_read_b128 v[208:211], v8 offset:0
    v_mfma_f32_16x16x32_bf16 v[68:71], v[212:215], v[116:119], v[68:71]
    v_mfma_f32_16x16x32_bf16 v[72:75], v[216:219], v[112:115], v[72:75]
    ds_read_b128 v[212:215], v8 offset:1024
    v_mfma_f32_16x16x32_bf16 v[76:79], v[216:219], v[116:119], v[76:79]
    s_waitcnt lgkmcnt(6)
    v_mfma_f32_16x16x32_bf16 v[80:83], v[192:195], v[112:115], v[80:83]
    ds_read_b128 v[216:219], v8 offset:2048
    v_mfma_f32_16x16x32_bf16 v[84:87], v[192:195], v[116:119], v[84:87]
    v_mfma_f32_16x16x32_bf16 v[88:91], v[196:199], v[112:115], v[88:91]
    ds_read_b128 v[192:195], v8 offset:3072
    v_mfma_f32_16x16x32_bf16 v[92:95], v[196:199], v[116:119], v[92:95]
    s_waitcnt lgkmcnt(6)
    v_mfma_f32_16x16x32_bf16 v[96:99], v[200:203], v[112:115], v[96:99]
    ds_read_b128 v[196:199], v8 offset:4096
    v_mfma_f32_16x16x32_bf16 v[100:103], v[200:203], v[116:119], v[100:103]
    v_mfma_f32_16x16x32_bf16 v[104:107], v[204:207], v[112:115], v[104:107]
    ds_read_b128 v[200:203], v8 offset:5120
    v_mfma_f32_16x16x32_bf16 v[108:111], v[204:207], v[116:119], v[108:111]
    s_waitcnt lgkmcnt(4)
    v_mfma_f32_16x16x32_bf16 v[16:19], v[208:211], v[120:123], v[16:19]
    ds_read_b128 v[204:207], v8 offset:6144
    v_mfma_f32_16x16x32_bf16 v[20:23], v[208:211], v[124:127], v[20:23]
    v_mfma_f32_16x16x32_bf16 v[24:27], v[212:215], v[120:123], v[24:27]
    ds_read_b128 v[208:211], v8 offset:7168
    v_mfma_f32_16x16x32_bf16 v[28:31], v[212:215], v[124:127], v[28:31]
    s_waitcnt lgkmcnt(4)
    v_mfma_f32_16x16x32_bf16 v[32:35], v[216:219], v[120:123], v[32:35]
    ds_read_b128 v[212:215], v8 offset:8192
    v_mfma_f32_16x16x32_bf16 v[36:39], v[216:219], v[124:127], v[36:39]
    v_mfma_f32_16x16x32_bf16 v[40:43], v[192:195], v[120:123], v[40:43]
    ds_read_b128 v[216:219], v8 offset:9216
    v_mfma_f32_16x16x32_bf16 v[44:47], v[192:195], v[124:127], v[44:47]
    s_waitcnt lgkmcnt(4)
    v_mfma_f32_16x16x32_bf16 v[48:51], v[196:199], v[120:123], v[48:51]
    ds_read_b128 v[192:195], v8 offset:10240
    v_mfma_f32_16x16x32_bf16 v[52:55], v[196:199], v[124:127], v[52:55]
    v_mfma_f32_16x16x32_bf16 v[56:59], v[200:203], v[120:123], v[56:59]
    ds_read_b128 v[196:199], v8 offset:11264
    v_mfma_f32_16x16x32_bf16 v[60:63], v[200:203], v[124:127], v[60:63]
    s_waitcnt lgkmcnt(4)
    v_mfma_f32_16x16x32_bf16 v[64:67], v[204:207], v[120:123], v[64:67]
    s_barrier
    ds_read_b128 v[200:203], v8 offset:20480
    v_mfma_f32_16x16x32_bf16 v[68:71], v[204:207], v[124:127], v[68:71]
    v_mfma_f32_16x16x32_bf16 v[72:75], v[208:211], v[120:123], v[72:75]
    ds_read_b128 v[204:207], v8 offset:21504
    v_mfma_f32_16x16x32_bf16 v[76:79], v[208:211], v[124:127], v[76:79]
    s_waitcnt lgkmcnt(4)
    v_mfma_f32_16x16x32_bf16 v[80:83], v[212:215], v[120:123], v[80:83]
    ds_read_b128 v[208:211], v8 offset:22528
    v_mfma_f32_16x16x32_bf16 v[84:87], v[212:215], v[124:127], v[84:87]
    v_mfma_f32_16x16x32_bf16 v[88:91], v[216:219], v[120:123], v[88:91]
    ds_read_b128 v[212:215], v8 offset:23552
    v_mfma_f32_16x16x32_bf16 v[92:95], v[216:219], v[124:127], v[92:95]
    s_waitcnt lgkmcnt(4)
    v_mfma_f32_16x16x32_bf16 v[96:99], v[192:195], v[120:123], v[96:99]
    ds_read_b128 v[216:219], v8 offset:24576
    v_mfma_f32_16x16x32_bf16 v[100:103], v[192:195], v[124:127], v[100:103]
    v_mfma_f32_16x16x32_bf16 v[104:107], v[196:199], v[120:123], v[104:107]
    ds_read_b128 v[192:195], v8 offset:25600
    v_mfma_f32_16x16x32_bf16 v[108:111], v[196:199], v[124:127], v[108:111]
    s_waitcnt lgkmcnt(4)
    v_mfma_f32_16x16x32_bf16 v[16:19], v[200:203], v[176:179], v[16:19]
    ds_read_b128 v[196:199], v8 offset:26624
    v_mfma_f32_16x16x32_bf16 v[20:23], v[200:203], v[180:183], v[20:23]
    v_mfma_f32_16x16x32_bf16 v[24:27], v[204:207], v[176:179], v[24:27]
    ds_read_b128 v[200:203], v8 offset:27648
    v_mfma_f32_16x16x32_bf16 v[28:31], v[204:207], v[180:183], v[28:31]
    s_waitcnt lgkmcnt(4)
    v_mfma_f32_16x16x32_bf16 v[32:35], v[208:211], v[176:179], v[32:35]
    ds_read_b128 v[204:207], v8 offset:28672
    v_mfma_f32_16x16x32_bf16 v[36:39], v[208:211], v[180:183], v[36:39]
    v_mfma_f32_16x16x32_bf16 v[40:43], v[212:215], v[176:179], v[40:43]
    ds_read_b128 v[208:211], v8 offset:29696
    v_mfma_f32_16x16x32_bf16 v[44:47], v[212:215], v[180:183], v[44:47]
    s_waitcnt lgkmcnt(4)
    v_mfma_f32_16x16x32_bf16 v[48:51], v[216:219], v[176:179], v[48:51]
    ds_read_b128 v[212:215], v8 offset:30720
    v_mfma_f32_16x16x32_bf16 v[52:55], v[216:219], v[180:183], v[52:55]
    v_mfma_f32_16x16x32_bf16 v[56:59], v[192:195], v[176:179], v[56:59]
    ds_read_b128 v[216:219], v8 offset:31744
    v_mfma_f32_16x16x32_bf16 v[60:63], v[192:195], v[180:183], v[60:63]
    s_waitcnt lgkmcnt(4)
    v_mfma_f32_16x16x32_bf16 v[64:67], v[196:199], v[176:179], v[64:67]
    v_mfma_f32_16x16x32_bf16 v[68:71], v[196:199], v[180:183], v[68:71]
    v_mfma_f32_16x16x32_bf16 v[72:75], v[200:203], v[176:179], v[72:75]
    v_mfma_f32_16x16x32_bf16 v[76:79], v[200:203], v[180:183], v[76:79]
    s_waitcnt lgkmcnt(2)
    v_mfma_f32_16x16x32_bf16 v[80:83], v[204:207], v[176:179], v[80:83]
    v_mfma_f32_16x16x32_bf16 v[84:87], v[204:207], v[180:183], v[84:87]
    v_mfma_f32_16x16x32_bf16 v[88:91], v[208:211], v[176:179], v[88:91]
    v_mfma_f32_16x16x32_bf16 v[92:95], v[208:211], v[180:183], v[92:95]
    s_waitcnt lgkmcnt(0)
    v_mfma_f32_16x16x32_bf16 v[96:99], v[212:215], v[176:179], v[96:99]
    v_mfma_f32_16x16x32_bf16 v[100:103], v[212:215], v[180:183], v[100:103]
    v_mfma_f32_16x16x32_bf16 v[104:107], v[216:219], v[176:179], v[104:107]
    v_mfma_f32_16x16x32_bf16 v[108:111], v[216:219], v[180:183], v[108:111]
    v_rcp_f32 v226, v225
    v_mul_f32 v224, 0xbfb8aa3b, v225
    v_mul_f32 v226, 0xbfb8aa3b, v226
    v_rcp_f32 v230, v229
    v_mul_f32 v228, 0xbfb8aa3b, v229
    v_mul_f32 v230, 0xbfb8aa3b, v230
    s_mul_i32 s60, s31, 96
    s_add_u32 s60, s60, s71
    s_lshl_b32 s60, s60, 10
    s_add_u32 s60, s60, 15728640
    s_add_u32 s61, s60, 49152
    s_lshl_b32 s62, s31, 8
    s_lshr_b32 s63, s71, 3
    s_lshl_b32 s63, s63, 7
    s_add_u32 s62, s62, s63
    s_and_b32 s63, s71, 7
    s_lshl_b32 s63, s63, 2
    s_add_u32 s62, s62, s63
    s_add_u32 s62, s62, 360448
    v_pk_mul_f32 v[16:17], v[16:17], v[224:225] op_sel_hi:[1,0]
    v_pk_mul_f32 v[18:19], v[18:19], v[224:225] op_sel_hi:[1,0]
    v_pk_mul_f32 v[32:33], v[32:33], v[224:225] op_sel_hi:[1,0]
    v_pk_mul_f32 v[34:35], v[34:35], v[224:225] op_sel_hi:[1,0]
    v_exp_f32 v112, v16
    v_exp_f32 v113, v17
    v_exp_f32 v114, v18
    v_exp_f32 v115, v19
    v_exp_f32 v116, v32
    v_exp_f32 v117, v33
    v_exp_f32 v118, v34
    v_exp_f32 v119, v35
    v_pk_mul_f32 v[16:17], v[16:17], v[24:25]
    v_pk_mul_f32 v[18:19], v[18:19], v[26:27]
    v_pk_mul_f32 v[32:33], v[32:33], v[40:41]
    v_pk_mul_f32 v[34:35], v[34:35], v[42:43]
    v_pk_fma_f32 v[112:113], v[112:113], v[226:227], v[226:227] op_sel_hi:[1,0,0]
    v_pk_fma_f32 v[114:115], v[114:115], v[226:227], v[226:227] op_sel_hi:[1,0,0]
    v_pk_fma_f32 v[116:117], v[116:117], v[226:227], v[226:227] op_sel_hi:[1,0,0]
    v_pk_fma_f32 v[118:119], v[118:119], v[226:227], v[226:227] op_sel_hi:[1,0,0]
    v_rcp_f32 v112, v112
    v_rcp_f32 v113, v113
    v_rcp_f32 v114, v114
    v_rcp_f32 v115, v115
    v_rcp_f32 v116, v116
    v_rcp_f32 v117, v117
    v_rcp_f32 v118, v118
    v_rcp_f32 v119, v119
    v_pk_mul_f32 v[16:17], v[16:17], v[112:113]
    v_pk_mul_f32 v[18:19], v[18:19], v[114:115]
    v_pk_mul_f32 v[32:33], v[32:33], v[116:117]
    v_pk_mul_f32 v[34:35], v[34:35], v[118:119]
    v_cvt_pk_bf16_f32 v128, v16, v17
    v_cvt_pk_bf16_f32 v129, v18, v19
    v_cvt_pk_bf16_f32 v130, v32, v33
    v_cvt_pk_bf16_f32 v131, v34, v35
    buffer_store_dwordx4 v[128:131], v3, s[4:7], s60 offen sc1
    s_add_u32 s60, s60, 16384
    v_pk_mul_f32 v[20:21], v[20:21], v[228:229] op_sel_hi:[1,0]
    v_pk_mul_f32 v[22:23], v[22:23], v[228:229] op_sel_hi:[1,0]
    v_pk_mul_f32 v[36:37], v[36:37], v[228:229] op_sel_hi:[1,0]
    v_pk_mul_f32 v[38:39], v[38:39], v[228:229] op_sel_hi:[1,0]
    v_exp_f32 v112, v20
    v_exp_f32 v113, v21
    v_exp_f32 v114, v22
    v_exp_f32 v115, v23
    v_exp_f32 v116, v36
    v_exp_f32 v117, v37
    v_exp_f32 v118, v38
    v_exp_f32 v119, v39
    v_pk_mul_f32 v[20:21], v[20:21], v[28:29]
    v_pk_mul_f32 v[22:23], v[22:23], v[30:31]
    v_pk_mul_f32 v[36:37], v[36:37], v[44:45]
    v_pk_mul_f32 v[38:39], v[38:39], v[46:47]
    v_pk_fma_f32 v[112:113], v[112:113], v[230:231], v[230:231] op_sel_hi:[1,0,0]
    v_pk_fma_f32 v[114:115], v[114:115], v[230:231], v[230:231] op_sel_hi:[1,0,0]
    v_pk_fma_f32 v[116:117], v[116:117], v[230:231], v[230:231] op_sel_hi:[1,0,0]
    v_pk_fma_f32 v[118:119], v[118:119], v[230:231], v[230:231] op_sel_hi:[1,0,0]
    v_rcp_f32 v112, v112
    v_rcp_f32 v113, v113
    v_rcp_f32 v114, v114
    v_rcp_f32 v115, v115
    v_rcp_f32 v116, v116
    v_rcp_f32 v117, v117
    v_rcp_f32 v118, v118
    v_rcp_f32 v119, v119
    v_pk_mul_f32 v[20:21], v[20:21], v[112:113]
    v_pk_mul_f32 v[22:23], v[22:23], v[114:115]
    v_pk_mul_f32 v[36:37], v[36:37], v[116:117]
    v_pk_mul_f32 v[38:39], v[38:39], v[118:119]
    v_cvt_pk_bf16_f32 v132, v20, v21
    v_cvt_pk_bf16_f32 v133, v22, v23
    v_cvt_pk_bf16_f32 v134, v36, v37
    v_cvt_pk_bf16_f32 v135, v38, v39
    buffer_store_dwordx4 v[132:135], v3, s[4:7], s61 offen sc1
    s_add_u32 s61, s61, 16384
    v_pk_mul_f32 v[48:49], v[48:49], v[224:225] op_sel_hi:[1,0]
    v_pk_mul_f32 v[50:51], v[50:51], v[224:225] op_sel_hi:[1,0]
    v_pk_mul_f32 v[64:65], v[64:65], v[224:225] op_sel_hi:[1,0]
    v_pk_mul_f32 v[66:67], v[66:67], v[224:225] op_sel_hi:[1,0]
    v_exp_f32 v112, v48
    v_exp_f32 v113, v49
    v_exp_f32 v114, v50
    v_exp_f32 v115, v51
    v_exp_f32 v116, v64
    v_exp_f32 v117, v65
    v_exp_f32 v118, v66
    v_exp_f32 v119, v67
    v_pk_mul_f32 v[48:49], v[48:49], v[56:57]
    v_pk_mul_f32 v[50:51], v[50:51], v[58:59]
    v_pk_mul_f32 v[64:65], v[64:65], v[72:73]
    v_pk_mul_f32 v[66:67], v[66:67], v[74:75]
    v_pk_fma_f32 v[112:113], v[112:113], v[226:227], v[226:227] op_sel_hi:[1,0,0]
    v_pk_fma_f32 v[114:115], v[114:115], v[226:227], v[226:227] op_sel_hi:[1,0,0]
    v_pk_fma_f32 v[116:117], v[116:117], v[226:227], v[226:227] op_sel_hi:[1,0,0]
    v_pk_fma_f32 v[118:119], v[118:119], v[226:227], v[226:227] op_sel_hi:[1,0,0]
    v_rcp_f32 v112, v112
    v_rcp_f32 v113, v113
    v_rcp_f32 v114, v114
    v_rcp_f32 v115, v115
    v_rcp_f32 v116, v116
    v_rcp_f32 v117, v117
    v_rcp_f32 v118, v118
    v_rcp_f32 v119, v119
    v_pk_mul_f32 v[48:49], v[48:49], v[112:113]
    v_pk_mul_f32 v[50:51], v[50:51], v[114:115]
    v_pk_mul_f32 v[64:65], v[64:65], v[116:117]
    v_pk_mul_f32 v[66:67], v[66:67], v[118:119]
    v_cvt_pk_bf16_f32 v136, v48, v49
    v_cvt_pk_bf16_f32 v137, v50, v51
    v_cvt_pk_bf16_f32 v138, v64, v65
    v_cvt_pk_bf16_f32 v139, v66, v67
    buffer_store_dwordx4 v[136:139], v3, s[4:7], s60 offen sc1
    s_add_u32 s60, s60, 16384
    v_pk_mul_f32 v[52:53], v[52:53], v[228:229] op_sel_hi:[1,0]
    v_pk_mul_f32 v[54:55], v[54:55], v[228:229] op_sel_hi:[1,0]
    v_pk_mul_f32 v[68:69], v[68:69], v[228:229] op_sel_hi:[1,0]
    v_pk_mul_f32 v[70:71], v[70:71], v[228:229] op_sel_hi:[1,0]
    v_exp_f32 v112, v52
    v_exp_f32 v113, v53
    v_exp_f32 v114, v54
    v_exp_f32 v115, v55
    v_exp_f32 v116, v68
    v_exp_f32 v117, v69
    v_exp_f32 v118, v70
    v_exp_f32 v119, v71
    v_pk_mul_f32 v[52:53], v[52:53], v[60:61]
    v_pk_mul_f32 v[54:55], v[54:55], v[62:63]
    v_pk_mul_f32 v[68:69], v[68:69], v[76:77]
    v_pk_mul_f32 v[70:71], v[70:71], v[78:79]
    v_pk_fma_f32 v[112:113], v[112:113], v[230:231], v[230:231] op_sel_hi:[1,0,0]
    v_pk_fma_f32 v[114:115], v[114:115], v[230:231], v[230:231] op_sel_hi:[1,0,0]
    v_pk_fma_f32 v[116:117], v[116:117], v[230:231], v[230:231] op_sel_hi:[1,0,0]
    v_pk_fma_f32 v[118:119], v[118:119], v[230:231], v[230:231] op_sel_hi:[1,0,0]
    v_rcp_f32 v112, v112
    v_rcp_f32 v113, v113
    v_rcp_f32 v114, v114
    v_rcp_f32 v115, v115
    v_rcp_f32 v116, v116
    v_rcp_f32 v117, v117
    v_rcp_f32 v118, v118
    v_rcp_f32 v119, v119
    v_pk_mul_f32 v[52:53], v[52:53], v[112:113]
    v_pk_mul_f32 v[54:55], v[54:55], v[114:115]
    v_pk_mul_f32 v[68:69], v[68:69], v[116:117]
    v_pk_mul_f32 v[70:71], v[70:71], v[118:119]
    v_cvt_pk_bf16_f32 v140, v52, v53
    v_cvt_pk_bf16_f32 v141, v54, v55
    v_cvt_pk_bf16_f32 v142, v68, v69
    v_cvt_pk_bf16_f32 v143, v70, v71
    buffer_store_dwordx4 v[140:143], v3, s[4:7], s61 offen sc1
    s_add_u32 s61, s61, 16384
    v_pk_mul_f32 v[80:81], v[80:81], v[224:225] op_sel_hi:[1,0]
    v_pk_mul_f32 v[82:83], v[82:83], v[224:225] op_sel_hi:[1,0]
    v_pk_mul_f32 v[96:97], v[96:97], v[224:225] op_sel_hi:[1,0]
    v_pk_mul_f32 v[98:99], v[98:99], v[224:225] op_sel_hi:[1,0]
    v_exp_f32 v112, v80
    v_exp_f32 v113, v81
    v_exp_f32 v114, v82
    v_exp_f32 v115, v83
    v_exp_f32 v116, v96
    v_exp_f32 v117, v97
    v_exp_f32 v118, v98
    v_exp_f32 v119, v99
    v_pk_mul_f32 v[80:81], v[80:81], v[88:89]
    v_pk_mul_f32 v[82:83], v[82:83], v[90:91]
    v_pk_mul_f32 v[96:97], v[96:97], v[104:105]
    v_pk_mul_f32 v[98:99], v[98:99], v[106:107]
    v_pk_fma_f32 v[112:113], v[112:113], v[226:227], v[226:227] op_sel_hi:[1,0,0]
    v_pk_fma_f32 v[114:115], v[114:115], v[226:227], v[226:227] op_sel_hi:[1,0,0]
    v_pk_fma_f32 v[116:117], v[116:117], v[226:227], v[226:227] op_sel_hi:[1,0,0]
    v_pk_fma_f32 v[118:119], v[118:119], v[226:227], v[226:227] op_sel_hi:[1,0,0]
    v_rcp_f32 v112, v112
    v_rcp_f32 v113, v113
    v_rcp_f32 v114, v114
    v_rcp_f32 v115, v115
    v_rcp_f32 v116, v116
    v_rcp_f32 v117, v117
    v_rcp_f32 v118, v118
    v_rcp_f32 v119, v119
    v_pk_mul_f32 v[80:81], v[80:81], v[112:113]
    v_pk_mul_f32 v[82:83], v[82:83], v[114:115]
    v_pk_mul_f32 v[96:97], v[96:97], v[116:117]
    v_pk_mul_f32 v[98:99], v[98:99], v[118:119]
    v_cvt_pk_bf16_f32 v128, v80, v81
    v_cvt_pk_bf16_f32 v129, v82, v83
    v_cvt_pk_bf16_f32 v130, v96, v97
    v_cvt_pk_bf16_f32 v131, v98, v99
    buffer_store_dwordx4 v[128:131], v3, s[4:7], s60 offen sc1
    v_pk_mul_f32 v[84:85], v[84:85], v[228:229] op_sel_hi:[1,0]
    v_pk_mul_f32 v[86:87], v[86:87], v[228:229] op_sel_hi:[1,0]
    v_pk_mul_f32 v[100:101], v[100:101], v[228:229] op_sel_hi:[1,0]
    v_pk_mul_f32 v[102:103], v[102:103], v[228:229] op_sel_hi:[1,0]
    v_exp_f32 v112, v84
    v_exp_f32 v113, v85
    v_exp_f32 v114, v86
    v_exp_f32 v115, v87
    v_exp_f32 v116, v100
    v_exp_f32 v117, v101
    v_exp_f32 v118, v102
    v_exp_f32 v119, v103
    v_pk_mul_f32 v[84:85], v[84:85], v[92:93]
    v_pk_mul_f32 v[86:87], v[86:87], v[94:95]
    v_pk_mul_f32 v[100:101], v[100:101], v[108:109]
    v_pk_mul_f32 v[102:103], v[102:103], v[110:111]
    v_pk_fma_f32 v[112:113], v[112:113], v[230:231], v[230:231] op_sel_hi:[1,0,0]
    v_pk_fma_f32 v[114:115], v[114:115], v[230:231], v[230:231] op_sel_hi:[1,0,0]
    v_pk_fma_f32 v[116:117], v[116:117], v[230:231], v[230:231] op_sel_hi:[1,0,0]
    v_pk_fma_f32 v[118:119], v[118:119], v[230:231], v[230:231] op_sel_hi:[1,0,0]
    s_waitcnt vmcnt(3)
    v_mov_b32 v10, 0
    v_mov_b32 v11, 1
    s_mov_b64 exec, 1
    buffer_store_dword v11, v10, s[4:7], s62 offen sc1
    s_mov_b64 exec, -1
    s_add_u32 s62, s62, 16384
    v_rcp_f32 v112, v112
    v_rcp_f32 v113, v113
    v_rcp_f32 v114, v114
    v_rcp_f32 v115, v115
    v_rcp_f32 v116, v116
    v_rcp_f32 v117, v117
    v_rcp_f32 v118, v118
    v_rcp_f32 v119, v119
    v_pk_mul_f32 v[84:85], v[84:85], v[112:113]
    v_pk_mul_f32 v[86:87], v[86:87], v[114:115]
    v_pk_mul_f32 v[100:101], v[100:101], v[116:117]
    v_pk_mul_f32 v[102:103], v[102:103], v[118:119]
    v_cvt_pk_bf16_f32 v132, v84, v85
    v_cvt_pk_bf16_f32 v133, v86, v87
    v_cvt_pk_bf16_f32 v134, v100, v101
    v_cvt_pk_bf16_f32 v135, v102, v103
    buffer_store_dwordx4 v[132:135], v3, s[4:7], s61 offen sc1
    s_barrier
    s_waitcnt vmcnt(2)
    v_mov_b32 v10, 0
    v_mov_b32 v11, 1
    s_mov_b64 exec, 1
    buffer_store_dword v11, v10, s[4:7], s62 offen sc1
    s_mov_b64 exec, -1
    s_add_u32 s62, s62, 16384
    s_waitcnt vmcnt(0)
    v_mov_b32 v10, 0
    v_mov_b32 v11, 1
    s_mov_b64 exec, 1
    buffer_store_dword v11, v10, s[4:7], s62 offen sc1
    s_mov_b64 exec, -1
    s_add_u32 s62, s62, 16384
    s_lshl_b32 s62, s25, 9
    s_add_u32 s62, s62, 360448
    s_mul_i32 s63, s34, 49152
    s_add_u32 s46, s63, 15728640
    s_mov_b32 s69, s46
    v_lshrrev_b32 v11, 3, v2
    v_lshlrev_b32 v11, 7, v11
    v_and_b32 v12, 7, v2
    v_lshl_add_u32 v11, v12, 2, v11
    s_mov_b32 s12, s54
    s_mov_b32 s13, s55
    s_mov_b32 s14, 2621440
    s_mov_b32 s15, 0x00020000
    s_barrier
    buffer_load_dwordx4 v[92:95], v3, s[4:7], s46 offen sc1
    buffer_load_dwordx4 v[96:99], v3, s[4:7], s46 offen offset:1024 sc1
    buffer_load_dwordx4 v[100:103], v3, s[4:7], s46 offen offset:2048 sc1
    buffer_load_dwordx4 v[104:107], v3, s[4:7], s46 offen offset:3072 sc1
    s_add_u32 s46, s46, 4096
    buffer_load_dwordx4 v[108:111], v3, s[4:7], s46 offen sc1
    buffer_load_dwordx4 v[112:115], v3, s[4:7], s46 offen offset:1024 sc1
    s_barrier
    ds_read_b128 v[40:43], v8 offset:40960
    ds_read_b128 v[44:47], v8 offset:41984
    ds_read_b128 v[48:51], v8 offset:43008
    ds_read_b128 v[52:55], v8 offset:44032
    ds_read_b128 v[56:59], v8 offset:45056
    ds_read_b128 v[60:63], v8 offset:46080
    ds_read_b128 v[64:67], v8 offset:47104
    ds_read_b128 v[68:71], v8 offset:48128
    ds_read_b128 v[72:75], v8 offset:49152
    s_waitcnt vmcnt(5)
    s_waitcnt lgkmcnt(7)
    v_mfma_f32_16x16x32_bf16 v[16:19], v[40:43], v[92:95], 0
    ds_read_b128 v[76:79], v8 offset:50176
    v_mfma_f32_16x16x32_bf16 v[20:23], v[44:47], v[92:95], 0
    ds_read_b128 v[40:43], v8 offset:51200
    buffer_load_dwordx4 v[116:119], v3, s[4:7], s46 offen offset:2048 sc1
    s_waitcnt lgkmcnt(7)
    v_mfma_f32_16x16x32_bf16 v[24:27], v[48:51], v[92:95], 0
    ds_read_b128 v[44:47], v8 offset:52224
    v_mfma_f32_16x16x32_bf16 v[28:31], v[52:55], v[92:95], 0
    ds_read_b128 v[48:51], v8 offset:53248
    s_waitcnt lgkmcnt(7)
    v_mfma_f32_16x16x32_bf16 v[32:35], v[56:59], v[92:95], 0
    ds_read_b128 v[52:55], v8 offset:54272
    buffer_load_dwordx4 v[120:123], v3, s[4:7], s46 offen offset:3072 sc1
    s_waitcnt vmcnt(6)
    v_mfma_f32_16x16x32_bf16 v[16:19], v[60:63], v[96:99], v[16:19]
    ds_read_b128 v[56:59], v8 offset:55296
    s_waitcnt lgkmcnt(7)
    v_mfma_f32_16x16x32_bf16 v[20:23], v[64:67], v[96:99], v[20:23]
    ds_read_b128 v[60:63], v8 offset:56320
    s_add_u32 s46, s46, 4096
    buffer_load_dwordx4 v[124:127], v3, s[4:7], s46 offen sc1
    v_mfma_f32_16x16x32_bf16 v[24:27], v[68:71], v[96:99], v[24:27]
    ds_read_b128 v[64:67], v8 offset:57344
    s_waitcnt lgkmcnt(7)
    v_mfma_f32_16x16x32_bf16 v[28:31], v[72:75], v[96:99], v[28:31]
    ds_read_b128 v[68:71], v8 offset:58368
    v_mfma_f32_16x16x32_bf16 v[32:35], v[76:79], v[96:99], v[32:35]
    ds_read_b128 v[72:75], v8 offset:59392
    buffer_load_dwordx4 v[92:95], v3, s[4:7], s46 offen offset:1024 sc1
    s_waitcnt vmcnt(7)
    s_waitcnt lgkmcnt(7)
    v_mfma_f32_16x16x32_bf16 v[16:19], v[40:43], v[100:103], v[16:19]
    ds_read_b128 v[76:79], v8 offset:60416
    v_mfma_f32_16x16x32_bf16 v[20:23], v[44:47], v[100:103], v[20:23]
    s_barrier
    ds_read_b128 v[40:43], v9 offset:0
    buffer_load_dwordx4 v[96:99], v3, s[4:7], s46 offen offset:2048 sc1
    s_waitcnt lgkmcnt(7)
    v_mfma_f32_16x16x32_bf16 v[24:27], v[48:51], v[100:103], v[24:27]
    ds_read_b128 v[44:47], v9 offset:1024
    v_mfma_f32_16x16x32_bf16 v[28:31], v[52:55], v[100:103], v[28:31]
    ds_read_b128 v[48:51], v9 offset:2048
    s_waitcnt lgkmcnt(7)
    v_mfma_f32_16x16x32_bf16 v[32:35], v[56:59], v[100:103], v[32:35]
    ds_read_b128 v[52:55], v9 offset:3072
    buffer_load_dwordx4 v[100:103], v3, s[4:7], s46 offen offset:3072 sc1
    s_waitcnt vmcnt(8)
    v_mfma_f32_16x16x32_bf16 v[16:19], v[60:63], v[104:107], v[16:19]
    ds_read_b128 v[56:59], v9 offset:4096
    s_waitcnt lgkmcnt(7)
    v_mfma_f32_16x16x32_bf16 v[20:23], v[64:67], v[104:107], v[20:23]
    ds_read_b128 v[60:63], v9 offset:5120
    v_mfma_f32_16x16x32_bf16 v[24:27], v[68:71], v[104:107], v[24:27]
    ds_read_b128 v[64:67], v9 offset:6144
    s_waitcnt lgkmcnt(7)
    v_mfma_f32_16x16x32_bf16 v[28:31], v[72:75], v[104:107], v[28:31]
    ds_read_b128 v[68:71], v9 offset:7168
    v_mfma_f32_16x16x32_bf16 v[32:35], v[76:79], v[104:107], v[32:35]
    ds_read_b128 v[72:75], v9 offset:8192
    s_add_u32 s46, s46, 4096
    buffer_load_dwordx4 v[104:107], v3, s[4:7], s46 offen sc1
    s_waitcnt vmcnt(8)
    s_waitcnt lgkmcnt(7)
    v_mfma_f32_16x16x32_bf16 v[16:19], v[40:43], v[108:111], v[16:19]
    ds_read_b128 v[76:79], v9 offset:9216
    v_mfma_f32_16x16x32_bf16 v[20:23], v[44:47], v[108:111], v[20:23]
    ds_read_b128 v[40:43], v9 offset:10240
    s_waitcnt lgkmcnt(7)
    v_mfma_f32_16x16x32_bf16 v[24:27], v[48:51], v[108:111], v[24:27]
    ds_read_b128 v[44:47], v9 offset:11264
    v_mfma_f32_16x16x32_bf16 v[28:31], v[52:55], v[108:111], v[28:31]
    ds_read_b128 v[48:51], v9 offset:12288
    s_waitcnt lgkmcnt(7)
    v_mfma_f32_16x16x32_bf16 v[32:35], v[56:59], v[108:111], v[32:35]
    ds_read_b128 v[52:55], v9 offset:13312
    buffer_load_dwordx4 v[108:111], v3, s[4:7], s46 offen offset:1024 sc1
    s_waitcnt vmcnt(8)
    v_mfma_f32_16x16x32_bf16 v[16:19], v[60:63], v[112:115], v[16:19]
    ds_read_b128 v[56:59], v9 offset:14336
    s_waitcnt lgkmcnt(7)
    v_mfma_f32_16x16x32_bf16 v[20:23], v[64:67], v[112:115], v[20:23]
    ds_read_b128 v[60:63], v9 offset:15360
    v_mfma_f32_16x16x32_bf16 v[24:27], v[68:71], v[112:115], v[24:27]
    ds_read_b128 v[64:67], v9 offset:16384
    s_waitcnt lgkmcnt(7)
    v_mfma_f32_16x16x32_bf16 v[28:31], v[72:75], v[112:115], v[28:31]
    ds_read_b128 v[68:71], v9 offset:17408
    v_mfma_f32_16x16x32_bf16 v[32:35], v[76:79], v[112:115], v[32:35]
    ds_read_b128 v[72:75], v9 offset:18432
    buffer_load_dwordx4 v[112:115], v3, s[4:7], s46 offen offset:2048 sc1
    s_waitcnt vmcnt(8)
    s_waitcnt lgkmcnt(7)
    v_mfma_f32_16x16x32_bf16 v[16:19], v[40:43], v[116:119], v[16:19]
    ds_read_b128 v[76:79], v9 offset:19456
    v_mfma_f32_16x16x32_bf16 v[20:23], v[44:47], v[116:119], v[20:23]
    s_barrier
    ds_read_b128 v[40:43], v9 offset:20480
    s_waitcnt lgkmcnt(7)
    v_mfma_f32_16x16x32_bf16 v[24:27], v[48:51], v[116:119], v[24:27]
    ds_read_b128 v[44:47], v9 offset:21504
    v_mfma_f32_16x16x32_bf16 v[28:31], v[52:55], v[116:119], v[28:31]
    ds_read_b128 v[48:51], v9 offset:22528
    s_waitcnt lgkmcnt(7)
    v_mfma_f32_16x16x32_bf16 v[32:35], v[56:59], v[116:119], v[32:35]
    ds_read_b128 v[52:55], v9 offset:23552
    buffer_load_dwordx4 v[116:119], v3, s[4:7], s46 offen offset:3072 sc1
    s_waitcnt vmcnt(8)
    v_mfma_f32_16x16x32_bf16 v[16:19], v[60:63], v[120:123], v[16:19]
    ds_read_b128 v[56:59], v9 offset:24576
    s_waitcnt lgkmcnt(7)
    v_mfma_f32_16x16x32_bf16 v[20:23], v[64:67], v[120:123], v[20:23]
    ds_read_b128 v[60:63], v9 offset:25600
    v_mfma_f32_16x16x32_bf16 v[24:27], v[68:71], v[120:123], v[24:27]
    ds_read_b128 v[64:67], v9 offset:26624
    s_waitcnt lgkmcnt(7)
    v_mfma_f32_16x16x32_bf16 v[28:31], v[72:75], v[120:123], v[28:31]
    ds_read_b128 v[68:71], v9 offset:27648
    v_mfma_f32_16x16x32_bf16 v[32:35], v[76:79], v[120:123], v[32:35]
    ds_read_b128 v[72:75], v9 offset:28672
    s_add_u32 s46, s46, 4096
    buffer_load_dwordx4 v[120:123], v3, s[4:7], s46 offen sc1
    s_waitcnt vmcnt(8)
    s_waitcnt lgkmcnt(7)
    v_mfma_f32_16x16x32_bf16 v[16:19], v[40:43], v[124:127], v[16:19]
    ds_read_b128 v[76:79], v9 offset:29696
    v_mfma_f32_16x16x32_bf16 v[20:23], v[44:47], v[124:127], v[20:23]
    ds_read_b128 v[40:43], v9 offset:30720
    s_waitcnt lgkmcnt(7)
    v_mfma_f32_16x16x32_bf16 v[24:27], v[48:51], v[124:127], v[24:27]
    ds_read_b128 v[44:47], v9 offset:31744
    v_mfma_f32_16x16x32_bf16 v[28:31], v[52:55], v[124:127], v[28:31]
    ds_read_b128 v[48:51], v9 offset:32768
    s_waitcnt lgkmcnt(7)
    v_mfma_f32_16x16x32_bf16 v[32:35], v[56:59], v[124:127], v[32:35]
    ds_read_b128 v[52:55], v9 offset:33792
    buffer_load_dwordx4 v[124:127], v3, s[4:7], s46 offen offset:1024 sc1
    s_waitcnt vmcnt(8)
    v_mfma_f32_16x16x32_bf16 v[16:19], v[60:63], v[92:95], v[16:19]
    ds_read_b128 v[56:59], v9 offset:34816
    s_waitcnt lgkmcnt(7)
    v_mfma_f32_16x16x32_bf16 v[20:23], v[64:67], v[92:95], v[20:23]
    ds_read_b128 v[60:63], v9 offset:35840
    v_mfma_f32_16x16x32_bf16 v[24:27], v[68:71], v[92:95], v[24:27]
    ds_read_b128 v[64:67], v9 offset:36864
    s_waitcnt lgkmcnt(7)
    v_mfma_f32_16x16x32_bf16 v[28:31], v[72:75], v[92:95], v[28:31]
    ds_read_b128 v[68:71], v9 offset:37888
    v_mfma_f32_16x16x32_bf16 v[32:35], v[76:79], v[92:95], v[32:35]
    ds_read_b128 v[72:75], v9 offset:38912
    buffer_load_dwordx4 v[92:95], v3, s[4:7], s46 offen offset:2048 sc1
    s_waitcnt vmcnt(8)
    s_waitcnt lgkmcnt(7)
    v_mfma_f32_16x16x32_bf16 v[16:19], v[40:43], v[96:99], v[16:19]
    ds_read_b128 v[76:79], v9 offset:39936
    v_mfma_f32_16x16x32_bf16 v[20:23], v[44:47], v[96:99], v[20:23]
    s_barrier
    ds_read_b128 v[40:43], v7 offset:0
    s_waitcnt lgkmcnt(7)
    v_mfma_f32_16x16x32_bf16 v[24:27], v[48:51], v[96:99], v[24:27]
    ds_read_b128 v[44:47], v7 offset:1024
    v_mfma_f32_16x16x32_bf16 v[28:31], v[52:55], v[96:99], v[28:31]
    ds_read_b128 v[48:51], v7 offset:2048
    s_waitcnt lgkmcnt(7)
    v_mfma_f32_16x16x32_bf16 v[32:35], v[56:59], v[96:99], v[32:35]
    ds_read_b128 v[52:55], v7 offset:3072
    buffer_load_dwordx4 v[96:99], v3, s[4:7], s46 offen offset:3072 sc1
    s_waitcnt vmcnt(8)
    v_mfma_f32_16x16x32_bf16 v[16:19], v[60:63], v[100:103], v[16:19]
    ds_read_b128 v[56:59], v7 offset:4096
    s_waitcnt lgkmcnt(7)
    v_mfma_f32_16x16x32_bf16 v[20:23], v[64:67], v[100:103], v[20:23]
    ds_read_b128 v[60:63], v7 offset:5120
    v_mfma_f32_16x16x32_bf16 v[24:27], v[68:71], v[100:103], v[24:27]
    ds_read_b128 v[64:67], v7 offset:6144
    s_waitcnt lgkmcnt(7)
    v_mfma_f32_16x16x32_bf16 v[28:31], v[72:75], v[100:103], v[28:31]
    ds_read_b128 v[68:71], v7 offset:7168
    v_mfma_f32_16x16x32_bf16 v[32:35], v[76:79], v[100:103], v[32:35]
    ds_read_b128 v[72:75], v7 offset:8192
    s_add_u32 s46, s46, 4096
    buffer_load_dwordx4 v[100:103], v3, s[4:7], s46 offen sc1
    s_waitcnt vmcnt(8)
    s_waitcnt lgkmcnt(7)
    v_mfma_f32_16x16x32_bf16 v[16:19], v[40:43], v[104:107], v[16:19]
    ds_read_b128 v[76:79], v7 offset:9216
    v_mfma_f32_16x16x32_bf16 v[20:23], v[44:47], v[104:107], v[20:23]
    ds_read_b128 v[40:43], v7 offset:10240
    s_waitcnt lgkmcnt(7)
    v_mfma_f32_16x16x32_bf16 v[24:27], v[48:51], v[104:107], v[24:27]
    ds_read_b128 v[44:47], v7 offset:11264
    v_mfma_f32_16x16x32_bf16 v[28:31], v[52:55], v[104:107], v[28:31]
    ds_read_b128 v[48:51], v7 offset:12288
    s_waitcnt lgkmcnt(7)
    v_mfma_f32_16x16x32_bf16 v[32:35], v[56:59], v[104:107], v[32:35]
    ds_read_b128 v[52:55], v7 offset:13312
    buffer_load_dwordx4 v[104:107], v3, s[4:7], s46 offen offset:1024 sc1
    s_waitcnt vmcnt(8)
    v_mfma_f32_16x16x32_bf16 v[16:19], v[60:63], v[108:111], v[16:19]
    ds_read_b128 v[56:59], v7 offset:14336
    s_waitcnt lgkmcnt(7)
    v_mfma_f32_16x16x32_bf16 v[20:23], v[64:67], v[108:111], v[20:23]
    ds_read_b128 v[60:63], v7 offset:15360
    v_mfma_f32_16x16x32_bf16 v[24:27], v[68:71], v[108:111], v[24:27]
    ds_read_b128 v[64:67], v7 offset:16384
    s_waitcnt lgkmcnt(7)
    v_mfma_f32_16x16x32_bf16 v[28:31], v[72:75], v[108:111], v[28:31]
    ds_read_b128 v[68:71], v7 offset:17408
    v_mfma_f32_16x16x32_bf16 v[32:35], v[76:79], v[108:111], v[32:35]
    ds_read_b128 v[72:75], v7 offset:18432
    buffer_load_dwordx4 v[108:111], v3, s[4:7], s46 offen offset:2048 sc1
    s_waitcnt vmcnt(8)
    s_waitcnt lgkmcnt(7)
    v_mfma_f32_16x16x32_bf16 v[16:19], v[40:43], v[112:115], v[16:19]
    ds_read_b128 v[76:79], v7 offset:19456
    v_mfma_f32_16x16x32_bf16 v[20:23], v[44:47], v[112:115], v[20:23]
    s_barrier
    ds_read_b128 v[40:43], v7 offset:20480
    s_waitcnt lgkmcnt(7)
    v_mfma_f32_16x16x32_bf16 v[24:27], v[48:51], v[112:115], v[24:27]
    ds_read_b128 v[44:47], v7 offset:21504
    v_mfma_f32_16x16x32_bf16 v[28:31], v[52:55], v[112:115], v[28:31]
    ds_read_b128 v[48:51], v7 offset:22528
    s_waitcnt lgkmcnt(7)
    v_mfma_f32_16x16x32_bf16 v[32:35], v[56:59], v[112:115], v[32:35]
    ds_read_b128 v[52:55], v7 offset:23552
    buffer_load_dwordx4 v[112:115], v3, s[4:7], s46 offen offset:3072 sc1
    s_waitcnt vmcnt(8)
    v_mfma_f32_16x16x32_bf16 v[16:19], v[60:63], v[116:119], v[16:19]
    ds_read_b128 v[56:59], v7 offset:24576
    s_waitcnt lgkmcnt(7)
    v_mfma_f32_16x16x32_bf16 v[20:23], v[64:67], v[116:119], v[20:23]
    ds_read_b128 v[60:63], v7 offset:25600
    v_mfma_f32_16x16x32_bf16 v[24:27], v[68:71], v[116:119], v[24:27]
    ds_read_b128 v[64:67], v7 offset:26624
    s_waitcnt lgkmcnt(7)
    v_mfma_f32_16x16x32_bf16 v[28:31], v[72:75], v[116:119], v[28:31]
    ds_read_b128 v[68:71], v7 offset:27648
    v_mfma_f32_16x16x32_bf16 v[32:35], v[76:79], v[116:119], v[32:35]
    ds_read_b128 v[72:75], v7 offset:28672
    s_add_u32 s46, s46, 4096
    buffer_load_dwordx4 v[116:119], v3, s[4:7], s46 offen sc1
    s_waitcnt vmcnt(8)
    s_waitcnt lgkmcnt(7)
    v_mfma_f32_16x16x32_bf16 v[16:19], v[40:43], v[120:123], v[16:19]
    ds_read_b128 v[76:79], v7 offset:29696
    v_mfma_f32_16x16x32_bf16 v[20:23], v[44:47], v[120:123], v[20:23]
    ds_read_b128 v[40:43], v7 offset:30720
    s_waitcnt lgkmcnt(7)
    v_mfma_f32_16x16x32_bf16 v[24:27], v[48:51], v[120:123], v[24:27]
    ds_read_b128 v[44:47], v7 offset:31744
    v_mfma_f32_16x16x32_bf16 v[28:31], v[52:55], v[120:123], v[28:31]
    ds_read_b128 v[48:51], v7 offset:32768
    s_waitcnt lgkmcnt(7)
    v_mfma_f32_16x16x32_bf16 v[32:35], v[56:59], v[120:123], v[32:35]
    ds_read_b128 v[52:55], v7 offset:33792
    buffer_load_dwordx4 v[120:123], v3, s[4:7], s46 offen offset:1024 sc1
    s_waitcnt vmcnt(8)
    v_mfma_f32_16x16x32_bf16 v[16:19], v[60:63], v[124:127], v[16:19]
    ds_read_b128 v[56:59], v7 offset:34816
    s_waitcnt lgkmcnt(7)
    v_mfma_f32_16x16x32_bf16 v[20:23], v[64:67], v[124:127], v[20:23]
    ds_read_b128 v[60:63], v7 offset:35840
    v_mfma_f32_16x16x32_bf16 v[24:27], v[68:71], v[124:127], v[24:27]
    ds_read_b128 v[64:67], v7 offset:36864
    s_waitcnt lgkmcnt(7)
    v_mfma_f32_16x16x32_bf16 v[28:31], v[72:75], v[124:127], v[28:31]
    ds_read_b128 v[68:71], v7 offset:37888
    v_mfma_f32_16x16x32_bf16 v[32:35], v[76:79], v[124:127], v[32:35]
    ds_read_b128 v[72:75], v7 offset:38912
    buffer_load_dwordx4 v[124:127], v3, s[4:7], s46 offen offset:2048 sc1
    s_waitcnt vmcnt(8)
    s_waitcnt lgkmcnt(7)
    v_mfma_f32_16x16x32_bf16 v[16:19], v[40:43], v[92:95], v[16:19]
    ds_read_b128 v[76:79], v7 offset:39936
    v_mfma_f32_16x16x32_bf16 v[20:23], v[44:47], v[92:95], v[20:23]
    s_barrier
    ds_read_b128 v[40:43], v7 offset:40960
    s_waitcnt lgkmcnt(7)
    v_mfma_f32_16x16x32_bf16 v[24:27], v[48:51], v[92:95], v[24:27]
    ds_read_b128 v[44:47], v7 offset:41984
    v_mfma_f32_16x16x32_bf16 v[28:31], v[52:55], v[92:95], v[28:31]
    ds_read_b128 v[48:51], v7 offset:43008
    s_waitcnt lgkmcnt(7)
    v_mfma_f32_16x16x32_bf16 v[32:35], v[56:59], v[92:95], v[32:35]
    ds_read_b128 v[52:55], v7 offset:44032
    buffer_load_dwordx4 v[92:95], v3, s[4:7], s46 offen offset:3072 sc1
    s_waitcnt vmcnt(8)
    v_mfma_f32_16x16x32_bf16 v[16:19], v[60:63], v[96:99], v[16:19]
    ds_read_b128 v[56:59], v7 offset:45056
    s_waitcnt lgkmcnt(7)
    v_mfma_f32_16x16x32_bf16 v[20:23], v[64:67], v[96:99], v[20:23]
    ds_read_b128 v[60:63], v7 offset:46080
    v_mfma_f32_16x16x32_bf16 v[24:27], v[68:71], v[96:99], v[24:27]
    ds_read_b128 v[64:67], v7 offset:47104
    s_waitcnt lgkmcnt(7)
    v_mfma_f32_16x16x32_bf16 v[28:31], v[72:75], v[96:99], v[28:31]
    ds_read_b128 v[68:71], v7 offset:48128
    v_mfma_f32_16x16x32_bf16 v[32:35], v[76:79], v[96:99], v[32:35]
    ds_read_b128 v[72:75], v7 offset:49152
    s_add_u32 s46, s46, 4096
    buffer_load_dwordx4 v[96:99], v3, s[4:7], s46 offen sc1
    s_waitcnt vmcnt(8)
    s_waitcnt lgkmcnt(7)
    v_mfma_f32_16x16x32_bf16 v[16:19], v[40:43], v[100:103], v[16:19]
    ds_read_b128 v[76:79], v7 offset:50176
    v_mfma_f32_16x16x32_bf16 v[20:23], v[44:47], v[100:103], v[20:23]
    ds_read_b128 v[40:43], v7 offset:51200
    s_waitcnt lgkmcnt(7)
    v_mfma_f32_16x16x32_bf16 v[24:27], v[48:51], v[100:103], v[24:27]
    ds_read_b128 v[44:47], v7 offset:52224
    v_mfma_f32_16x16x32_bf16 v[28:31], v[52:55], v[100:103], v[28:31]
    ds_read_b128 v[48:51], v7 offset:53248
    s_waitcnt lgkmcnt(7)
    v_mfma_f32_16x16x32_bf16 v[32:35], v[56:59], v[100:103], v[32:35]
    ds_read_b128 v[52:55], v7 offset:54272
    buffer_load_dwordx4 v[100:103], v3, s[4:7], s46 offen offset:1024 sc1
    s_waitcnt vmcnt(8)
    v_mfma_f32_16x16x32_bf16 v[16:19], v[60:63], v[104:107], v[16:19]
    ds_read_b128 v[56:59], v7 offset:55296
    s_waitcnt lgkmcnt(7)
    v_mfma_f32_16x16x32_bf16 v[20:23], v[64:67], v[104:107], v[20:23]
    ds_read_b128 v[60:63], v7 offset:56320
    v_mfma_f32_16x16x32_bf16 v[24:27], v[68:71], v[104:107], v[24:27]
    ds_read_b128 v[64:67], v7 offset:57344
    s_waitcnt lgkmcnt(7)
    v_mfma_f32_16x16x32_bf16 v[28:31], v[72:75], v[104:107], v[28:31]
    ds_read_b128 v[68:71], v7 offset:58368
    v_mfma_f32_16x16x32_bf16 v[32:35], v[76:79], v[104:107], v[32:35]
    ds_read_b128 v[72:75], v7 offset:59392
    buffer_load_dwordx4 v[104:107], v3, s[4:7], s46 offen offset:2048 sc1
    s_waitcnt vmcnt(8)
    s_waitcnt lgkmcnt(7)
    v_mfma_f32_16x16x32_bf16 v[16:19], v[40:43], v[108:111], v[16:19]
    ds_read_b128 v[76:79], v7 offset:60416
    v_mfma_f32_16x16x32_bf16 v[20:23], v[44:47], v[108:111], v[20:23]
    s_barrier
    ds_read_b128 v[40:43], v8 offset:0
    s_waitcnt lgkmcnt(7)
    v_mfma_f32_16x16x32_bf16 v[24:27], v[48:51], v[108:111], v[24:27]
    ds_read_b128 v[44:47], v8 offset:1024
    v_mfma_f32_16x16x32_bf16 v[28:31], v[52:55], v[108:111], v[28:31]
    ds_read_b128 v[48:51], v8 offset:2048
    s_waitcnt lgkmcnt(7)
    v_mfma_f32_16x16x32_bf16 v[32:35], v[56:59], v[108:111], v[32:35]
    ds_read_b128 v[52:55], v8 offset:3072
    buffer_load_dwordx4 v[108:111], v3, s[4:7], s46 offen offset:3072 sc1
    s_waitcnt vmcnt(8)
    v_mfma_f32_16x16x32_bf16 v[16:19], v[60:63], v[112:115], v[16:19]
    ds_read_b128 v[56:59], v8 offset:4096
    s_waitcnt lgkmcnt(7)
    v_mfma_f32_16x16x32_bf16 v[20:23], v[64:67], v[112:115], v[20:23]
    ds_read_b128 v[60:63], v8 offset:5120
    v_mfma_f32_16x16x32_bf16 v[24:27], v[68:71], v[112:115], v[24:27]
    ds_read_b128 v[64:67], v8 offset:6144
    s_waitcnt lgkmcnt(7)
    v_mfma_f32_16x16x32_bf16 v[28:31], v[72:75], v[112:115], v[28:31]
    ds_read_b128 v[68:71], v8 offset:7168
    v_mfma_f32_16x16x32_bf16 v[32:35], v[76:79], v[112:115], v[32:35]
    ds_read_b128 v[72:75], v8 offset:8192
    s_add_u32 s46, s46, 4096
    buffer_load_dwordx4 v[112:115], v3, s[4:7], s46 offen sc1
    s_waitcnt vmcnt(8)
    s_waitcnt lgkmcnt(7)
    v_mfma_f32_16x16x32_bf16 v[16:19], v[40:43], v[116:119], v[16:19]
    ds_read_b128 v[76:79], v8 offset:9216
    v_mfma_f32_16x16x32_bf16 v[20:23], v[44:47], v[116:119], v[20:23]
    ds_read_b128 v[40:43], v8 offset:10240
    s_waitcnt lgkmcnt(7)
    v_mfma_f32_16x16x32_bf16 v[24:27], v[48:51], v[116:119], v[24:27]
    ds_read_b128 v[44:47], v8 offset:11264
    v_mfma_f32_16x16x32_bf16 v[28:31], v[52:55], v[116:119], v[28:31]
    ds_read_b128 v[48:51], v8 offset:12288
    s_waitcnt lgkmcnt(7)
    v_mfma_f32_16x16x32_bf16 v[32:35], v[56:59], v[116:119], v[32:35]
    ds_read_b128 v[52:55], v8 offset:13312
    buffer_load_dwordx4 v[116:119], v3, s[4:7], s46 offen offset:1024 sc1
    s_waitcnt vmcnt(8)
    v_mfma_f32_16x16x32_bf16 v[16:19], v[60:63], v[120:123], v[16:19]
    ds_read_b128 v[56:59], v8 offset:14336
    s_waitcnt lgkmcnt(7)
    v_mfma_f32_16x16x32_bf16 v[20:23], v[64:67], v[120:123], v[20:23]
    ds_read_b128 v[60:63], v8 offset:15360
    v_mfma_f32_16x16x32_bf16 v[24:27], v[68:71], v[120:123], v[24:27]
    ds_read_b128 v[64:67], v8 offset:16384
    s_waitcnt lgkmcnt(7)
    v_mfma_f32_16x16x32_bf16 v[28:31], v[72:75], v[120:123], v[28:31]
    ds_read_b128 v[68:71], v8 offset:17408
    v_mfma_f32_16x16x32_bf16 v[32:35], v[76:79], v[120:123], v[32:35]
    ds_read_b128 v[72:75], v8 offset:18432
    buffer_load_dwordx4 v[120:123], v3, s[4:7], s46 offen offset:2048 sc1
    s_waitcnt vmcnt(8)
    s_waitcnt lgkmcnt(7)
    v_mfma_f32_16x16x32_bf16 v[16:19], v[40:43], v[124:127], v[16:19]
    ds_read_b128 v[76:79], v8 offset:19456
    v_mfma_f32_16x16x32_bf16 v[20:23], v[44:47], v[124:127], v[20:23]
    s_barrier
    ds_read_b128 v[40:43], v8 offset:20480
    s_waitcnt lgkmcnt(7)
    v_mfma_f32_16x16x32_bf16 v[24:27], v[48:51], v[124:127], v[24:27]
    ds_read_b128 v[44:47], v8 offset:21504
    v_mfma_f32_16x16x32_bf16 v[28:31], v[52:55], v[124:127], v[28:31]
    ds_read_b128 v[48:51], v8 offset:22528
    s_waitcnt lgkmcnt(7)
    v_mfma_f32_16x16x32_bf16 v[32:35], v[56:59], v[124:127], v[32:35]
    ds_read_b128 v[52:55], v8 offset:23552
    buffer_load_dwordx4 v[124:127], v3, s[4:7], s46 offen offset:3072 sc1
    s_waitcnt vmcnt(8)
    v_mfma_f32_16x16x32_bf16 v[16:19], v[60:63], v[92:95], v[16:19]
    ds_read_b128 v[56:59], v8 offset:24576
    s_waitcnt lgkmcnt(7)
    v_mfma_f32_16x16x32_bf16 v[20:23], v[64:67], v[92:95], v[20:23]
    ds_read_b128 v[60:63], v8 offset:25600
    v_mfma_f32_16x16x32_bf16 v[24:27], v[68:71], v[92:95], v[24:27]
    ds_read_b128 v[64:67], v8 offset:26624
    s_waitcnt lgkmcnt(7)
    v_mfma_f32_16x16x32_bf16 v[28:31], v[72:75], v[92:95], v[28:31]
    ds_read_b128 v[68:71], v8 offset:27648
    v_mfma_f32_16x16x32_bf16 v[32:35], v[76:79], v[92:95], v[32:35]
    ds_read_b128 v[72:75], v8 offset:28672
    s_add_u32 s46, s46, 4096
    buffer_load_dwordx4 v[92:95], v3, s[4:7], s46 offen sc1
    s_waitcnt vmcnt(8)
    s_waitcnt lgkmcnt(7)
    v_mfma_f32_16x16x32_bf16 v[16:19], v[40:43], v[96:99], v[16:19]
    ds_read_b128 v[76:79], v8 offset:29696
    v_mfma_f32_16x16x32_bf16 v[20:23], v[44:47], v[96:99], v[20:23]
    ds_read_b128 v[40:43], v8 offset:30720
    s_waitcnt lgkmcnt(7)
    v_mfma_f32_16x16x32_bf16 v[24:27], v[48:51], v[96:99], v[24:27]
    ds_read_b128 v[44:47], v8 offset:31744
    v_mfma_f32_16x16x32_bf16 v[28:31], v[52:55], v[96:99], v[28:31]
    ds_read_b128 v[48:51], v8 offset:32768
    s_waitcnt lgkmcnt(7)
    v_mfma_f32_16x16x32_bf16 v[32:35], v[56:59], v[96:99], v[32:35]
    ds_read_b128 v[52:55], v8 offset:33792
    buffer_load_dwordx4 v[96:99], v3, s[4:7], s46 offen offset:1024 sc1
    s_waitcnt vmcnt(8)
    v_mfma_f32_16x16x32_bf16 v[16:19], v[60:63], v[100:103], v[16:19]
    ds_read_b128 v[56:59], v8 offset:34816
    s_waitcnt lgkmcnt(7)
    v_mfma_f32_16x16x32_bf16 v[20:23], v[64:67], v[100:103], v[20:23]
    ds_read_b128 v[60:63], v8 offset:35840
    v_mfma_f32_16x16x32_bf16 v[24:27], v[68:71], v[100:103], v[24:27]
    ds_read_b128 v[64:67], v8 offset:36864
    s_waitcnt lgkmcnt(7)
    v_mfma_f32_16x16x32_bf16 v[28:31], v[72:75], v[100:103], v[28:31]
    ds_read_b128 v[68:71], v8 offset:37888
    v_mfma_f32_16x16x32_bf16 v[32:35], v[76:79], v[100:103], v[32:35]
    ds_read_b128 v[72:75], v8 offset:38912
    buffer_load_dwordx4 v[100:103], v3, s[4:7], s46 offen offset:2048 sc1
    s_waitcnt vmcnt(8)
    s_waitcnt lgkmcnt(7)
    v_mfma_f32_16x16x32_bf16 v[16:19], v[40:43], v[104:107], v[16:19]
    ds_read_b128 v[76:79], v8 offset:39936
    v_mfma_f32_16x16x32_bf16 v[20:23], v[44:47], v[104:107], v[20:23]
    s_barrier
    ds_read_b128 v[40:43], v8 offset:40960
    s_waitcnt lgkmcnt(7)
    v_mfma_f32_16x16x32_bf16 v[24:27], v[48:51], v[104:107], v[24:27]
    ds_read_b128 v[44:47], v8 offset:41984
    v_mfma_f32_16x16x32_bf16 v[28:31], v[52:55], v[104:107], v[28:31]
    ds_read_b128 v[48:51], v8 offset:43008
    s_waitcnt lgkmcnt(7)
    v_mfma_f32_16x16x32_bf16 v[32:35], v[56:59], v[104:107], v[32:35]
    ds_read_b128 v[52:55], v8 offset:44032
    buffer_load_dwordx4 v[104:107], v3, s[4:7], s46 offen offset:3072 sc1
    s_waitcnt vmcnt(8)
    v_mfma_f32_16x16x32_bf16 v[16:19], v[60:63], v[108:111], v[16:19]
    ds_read_b128 v[56:59], v8 offset:45056
    s_waitcnt lgkmcnt(7)
    v_mfma_f32_16x16x32_bf16 v[20:23], v[64:67], v[108:111], v[20:23]
    ds_read_b128 v[60:63], v8 offset:46080
    v_mfma_f32_16x16x32_bf16 v[24:27], v[68:71], v[108:111], v[24:27]
    ds_read_b128 v[64:67], v8 offset:47104
    s_waitcnt lgkmcnt(7)
    v_mfma_f32_16x16x32_bf16 v[28:31], v[72:75], v[108:111], v[28:31]
    ds_read_b128 v[68:71], v8 offset:48128
    v_mfma_f32_16x16x32_bf16 v[32:35], v[76:79], v[108:111], v[32:35]
    ds_read_b128 v[72:75], v8 offset:49152
    s_add_u32 s46, s46, 4096
    buffer_load_dwordx4 v[108:111], v3, s[4:7], s46 offen sc1
    s_waitcnt vmcnt(8)
    s_waitcnt lgkmcnt(7)
    v_mfma_f32_16x16x32_bf16 v[16:19], v[40:43], v[112:115], v[16:19]
    ds_read_b128 v[76:79], v8 offset:50176
    v_mfma_f32_16x16x32_bf16 v[20:23], v[44:47], v[112:115], v[20:23]
    ds_read_b128 v[40:43], v8 offset:51200
    s_waitcnt lgkmcnt(7)
    v_mfma_f32_16x16x32_bf16 v[24:27], v[48:51], v[112:115], v[24:27]
    ds_read_b128 v[44:47], v8 offset:52224
    v_mfma_f32_16x16x32_bf16 v[28:31], v[52:55], v[112:115], v[28:31]
    ds_read_b128 v[48:51], v8 offset:53248
    s_waitcnt lgkmcnt(7)
    v_mfma_f32_16x16x32_bf16 v[32:35], v[56:59], v[112:115], v[32:35]
    ds_read_b128 v[52:55], v8 offset:54272
    buffer_load_dwordx4 v[112:115], v3, s[4:7], s46 offen offset:1024 sc1
    s_waitcnt vmcnt(8)
    v_mfma_f32_16x16x32_bf16 v[16:19], v[60:63], v[116:119], v[16:19]
    ds_read_b128 v[56:59], v8 offset:55296
    s_waitcnt lgkmcnt(7)
    v_mfma_f32_16x16x32_bf16 v[20:23], v[64:67], v[116:119], v[20:23]
    ds_read_b128 v[60:63], v8 offset:56320
    v_mfma_f32_16x16x32_bf16 v[24:27], v[68:71], v[116:119], v[24:27]
    ds_read_b128 v[64:67], v8 offset:57344
    s_waitcnt lgkmcnt(7)
    v_mfma_f32_16x16x32_bf16 v[28:31], v[72:75], v[116:119], v[28:31]
    ds_read_b128 v[68:71], v8 offset:58368
    v_mfma_f32_16x16x32_bf16 v[32:35], v[76:79], v[116:119], v[32:35]
    ds_read_b128 v[72:75], v8 offset:59392
    buffer_load_dwordx4 v[116:119], v3, s[4:7], s46 offen offset:2048 sc1
    s_waitcnt vmcnt(8)
    s_waitcnt lgkmcnt(7)
    v_mfma_f32_16x16x32_bf16 v[16:19], v[40:43], v[120:123], v[16:19]
    ds_read_b128 v[76:79], v8 offset:60416
    v_mfma_f32_16x16x32_bf16 v[20:23], v[44:47], v[120:123], v[20:23]
    s_barrier
    ds_read_b128 v[40:43], v9 offset:0
    s_waitcnt lgkmcnt(7)
    v_mfma_f32_16x16x32_bf16 v[24:27], v[48:51], v[120:123], v[24:27]
    ds_read_b128 v[44:47], v9 offset:1024
    v_mfma_f32_16x16x32_bf16 v[28:31], v[52:55], v[120:123], v[28:31]
    ds_read_b128 v[48:51], v9 offset:2048
    s_waitcnt lgkmcnt(7)
    v_mfma_f32_16x16x32_bf16 v[32:35], v[56:59], v[120:123], v[32:35]
    ds_read_b128 v[52:55], v9 offset:3072
    buffer_load_dwordx4 v[120:123], v3, s[4:7], s46 offen offset:3072 sc1
    s_waitcnt vmcnt(8)
    v_mfma_f32_16x16x32_bf16 v[16:19], v[60:63], v[124:127], v[16:19]
    ds_read_b128 v[56:59], v9 offset:4096
    s_waitcnt lgkmcnt(7)
    v_mfma_f32_16x16x32_bf16 v[20:23], v[64:67], v[124:127], v[20:23]
    ds_read_b128 v[60:63], v9 offset:5120
    v_mfma_f32_16x16x32_bf16 v[24:27], v[68:71], v[124:127], v[24:27]
    ds_read_b128 v[64:67], v9 offset:6144
    s_waitcnt lgkmcnt(7)
    v_mfma_f32_16x16x32_bf16 v[28:31], v[72:75], v[124:127], v[28:31]
    ds_read_b128 v[68:71], v9 offset:7168
    v_mfma_f32_16x16x32_bf16 v[32:35], v[76:79], v[124:127], v[32:35]
    ds_read_b128 v[72:75], v9 offset:8192
    s_add_u32 s46, s46, 4096
    buffer_load_dwordx4 v[124:127], v3, s[4:7], s46 offen sc1
    s_waitcnt vmcnt(8)
    s_waitcnt lgkmcnt(7)
    v_mfma_f32_16x16x32_bf16 v[16:19], v[40:43], v[92:95], v[16:19]
    ds_read_b128 v[76:79], v9 offset:9216
    v_mfma_f32_16x16x32_bf16 v[20:23], v[44:47], v[92:95], v[20:23]
    ds_read_b128 v[40:43], v9 offset:10240
    s_waitcnt lgkmcnt(7)
    v_mfma_f32_16x16x32_bf16 v[24:27], v[48:51], v[92:95], v[24:27]
    ds_read_b128 v[44:47], v9 offset:11264
    v_mfma_f32_16x16x32_bf16 v[28:31], v[52:55], v[92:95], v[28:31]
    ds_read_b128 v[48:51], v9 offset:12288
    s_waitcnt lgkmcnt(7)
    v_mfma_f32_16x16x32_bf16 v[32:35], v[56:59], v[92:95], v[32:35]
    ds_read_b128 v[52:55], v9 offset:13312
    buffer_load_dwordx4 v[92:95], v3, s[4:7], s46 offen offset:1024 sc1
    s_waitcnt vmcnt(8)
    v_mfma_f32_16x16x32_bf16 v[16:19], v[60:63], v[96:99], v[16:19]
    ds_read_b128 v[56:59], v9 offset:14336
    s_waitcnt lgkmcnt(7)
    v_mfma_f32_16x16x32_bf16 v[20:23], v[64:67], v[96:99], v[20:23]
    ds_read_b128 v[60:63], v9 offset:15360
    v_mfma_f32_16x16x32_bf16 v[24:27], v[68:71], v[96:99], v[24:27]
    ds_read_b128 v[64:67], v9 offset:16384
    s_waitcnt lgkmcnt(7)
    v_mfma_f32_16x16x32_bf16 v[28:31], v[72:75], v[96:99], v[28:31]
    ds_read_b128 v[68:71], v9 offset:17408
    v_mfma_f32_16x16x32_bf16 v[32:35], v[76:79], v[96:99], v[32:35]
    ds_read_b128 v[72:75], v9 offset:18432
    buffer_load_dwordx4 v[96:99], v3, s[4:7], s46 offen offset:2048 sc1
    s_waitcnt vmcnt(8)
    s_waitcnt lgkmcnt(7)
    v_mfma_f32_16x16x32_bf16 v[16:19], v[40:43], v[100:103], v[16:19]
    ds_read_b128 v[76:79], v9 offset:19456
    v_mfma_f32_16x16x32_bf16 v[20:23], v[44:47], v[100:103], v[20:23]
    s_barrier
    ds_read_b128 v[40:43], v9 offset:20480
    s_waitcnt lgkmcnt(7)
    v_mfma_f32_16x16x32_bf16 v[24:27], v[48:51], v[100:103], v[24:27]
    ds_read_b128 v[44:47], v9 offset:21504
    v_mfma_f32_16x16x32_bf16 v[28:31], v[52:55], v[100:103], v[28:31]
    ds_read_b128 v[48:51], v9 offset:22528
    s_waitcnt lgkmcnt(7)
    v_mfma_f32_16x16x32_bf16 v[32:35], v[56:59], v[100:103], v[32:35]
    ds_read_b128 v[52:55], v9 offset:23552
    buffer_load_dwordx4 v[100:103], v3, s[4:7], s46 offen offset:3072 sc1
    s_waitcnt vmcnt(8)
    v_mfma_f32_16x16x32_bf16 v[16:19], v[60:63], v[104:107], v[16:19]
    ds_read_b128 v[56:59], v9 offset:24576
    s_waitcnt lgkmcnt(7)
    v_mfma_f32_16x16x32_bf16 v[20:23], v[64:67], v[104:107], v[20:23]
    ds_read_b128 v[60:63], v9 offset:25600
    v_mfma_f32_16x16x32_bf16 v[24:27], v[68:71], v[104:107], v[24:27]
    ds_read_b128 v[64:67], v9 offset:26624
    s_waitcnt lgkmcnt(7)
    v_mfma_f32_16x16x32_bf16 v[28:31], v[72:75], v[104:107], v[28:31]
    ds_read_b128 v[68:71], v9 offset:27648
    v_mfma_f32_16x16x32_bf16 v[32:35], v[76:79], v[104:107], v[32:35]
    ds_read_b128 v[72:75], v9 offset:28672
    s_waitcnt vmcnt(7)
    s_waitcnt lgkmcnt(7)
    v_mfma_f32_16x16x32_bf16 v[16:19], v[40:43], v[108:111], v[16:19]
    ds_read_b128 v[76:79], v9 offset:29696
    v_mfma_f32_16x16x32_bf16 v[20:23], v[44:47], v[108:111], v[20:23]
    ds_read_b128 v[40:43], v9 offset:30720
    s_waitcnt lgkmcnt(7)
    v_mfma_f32_16x16x32_bf16 v[24:27], v[48:51], v[108:111], v[24:27]
    ds_read_b128 v[44:47], v9 offset:31744
    v_mfma_f32_16x16x32_bf16 v[28:31], v[52:55], v[108:111], v[28:31]
    ds_read_b128 v[48:51], v9 offset:32768
    s_waitcnt lgkmcnt(7)
    v_mfma_f32_16x16x32_bf16 v[32:35], v[56:59], v[108:111], v[32:35]
    ds_read_b128 v[52:55], v9 offset:33792
    s_waitcnt vmcnt(6)
    v_mfma_f32_16x16x32_bf16 v[16:19], v[60:63], v[112:115], v[16:19]
    ds_read_b128 v[56:59], v9 offset:34816
    s_waitcnt lgkmcnt(7)
    v_mfma_f32_16x16x32_bf16 v[20:23], v[64:67], v[112:115], v[20:23]
    ds_read_b128 v[60:63], v9 offset:35840
    v_mfma_f32_16x16x32_bf16 v[24:27], v[68:71], v[112:115], v[24:27]
    ds_read_b128 v[64:67], v9 offset:36864
    s_waitcnt lgkmcnt(7)
    v_mfma_f32_16x16x32_bf16 v[28:31], v[72:75], v[112:115], v[28:31]
    ds_read_b128 v[68:71], v9 offset:37888
    v_mfma_f32_16x16x32_bf16 v[32:35], v[76:79], v[112:115], v[32:35]
    ds_read_b128 v[72:75], v9 offset:38912
    s_waitcnt vmcnt(5)
    s_waitcnt lgkmcnt(7)
    v_mfma_f32_16x16x32_bf16 v[16:19], v[40:43], v[116:119], v[16:19]
    ds_read_b128 v[76:79], v9 offset:39936
    v_mfma_f32_16x16x32_bf16 v[20:23], v[44:47], v[116:119], v[20:23]
    s_barrier
    ds_read_b128 v[40:43], v7 offset:0
    s_waitcnt lgkmcnt(7)
    v_mfma_f32_16x16x32_bf16 v[24:27], v[48:51], v[116:119], v[24:27]
    ds_read_b128 v[44:47], v7 offset:1024
    v_mfma_f32_16x16x32_bf16 v[28:31], v[52:55], v[116:119], v[28:31]
    ds_read_b128 v[48:51], v7 offset:2048
    s_waitcnt lgkmcnt(7)
    v_mfma_f32_16x16x32_bf16 v[32:35], v[56:59], v[116:119], v[32:35]
    ds_read_b128 v[52:55], v7 offset:3072
    s_waitcnt vmcnt(4)
    v_mfma_f32_16x16x32_bf16 v[16:19], v[60:63], v[120:123], v[16:19]
    ds_read_b128 v[56:59], v7 offset:4096
    s_waitcnt lgkmcnt(7)
    v_mfma_f32_16x16x32_bf16 v[20:23], v[64:67], v[120:123], v[20:23]
    ds_read_b128 v[60:63], v7 offset:5120
    v_mfma_f32_16x16x32_bf16 v[24:27], v[68:71], v[120:123], v[24:27]
    ds_read_b128 v[64:67], v7 offset:6144
    s_waitcnt lgkmcnt(7)
    v_mfma_f32_16x16x32_bf16 v[28:31], v[72:75], v[120:123], v[28:31]
    ds_read_b128 v[68:71], v7 offset:7168
    v_mfma_f32_16x16x32_bf16 v[32:35], v[76:79], v[120:123], v[32:35]
    ds_read_b128 v[72:75], v7 offset:8192
    s_waitcnt vmcnt(3)
    s_waitcnt lgkmcnt(7)
    v_mfma_f32_16x16x32_bf16 v[16:19], v[40:43], v[124:127], v[16:19]
    ds_read_b128 v[76:79], v7 offset:9216
    v_mfma_f32_16x16x32_bf16 v[20:23], v[44:47], v[124:127], v[20:23]
    ds_read_b128 v[40:43], v7 offset:10240
    s_waitcnt lgkmcnt(7)
    v_mfma_f32_16x16x32_bf16 v[24:27], v[48:51], v[124:127], v[24:27]
    ds_read_b128 v[44:47], v7 offset:11264
    v_mfma_f32_16x16x32_bf16 v[28:31], v[52:55], v[124:127], v[28:31]
    ds_read_b128 v[48:51], v7 offset:12288
    s_waitcnt lgkmcnt(7)
    v_mfma_f32_16x16x32_bf16 v[32:35], v[56:59], v[124:127], v[32:35]
    ds_read_b128 v[52:55], v7 offset:13312
    s_waitcnt vmcnt(2)
    v_mfma_f32_16x16x32_bf16 v[16:19], v[60:63], v[92:95], v[16:19]
    ds_read_b128 v[56:59], v7 offset:14336
    s_waitcnt lgkmcnt(7)
    v_mfma_f32_16x16x32_bf16 v[20:23], v[64:67], v[92:95], v[20:23]
    ds_read_b128 v[60:63], v7 offset:15360
    v_mfma_f32_16x16x32_bf16 v[24:27], v[68:71], v[92:95], v[24:27]
    ds_read_b128 v[64:67], v7 offset:16384
    s_waitcnt lgkmcnt(7)
    v_mfma_f32_16x16x32_bf16 v[28:31], v[72:75], v[92:95], v[28:31]
    ds_read_b128 v[68:71], v7 offset:17408
    v_mfma_f32_16x16x32_bf16 v[32:35], v[76:79], v[92:95], v[32:35]
    ds_read_b128 v[72:75], v7 offset:18432
    s_waitcnt vmcnt(1)
    s_waitcnt lgkmcnt(7)
    v_mfma_f32_16x16x32_bf16 v[16:19], v[40:43], v[96:99], v[16:19]
    ds_read_b128 v[76:79], v7 offset:19456
    v_mfma_f32_16x16x32_bf16 v[20:23], v[44:47], v[96:99], v[20:23]
    s_waitcnt lgkmcnt(6)
    v_mfma_f32_16x16x32_bf16 v[24:27], v[48:51], v[96:99], v[24:27]
    v_mfma_f32_16x16x32_bf16 v[28:31], v[52:55], v[96:99], v[28:31]
    s_waitcnt lgkmcnt(4)
    v_mfma_f32_16x16x32_bf16 v[32:35], v[56:59], v[96:99], v[32:35]
    s_waitcnt vmcnt(0)
    v_mfma_f32_16x16x32_bf16 v[16:19], v[60:63], v[100:103], v[16:19]
    s_waitcnt lgkmcnt(2)
    v_mfma_f32_16x16x32_bf16 v[20:23], v[64:67], v[100:103], v[20:23]
    v_mfma_f32_16x16x32_bf16 v[24:27], v[68:71], v[100:103], v[24:27]
    s_waitcnt lgkmcnt(0)
    v_mfma_f32_16x16x32_bf16 v[28:31], v[72:75], v[100:103], v[28:31]
    v_mfma_f32_16x16x32_bf16 v[32:35], v[76:79], v[100:103], v[32:35]
    s_nop 7
    v_lshlrev_b32 v12, 16, v240
    v_and_b32 v13, 0xffff0000, v240
    v_pk_add_f32 v[16:17], v[16:17], v[12:13]
    v_lshlrev_b32 v14, 16, v241
    v_and_b32 v15, 0xffff0000, v241
    v_pk_add_f32 v[18:19], v[18:19], v[14:15]
    v_lshlrev_b32 v12, 16, v242
    v_and_b32 v13, 0xffff0000, v242
    v_pk_add_f32 v[20:21], v[20:21], v[12:13]
    v_lshlrev_b32 v14, 16, v243
    v_and_b32 v15, 0xffff0000, v243
    v_pk_add_f32 v[22:23], v[22:23], v[14:15]
    v_lshlrev_b32 v12, 16, v244
    v_and_b32 v13, 0xffff0000, v244
    v_pk_add_f32 v[24:25], v[24:25], v[12:13]
    v_lshlrev_b32 v14, 16, v245
    v_and_b32 v15, 0xffff0000, v245
    v_pk_add_f32 v[26:27], v[26:27], v[14:15]
    v_lshlrev_b32 v12, 16, v246
    v_and_b32 v13, 0xffff0000, v246
    v_pk_add_f32 v[28:29], v[28:29], v[12:13]
    v_lshlrev_b32 v14, 16, v247
    v_and_b32 v15, 0xffff0000, v247
    v_pk_add_f32 v[30:31], v[30:31], v[14:15]
    v_lshlrev_b32 v12, 16, v248
    v_and_b32 v13, 0xffff0000, v248
    v_pk_add_f32 v[32:33], v[32:33], v[12:13]
    v_lshlrev_b32 v14, 16, v249
    v_and_b32 v15, 0xffff0000, v249
    v_pk_add_f32 v[34:35], v[34:35], v[14:15]
    v_cvt_pk_bf16_f32 v92, v16, v17
    v_cvt_pk_bf16_f32 v93, v18, v19
    v_cvt_pk_bf16_f32 v94, v20, v21
    v_cvt_pk_bf16_f32 v95, v22, v23
    v_cvt_pk_bf16_f32 v96, v24, v25
    v_cvt_pk_bf16_f32 v97, v26, v27
    v_cvt_pk_bf16_f32 v98, v28, v29
    v_cvt_pk_bf16_f32 v99, v30, v31
    v_cvt_pk_bf16_f32 v100, v32, v33
    v_cvt_pk_bf16_f32 v101, v34, v35
    s_lshl_b32 s60, s25, 6
    s_lshl_b32 s61, s24, 4
    s_add_u32 s60, s60, s61
    v_add_u32 v10, s60, v5
    v_mul_u32_u24 v10, 1280, v10
    v_lshl_add_u32 v11, v4, 3, v10
    v_and_b32 v12, 1, v4
    v_lshl_add_u32 v10, v12, 5, v10
    v_lshrrev_b32 v12, 1, v4
    v_lshl_add_u32 v10, v12, 4, v10
    s_mul_i32 s60, s26, 160
    buffer_store_dwordx2 v[100:101], v11, s[12:15], s60 offen offset:128
    v_permlane16_swap_b32 v92, v94
    v_permlane16_swap_b32 v93, v95
    buffer_store_dwordx4 v[92:95], v10, s[12:15], s60 offen offset:0
    v_permlane16_swap_b32 v96, v98
    v_permlane16_swap_b32 v97, v99
    buffer_store_dwordx4 v[96:99], v10, s[12:15], s60 offen offset:64
L_end:
    s_endpgm
L_loader:
    v_lshrrev_b32 v11, 3, v2
    v_lshlrev_b32 v11, 7, v11
    v_and_b32 v12, 7, v2
    v_lshl_add_u32 v11, v12, 2, v11
    s_mul_i32 s33, s71, 258048
    s_add_u32 s33, s33, 9437184
    s_mul_i32 s34, s26, 245760
    s_add_u32 s34, s34, 13631488
    s_lshl_b32 s60, s70, 2
    s_add_u32 s60, s60, s29
    s_mul_i32 s60, s60, 40960
    s_add_u32 s46, s60, 4194304
    s_mul_i32 s60, s29, 3072
    s_add_u32 s61, s60, 0
    s_add_u32 s61, s61, s33
    s_add_u32 s60, s60, 0
    s_mov_b32 m0, s60
    s_nop 0
    buffer_load_dwordx4 v3, s[4:7], s61 offen sc1 lds
    buffer_load_dwordx4 v3, s[4:7], s61 offen offset:1024 sc1 lds
    buffer_load_dwordx4 v3, s[4:7], s61 offen offset:2048 sc1 lds
    s_mul_i32 s60, s29, 3072
    s_add_u32 s61, s60, 12288
    s_add_u32 s61, s61, s33
    s_add_u32 s60, s60, 20480
    s_mov_b32 m0, s60
    s_nop 0
    buffer_load_dwordx4 v3, s[4:7], s61 offen sc1 lds
    buffer_load_dwordx4 v3, s[4:7], s61 offen offset:1024 sc1 lds
    buffer_load_dwordx4 v3, s[4:7], s61 offen offset:2048 sc1 lds
    s_cmp_lg_u32 s29, 0
    s_cbranch_scc1 L_seen_o
    s_lshl_b32 s62, s25, 7
    s_add_u32 s62, s62, 335872
    s_waitcnt vmcnt(0)
    s_mov_b32 exec_lo, 0xff
    s_mov_b32 exec_hi, 0x0
    s_mov_b32 s60, 0
L_poll_5:
    buffer_load_dword v10, v11, s[4:7], s62 offen sc1
    s_add_u32 s60, s60, 1
    s_waitcnt vmcnt(0)
    v_cmp_ne_u32 vcc, 1, v10
    s_nop 4
    s_cbranch_vccz L_polled_6
    s_cmp_lt_u32 s60, 262144
    s_cbranch_scc1 L_poll_5
L_polled_6:
    s_mov_b64 exec, -1
L_seen_o:
    s_barrier
    s_barrier
    s_mul_i32 s60, s29, 3072
    s_add_u32 s61, s60, 24576
    s_add_u32 s61, s61, s33
    s_add_u32 s60, s60, 40960
    s_waitcnt vmcnt(5)
    s_mov_b32 m0, s60
    s_nop 0
    buffer_load_dwordx4 v3, s[4:7], s61 offen sc1 lds
    s_waitcnt vmcnt(5)
    buffer_load_dwordx4 v3, s[4:7], s61 offen offset:1024 sc1 lds
    s_waitcnt vmcnt(5)
    buffer_load_dwordx4 v3, s[4:7], s61 offen offset:2048 sc1 lds
    s_mul_i32 s60, s29, 3072
    s_add_u32 s61, s60, 36864
    s_add_u32 s61, s61, s33
    s_add_u32 s60, s60, 61440
    s_waitcnt vmcnt(5)
    s_mov_b32 m0, s60
    s_nop 0
    buffer_load_dwordx4 v3, s[4:7], s61 offen sc1 lds
    s_waitcnt vmcnt(5)
    buffer_load_dwordx4 v3, s[4:7], s61 offen offset:1024 sc1 lds
    s_waitcnt vmcnt(5)
    buffer_load_dwordx4 v3, s[4:7], s61 offen offset:2048 sc1 lds
    s_mul_i32 s60, s29, 3072
    s_add_u32 s61, s60, 49152
    s_add_u32 s61, s61, s33
    s_add_u32 s60, s60, 81920
    s_waitcnt vmcnt(5)
    s_mov_b32 m0, s60
    s_nop 0
    buffer_load_dwordx4 v3, s[4:7], s61 offen sc1 lds
    s_waitcnt vmcnt(5)
    buffer_load_dwordx4 v3, s[4:7], s61 offen offset:1024 sc1 lds
    s_waitcnt vmcnt(5)
    buffer_load_dwordx4 v3, s[4:7], s61 offen offset:2048 sc1 lds
    s_mul_i32 s60, s29, 3072
    s_add_u32 s61, s60, 61440
    s_add_u32 s61, s61, s33
    s_add_u32 s60, s60, 102400
    s_waitcnt vmcnt(5)
    s_mov_b32 m0, s60
    s_nop 0
    buffer_load_dwordx4 v3, s[4:7], s61 offen sc1 lds
    s_waitcnt vmcnt(5)
    buffer_load_dwordx4 v3, s[4:7], s61 offen offset:1024 sc1 lds
    s_waitcnt vmcnt(5)
    buffer_load_dwordx4 v3, s[4:7], s61 offen offset:2048 sc1 lds
    s_mul_i32 s60, s29, 3072
    s_add_u32 s61, s60, 73728
    s_add_u32 s61, s61, s33
    s_add_u32 s60, s60, 122880
    s_waitcnt vmcnt(5)
    s_mov_b32 m0, s60
    s_nop 0
    buffer_load_dwordx4 v3, s[4:7], s61 offen sc1 lds
    s_waitcnt vmcnt(5)
    buffer_load_dwordx4 v3, s[4:7], s61 offen offset:1024 sc1 lds
    s_waitcnt vmcnt(5)
    buffer_load_dwordx4 v3, s[4:7], s61 offen offset:2048 sc1 lds
    s_cmp_lg_u32 s29, 0
    s_cbranch_scc1 L_seen_h
    s_lshl_b32 s62, s70, 10
    s_add_u32 s62, s62, 344064
    s_waitcnt vmcnt(0)
    s_mov_b32 exec_lo, 0xffffffff
    s_mov_b32 exec_hi, 0xffffffff
    s_mov_b32 s60, 0
L_poll_7:
    buffer_load_dword v10, v11, s[4:7], s62 offen sc1
    s_add_u32 s60, s60, 1
    s_waitcnt vmcnt(0)
    v_cmp_ne_u32 vcc, 1, v10
    s_nop 4
    s_cbranch_vccz L_polled_8
    s_cmp_lt_u32 s60, 262144
    s_cbranch_scc1 L_poll_7
L_polled_8:
    s_mov_b64 exec, -1
L_seen_h:
    s_barrier
    s_lshl_b32 s60, s29, 11
    s_add_u32 s60, s60, 12288
    s_add_u32 s61, s46, 0
    s_mov_b32 m0, s60
    s_nop 0
    buffer_load_dwordx4 v3, s[4:7], s61 offen sc1 lds
    s_add_u32 s60, s60, 1024
    s_add_u32 s61, s61, 20480
    s_mov_b32 m0, s60
    s_nop 0
    buffer_load_dwordx4 v3, s[4:7], s61 offen sc1 lds
    s_lshl_b32 s60, s29, 11
    s_add_u32 s60, s60, 32768
    s_add_u32 s61, s46, 1024
    s_mov_b32 m0, s60
    s_nop 0
    buffer_load_dwordx4 v3, s[4:7], s61 offen sc1 lds
    s_add_u32 s60, s60, 1024
    s_add_u32 s61, s61, 20480
    s_mov_b32 m0, s60
    s_nop 0
    buffer_load_dwordx4 v3, s[4:7], s61 offen sc1 lds
    s_lshl_b32 s60, s29, 11
    s_add_u32 s60, s60, 53248
    s_add_u32 s61, s46, 2048
    s_mov_b32 m0, s60
    s_nop 0
    buffer_load_dwordx4 v3, s[4:7], s61 offen sc1 lds
    s_add_u32 s60, s60, 1024
    s_add_u32 s61, s61, 20480
    s_mov_b32 m0, s60
    s_nop 0
    buffer_load_dwordx4 v3, s[4:7], s61 offen sc1 lds
    s_lshl_b32 s60, s29, 11
    s_add_u32 s60, s60, 73728
    s_add_u32 s61, s46, 3072
    s_mov_b32 m0, s60
    s_nop 0
    buffer_load_dwordx4 v3, s[4:7], s61 offen sc1 lds
    s_add_u32 s60, s60, 1024
    s_add_u32 s61, s61, 20480
    s_mov_b32 m0, s60
    s_nop 0
    buffer_load_dwordx4 v3, s[4:7], s61 offen sc1 lds
    s_lshl_b32 s60, s29, 11
    s_add_u32 s60, s60, 94208
    s_add_u32 s61, s46, 4096
    s_mov_b32 m0, s60
    s_nop 0
    buffer_load_dwordx4 v3, s[4:7], s61 offen sc1 lds
    s_add_u32 s60, s60, 1024
    s_add_u32 s61, s61, 20480
    s_mov_b32 m0, s60
    s_nop 0
    buffer_load_dwordx4 v3, s[4:7], s61 offen sc1 lds
    s_lshl_b32 s60, s29, 11
    s_add_u32 s60, s60, 114688
    s_add_u32 s61, s46, 5120
    s_mov_b32 m0, s60
    s_nop 0
    buffer_load_dwordx4 v3, s[4:7], s61 offen sc1 lds
    s_add_u32 s60, s60, 1024
    s_add_u32 s61, s61, 20480
    s_mov_b32 m0, s60
    s_nop 0
    buffer_load_dwordx4 v3, s[4:7], s61 offen sc1 lds
    s_lshl_b32 s60, s29, 11
    s_add_u32 s60, s60, 135168
    s_add_u32 s61, s46, 6144
    s_mov_b32 m0, s60
    s_nop 0
    buffer_load_dwordx4 v3, s[4:7], s61 offen sc1 lds
    s_add_u32 s60, s60, 1024
    s_add_u32 s61, s61, 20480
    s_mov_b32 m0, s60
    s_nop 0
    buffer_load_dwordx4 v3, s[4:7], s61 offen sc1 lds
    s_waitcnt vmcnt(12)
    s_barrier
    s_waitcnt vmcnt(10)
    s_barrier
    s_lshl_b32 s60, s29, 11
    s_add_u32 s60, s60, 155648
    s_add_u32 s61, s46, 7168
    s_mov_b32 m0, s60
    s_nop 0
    buffer_load_dwordx4 v3, s[4:7], s61 offen sc1 lds
    s_add_u32 s60, s60, 1024
    s_add_u32 s61, s61, 20480
    s_mov_b32 m0, s60
    s_nop 0
    buffer_load_dwordx4 v3, s[4:7], s61 offen sc1 lds
    s_mul_i32 s60, s29, 3072
    s_add_u32 s61, s60, 86016
    s_add_u32 s61, s61, s33
    s_add_u32 s60, s60, 143360
    s_mov_b32 m0, s60
    s_nop 0
    buffer_load_dwordx4 v3, s[4:7], s61 offen sc1 lds
    buffer_load_dwordx4 v3, s[4:7], s61 offen offset:1024 sc1 lds
    buffer_load_dwordx4 v3, s[4:7], s61 offen offset:2048 sc1 lds
    s_waitcnt vmcnt(13)
    s_barrier
    s_lshl_b32 s60, s29, 11
    s_add_u32 s60, s60, 12288
    s_add_u32 s61, s46, 8192
    s_mov_b32 m0, s60
    s_nop 0
    buffer_load_dwordx4 v3, s[4:7], s61 offen sc1 lds
    s_add_u32 s60, s60, 1024
    s_add_u32 s61, s61, 20480
    s_mov_b32 m0, s60
    s_nop 0
    buffer_load_dwordx4 v3, s[4:7], s61 offen sc1 lds
    s_mul_i32 s60, s29, 3072
    s_add_u32 s61, s60, 98304
    s_add_u32 s61, s61, s33
    s_add_u32 s60, s60, 0
    s_mov_b32 m0, s60
    s_nop 0
    buffer_load_dwordx4 v3, s[4:7], s61 offen sc1 lds
    buffer_load_dwordx4 v3, s[4:7], s61 offen offset:1024 sc1 lds
    buffer_load_dwordx4 v3, s[4:7], s61 offen offset:2048 sc1 lds
    s_waitcnt vmcnt(16)
    s_barrier
    s_lshl_b32 s60, s29, 11
    s_add_u32 s60, s60, 32768
    s_add_u32 s61, s46, 9216
    s_mov_b32 m0, s60
    s_nop 0
    buffer_load_dwordx4 v3, s[4:7], s61 offen sc1 lds
    s_add_u32 s60, s60, 1024
    s_add_u32 s61, s61, 20480
    s_mov_b32 m0, s60
    s_nop 0
    buffer_load_dwordx4 v3, s[4:7], s61 offen sc1 lds
    s_mul_i32 s60, s29, 3072
    s_add_u32 s61, s60, 110592
    s_add_u32 s61, s61, s33
    s_add_u32 s60, s60, 20480
    s_mov_b32 m0, s60
    s_nop 0
    buffer_load_dwordx4 v3, s[4:7], s61 offen sc1 lds
    buffer_load_dwordx4 v3, s[4:7], s61 offen offset:1024 sc1 lds
    buffer_load_dwordx4 v3, s[4:7], s61 offen offset:2048 sc1 lds
    s_waitcnt vmcnt(19)
    s_barrier
    s_lshl_b32 s60, s29, 11
    s_add_u32 s60, s60, 53248
    s_add_u32 s61, s46, 10240
    s_mov_b32 m0, s60
    s_nop 0
    buffer_load_dwordx4 v3, s[4:7], s61 offen sc1 lds
    s_add_u32 s60, s60, 1024
    s_add_u32 s61, s61, 20480
    s_mov_b32 m0, s60
    s_nop 0
    buffer_load_dwordx4 v3, s[4:7], s61 offen sc1 lds
    s_mul_i32 s60, s29, 3072
    s_add_u32 s61, s60, 122880
    s_add_u32 s61, s61, s33
    s_add_u32 s60, s60, 40960
    s_mov_b32 m0, s60
    s_nop 0
    buffer_load_dwordx4 v3, s[4:7], s61 offen sc1 lds
    buffer_load_dwordx4 v3, s[4:7], s61 offen offset:1024 sc1 lds
    buffer_load_dwordx4 v3, s[4:7], s61 offen offset:2048 sc1 lds
    s_waitcnt vmcnt(22)
    s_barrier
    s_lshl_b32 s60, s29, 11
    s_add_u32 s60, s60, 73728
    s_add_u32 s61, s46, 11264
    s_mov_b32 m0, s60
    s_nop 0
    buffer_load_dwordx4 v3, s[4:7], s61 offen sc1 lds
    s_add_u32 s60, s60, 1024
    s_add_u32 s61, s61, 20480
    s_mov_b32 m0, s60
    s_nop 0
    buffer_load_dwordx4 v3, s[4:7], s61 offen sc1 lds
    s_mul_i32 s60, s29, 3072
    s_add_u32 s61, s60, 135168
    s_add_u32 s61, s61, s33
    s_add_u32 s60, s60, 61440
    s_mov_b32 m0, s60
    s_nop 0
    buffer_load_dwordx4 v3, s[4:7], s61 offen sc1 lds
    buffer_load_dwordx4 v3, s[4:7], s61 offen offset:1024 sc1 lds
    buffer_load_dwordx4 v3, s[4:7], s61 offen offset:2048 sc1 lds
    s_waitcnt vmcnt(25)
    s_barrier
    s_lshl_b32 s60, s29, 11
    s_add_u32 s60, s60, 94208
    s_add_u32 s61, s46, 12288
    s_mov_b32 m0, s60
    s_nop 0
    buffer_load_dwordx4 v3, s[4:7], s61 offen sc1 lds
    s_add_u32 s60, s60, 1024
    s_add_u32 s61, s61, 20480
    s_mov_b32 m0, s60
    s_nop 0
    buffer_load_dwordx4 v3, s[4:7], s61 offen sc1 lds
    s_mul_i32 s60, s29, 3072
    s_add_u32 s61, s60, 147456
    s_add_u32 s61, s61, s33
    s_add_u32 s60, s60, 81920
    s_mov_b32 m0, s60
    s_nop 0
    buffer_load_dwordx4 v3, s[4:7], s61 offen sc1 lds
    buffer_load_dwordx4 v3, s[4:7], s61 offen offset:1024 sc1 lds
    buffer_load_dwordx4 v3, s[4:7], s61 offen offset:2048 sc1 lds
    s_waitcnt vmcnt(25)
    s_barrier
    s_lshl_b32 s60, s29, 11
    s_add_u32 s60, s60, 114688
    s_add_u32 s61, s46, 13312
    s_mov_b32 m0, s60
    s_nop 0
    buffer_load_dwordx4 v3, s[4:7], s61 offen sc1 lds
    s_add_u32 s60, s60, 1024
    s_add_u32 s61, s61, 20480
    s_mov_b32 m0, s60
    s_nop 0
    buffer_load_dwordx4 v3, s[4:7], s61 offen sc1 lds
    s_mul_i32 s60, s29, 3072
    s_add_u32 s61, s60, 159744
    s_add_u32 s61, s61, s33
    s_add_u32 s60, s60, 102400
    s_mov_b32 m0, s60
    s_nop 0
    buffer_load_dwordx4 v3, s[4:7], s61 offen sc1 lds
    buffer_load_dwordx4 v3, s[4:7], s61 offen offset:1024 sc1 lds
    buffer_load_dwordx4 v3, s[4:7], s61 offen offset:2048 sc1 lds
    s_waitcnt vmcnt(25)
    s_barrier
    s_lshl_b32 s60, s29, 11
    s_add_u32 s60, s60, 135168
    s_add_u32 s61, s46, 14336
    s_mov_b32 m0, s60
    s_nop 0
    buffer_load_dwordx4 v3, s[4:7], s61 offen sc1 lds
    s_add_u32 s60, s60, 1024
    s_add_u32 s61, s61, 20480
    s_mov_b32 m0, s60
    s_nop 0
    buffer_load_dwordx4 v3, s[4:7], s61 offen sc1 lds
    s_mul_i32 s60, s29, 3072
    s_add_u32 s61, s60, 172032
    s_add_u32 s61, s61, s33
    s_add_u32 s60, s60, 122880
    s_mov_b32 m0, s60
    s_nop 0
    buffer_load_dwordx4 v3, s[4:7], s61 offen sc1 lds
    buffer_load_dwordx4 v3, s[4:7], s61 offen offset:1024 sc1 lds
    buffer_load_dwordx4 v3, s[4:7], s61 offen offset:2048 sc1 lds
    s_waitcnt vmcnt(25)
    s_barrier
    s_lshl_b32 s60, s29, 11
    s_add_u32 s60, s60, 155648
    s_add_u32 s61, s46, 15360
    s_mov_b32 m0, s60
    s_nop 0
    buffer_load_dwordx4 v3, s[4:7], s61 offen sc1 lds
    s_add_u32 s60, s60, 1024
    s_add_u32 s61, s61, 20480
    s_mov_b32 m0, s60
    s_nop 0
    buffer_load_dwordx4 v3, s[4:7], s61 offen sc1 lds
    s_mul_i32 s60, s29, 3072
    s_add_u32 s61, s60, 184320
    s_add_u32 s61, s61, s33
    s_add_u32 s60, s60, 143360
    s_mov_b32 m0, s60
    s_nop 0
    buffer_load_dwordx4 v3, s[4:7], s61 offen sc1 lds
    buffer_load_dwordx4 v3, s[4:7], s61 offen offset:1024 sc1 lds
    buffer_load_dwordx4 v3, s[4:7], s61 offen offset:2048 sc1 lds
    s_waitcnt vmcnt(25)
    s_barrier
    s_lshl_b32 s60, s29, 11
    s_add_u32 s60, s60, 12288
    s_add_u32 s61, s46, 16384
    s_mov_b32 m0, s60
    s_nop 0
    buffer_load_dwordx4 v3, s[4:7], s61 offen sc1 lds
    s_add_u32 s60, s60, 1024
    s_add_u32 s61, s61, 20480
    s_mov_b32 m0, s60
    s_nop 0
    buffer_load_dwordx4 v3, s[4:7], s61 offen sc1 lds
    s_mul_i32 s60, s29, 3072
    s_add_u32 s61, s60, 196608
    s_add_u32 s61, s61, s33
    s_add_u32 s60, s60, 0
    s_mov_b32 m0, s60
    s_nop 0
    buffer_load_dwordx4 v3, s[4:7], s61 offen sc1 lds
    buffer_load_dwordx4 v3, s[4:7], s61 offen offset:1024 sc1 lds
    buffer_load_dwordx4 v3, s[4:7], s61 offen offset:2048 sc1 lds
    s_waitcnt vmcnt(25)
    s_barrier
    s_lshl_b32 s60, s29, 11
    s_add_u32 s60, s60, 32768
    s_add_u32 s61, s46, 17408
    s_mov_b32 m0, s60
    s_nop 0
    buffer_load_dwordx4 v3, s[4:7], s61 offen sc1 lds
    s_add_u32 s60, s60, 1024
    s_add_u32 s61, s61, 20480
    s_mov_b32 m0, s60
    s_nop 0
    buffer_load_dwordx4 v3, s[4:7], s61 offen sc1 lds
    s_mul_i32 s60, s29, 3072
    s_add_u32 s61, s60, 208896
    s_add_u32 s61, s61, s33
    s_add_u32 s60, s60, 20480
    s_mov_b32 m0, s60
    s_nop 0
    buffer_load_dwordx4 v3, s[4:7], s61 offen sc1 lds
    buffer_load_dwordx4 v3, s[4:7], s61 offen offset:1024 sc1 lds
    buffer_load_dwordx4 v3, s[4:7], s61 offen offset:2048 sc1 lds
    s_waitcnt vmcnt(25)
    s_barrier
    s_lshl_b32 s60, s29, 11
    s_add_u32 s60, s60, 53248
    s_add_u32 s61, s46, 18432
    s_mov_b32 m0, s60
    s_nop 0
    buffer_load_dwordx4 v3, s[4:7], s61 offen sc1 lds
    s_add_u32 s60, s60, 1024
    s_add_u32 s61, s61, 20480
    s_mov_b32 m0, s60
    s_nop 0
    buffer_load_dwordx4 v3, s[4:7], s61 offen sc1 lds
    s_mul_i32 s60, s29, 3072
    s_add_u32 s61, s60, 221184
    s_add_u32 s61, s61, s33
    s_add_u32 s60, s60, 40960
    s_mov_b32 m0, s60
    s_nop 0
    buffer_load_dwordx4 v3, s[4:7], s61 offen sc1 lds
    buffer_load_dwordx4 v3, s[4:7], s61 offen offset:1024 sc1 lds
    buffer_load_dwordx4 v3, s[4:7], s61 offen offset:2048 sc1 lds
    s_waitcnt vmcnt(25)
    s_barrier
    s_lshl_b32 s60, s29, 11
    s_add_u32 s60, s60, 73728
    s_add_u32 s61, s46, 19456
    s_mov_b32 m0, s60
    s_nop 0
    buffer_load_dwordx4 v3, s[4:7], s61 offen sc1 lds
    s_add_u32 s60, s60, 1024
    s_add_u32 s61, s61, 20480
    s_mov_b32 m0, s60
    s_nop 0
    buffer_load_dwordx4 v3, s[4:7], s61 offen sc1 lds
    s_mul_i32 s60, s29, 3072
    s_add_u32 s61, s60, 233472
    s_add_u32 s61, s61, s33
    s_add_u32 s60, s60, 61440
    s_mov_b32 m0, s60
    s_nop 0
    buffer_load_dwordx4 v3, s[4:7], s61 offen sc1 lds
    buffer_load_dwordx4 v3, s[4:7], s61 offen offset:1024 sc1 lds
    buffer_load_dwordx4 v3, s[4:7], s61 offen offset:2048 sc1 lds
    s_waitcnt vmcnt(25)
    s_barrier
    s_mul_i32 s60, s29, 3072
    s_add_u32 s61, s60, 245760
    s_add_u32 s61, s61, s33
    s_add_u32 s60, s60, 81920
    s_mov_b32 m0, s60
    s_nop 0
    buffer_load_dwordx4 v3, s[4:7], s61 offen sc1 lds
    buffer_load_dwordx4 v3, s[4:7], s61 offen offset:1024 sc1 lds
    buffer_load_dwordx4 v3, s[4:7], s61 offen offset:2048 sc1 lds
    s_waitcnt vmcnt(23)
    s_barrier
    s_mul_i32 s60, s29, 5120
    s_add_u32 s61, s60, 0
    s_add_u32 s61, s61, s34
    s_add_u32 s60, s60, 102400
    s_mov_b32 m0, s60
    s_nop 0
    buffer_load_dwordx4 v3, s[4:7], s61 offen sc1 lds
    buffer_load_dwordx4 v3, s[4:7], s61 offen offset:1024 sc1 lds
    buffer_load_dwordx4 v3, s[4:7], s61 offen offset:2048 sc1 lds
    buffer_load_dwordx4 v3, s[4:7], s61 offen offset:3072 sc1 lds
    s_add_u32 s60, s60, 4096
    s_add_u32 s61, s61, 4096
    s_mov_b32 m0, s60
    s_nop 0
    buffer_load_dwordx4 v3, s[4:7], s61 offen sc1 lds
    s_waitcnt vmcnt(23)
    s_barrier
    s_mul_i32 s60, s29, 5120
    s_add_u32 s61, s60, 20480
    s_add_u32 s61, s61, s34
    s_add_u32 s60, s60, 122880
    s_mov_b32 m0, s60
    s_nop 0
    buffer_load_dwordx4 v3, s[4:7], s61 offen sc1 lds
    buffer_load_dwordx4 v3, s[4:7], s61 offen offset:1024 sc1 lds
    buffer_load_dwordx4 v3, s[4:7], s61 offen offset:2048 sc1 lds
    buffer_load_dwordx4 v3, s[4:7], s61 offen offset:3072 sc1 lds
    s_add_u32 s60, s60, 4096
    s_add_u32 s61, s61, 4096
    s_mov_b32 m0, s60
    s_nop 0
    buffer_load_dwordx4 v3, s[4:7], s61 offen sc1 lds
    s_waitcnt vmcnt(23)
    s_barrier
    s_mul_i32 s60, s29, 5120
    s_add_u32 s61, s60, 40960
    s_add_u32 s61, s61, s34
    s_add_u32 s60, s60, 143360
    s_mov_b32 m0, s60
    s_nop 0
    buffer_load_dwordx4 v3, s[4:7], s61 offen sc1 lds
    buffer_load_dwordx4 v3, s[4:7], s61 offen offset:1024 sc1 lds
    buffer_load_dwordx4 v3, s[4:7], s61 offen offset:2048 sc1 lds
    buffer_load_dwordx4 v3, s[4:7], s61 offen offset:3072 sc1 lds
    s_add_u32 s60, s60, 4096
    s_add_u32 s61, s61, 4096
    s_mov_b32 m0, s60
    s_nop 0
    buffer_load_dwordx4 v3, s[4:7], s61 offen sc1 lds
    s_waitcnt vmcnt(23)
    s_barrier
    s_mul_i32 s60, s29, 5120
    s_add_u32 s61, s60, 61440
    s_add_u32 s61, s61, s34
    s_add_u32 s60, s60, 0
    s_mov_b32 m0, s60
    s_nop 0
    buffer_load_dwordx4 v3, s[4:7], s61 offen sc1 lds
    buffer_load_dwordx4 v3, s[4:7], s61 offen offset:1024 sc1 lds
    buffer_load_dwordx4 v3, s[4:7], s61 offen offset:2048 sc1 lds
    buffer_load_dwordx4 v3, s[4:7], s61 offen offset:3072 sc1 lds
    s_add_u32 s60, s60, 4096
    s_add_u32 s61, s61, 4096
    s_mov_b32 m0, s60
    s_nop 0
    buffer_load_dwordx4 v3, s[4:7], s61 offen sc1 lds
    s_waitcnt vmcnt(23)
    s_barrier
    s_mul_i32 s60, s29, 5120
    s_add_u32 s61, s60, 81920
    s_add_u32 s61, s61, s34
    s_add_u32 s60, s60, 20480
    s_mov_b32 m0, s60
    s_nop 0
    buffer_load_dwordx4 v3, s[4:7], s61 offen sc1 lds
    buffer_load_dwordx4 v3, s[4:7], s61 offen offset:1024 sc1 lds
    buffer_load_dwordx4 v3, s[4:7], s61 offen offset:2048 sc1 lds
    buffer_load_dwordx4 v3, s[4:7], s61 offen offset:3072 sc1 lds
    s_add_u32 s60, s60, 4096
    s_add_u32 s61, s61, 4096
    s_mov_b32 m0, s60
    s_nop 0
    buffer_load_dwordx4 v3, s[4:7], s61 offen sc1 lds
    s_waitcnt vmcnt(25)
    s_barrier
    s_mul_i32 s60, s29, 5120
    s_add_u32 s61, s60, 102400
    s_add_u32 s61, s61, s34
    s_add_u32 s60, s60, 40960
    s_mov_b32 m0, s60
    s_nop 0
    buffer_load_dwordx4 v3, s[4:7], s61 offen sc1 lds
    buffer_load_dwordx4 v3, s[4:7], s61 offen offset:1024 sc1 lds
    buffer_load_dwordx4 v3, s[4:7], s61 offen offset:2048 sc1 lds
    buffer_load_dwordx4 v3, s[4:7], s61 offen offset:3072 sc1 lds
    s_add_u32 s60, s60, 4096
    s_add_u32 s61, s61, 4096
    s_mov_b32 m0, s60
    s_nop 0
    buffer_load_dwordx4 v3, s[4:7], s61 offen sc1 lds
    s_barrier
    s_mul_i32 s60, s29, 5120
    s_add_u32 s61, s60, 122880
    s_add_u32 s61, s61, s34
    s_add_u32 s60, s60, 61440
    s_mov_b32 m0, s60
    s_nop 0
    buffer_load_dwordx4 v3, s[4:7], s61 offen sc1 lds
    buffer_load_dwordx4 v3, s[4:7], s61 offen offset:1024 sc1 lds
    buffer_load_dwordx4 v3, s[4:7], s61 offen offset:2048 sc1 lds
    buffer_load_dwordx4 v3, s[4:7], s61 offen offset:3072 sc1 lds
    s_add_u32 s60, s60, 4096
    s_add_u32 s61, s61, 4096
    s_mov_b32 m0, s60
    s_nop 0
    buffer_load_dwordx4 v3, s[4:7], s61 offen sc1 lds
    s_mul_i32 s60, s29, 5120
    s_add_u32 s61, s60, 143360
    s_add_u32 s61, s61, s34
    s_add_u32 s60, s60, 81920
    s_mov_b32 m0, s60
    s_nop 0
    buffer_load_dwordx4 v3, s[4:7], s61 offen sc1 lds
    buffer_load_dwordx4 v3, s[4:7], s61 offen offset:1024 sc1 lds
    buffer_load_dwordx4 v3, s[4:7], s61 offen offset:2048 sc1 lds
    buffer_load_dwordx4 v3, s[4:7], s61 offen offset:3072 sc1 lds
    s_add_u32 s60, s60, 4096
    s_add_u32 s61, s61, 4096
    s_mov_b32 m0, s60
    s_nop 0
    buffer_load_dwordx4 v3, s[4:7], s61 offen sc1 lds
    s_cmp_lg_u32 s29, 0
    s_cbranch_scc1 L_seen_hh0
    s_lshl_b32 s62, s25, 9
    s_add_u32 s62, s62, 360448
    s_waitcnt vmcnt(0)
    s_mov_b32 exec_lo, 0xffffffff
    s_mov_b32 exec_hi, 0x0
    s_mov_b32 s60, 0
L_poll_9:
    buffer_load_dword v10, v11, s[4:7], s62 offen sc1
    s_add_u32 s60, s60, 1
    s_waitcnt vmcnt(0)
    v_cmp_ne_u32 vcc, 1, v10
    s_nop 4
    s_cbranch_vccz L_polled_10
    s_cmp_lt_u32 s60, 262144
    s_cbranch_scc1 L_poll_9
L_polled_10:
    s_mov_b64 exec, -1
L_seen_hh0:
    s_barrier
    s_waitcnt vmcnt(35)
    s_barrier
    v_mov_b32 v13, 1
    s_lshl_b32 s62, s25, 9
    s_add_u32 s62, s62, 376832
    s_cmp_eq_u32 s29, 0
    s_cselect_b32 s62, s62, 1073741824
    s_mov_b32 exec_hi, 0
    buffer_load_dword v13, v11, s[4:7], s62 offen sc1
    s_mov_b64 exec, -1
    s_waitcnt vmcnt(31)
    s_barrier
    s_cmp_lg_u32 s29, 0
    s_cbranch_scc1 L_seen_hh1
    s_waitcnt vmcnt(0)
    v_cmp_ne_u32 vcc, 1, v13
    s_lshl_b32 s62, s25, 9
    s_add_u32 s62, s62, 376832
    s_nop 2
    s_cbranch_vccz L_seen_hh1
    s_mov_b32 exec_lo, 0xffffffff
    s_mov_b32 exec_hi, 0x0
    s_mov_b32 s60, 0
L_poll_11:
    buffer_load_dword v10, v11, s[4:7], s62 offen sc1
    s_add_u32 s60, s60, 1
    s_waitcnt vmcnt(0)
    v_cmp_ne_u32 vcc, 1, v10
    s_nop 4
    s_cbranch_vccz L_polled_12
    s_cmp_lt_u32 s60, 262144
    s_cbranch_scc1 L_poll_11
L_polled_12:
    s_mov_b64 exec, -1
L_seen_hh1:
    s_waitcnt vmcnt(26)
    s_barrier
    s_mul_i32 s60, s29, 5120
    s_add_u32 s61, s60, 163840
    s_add_u32 s61, s61, s34
    s_add_u32 s60, s60, 102400
    s_mov_b32 m0, s60
    s_nop 0
    buffer_load_dwordx4 v3, s[4:7], s61 offen sc1 lds
    buffer_load_dwordx4 v3, s[4:7], s61 offen offset:1024 sc1 lds
    buffer_load_dwordx4 v3, s[4:7], s61 offen offset:2048 sc1 lds
    s_waitcnt vmcnt(24)
    s_barrier
    v_mov_b32 v13, 1
    s_lshl_b32 s62, s25, 9
    s_add_u32 s62, s62, 393216
    s_cmp_eq_u32 s29, 0
    s_cselect_b32 s62, s62, 1073741824
    s_mov_b32 exec_hi, 0
    buffer_load_dword v13, v11, s[4:7], s62 offen sc1
    s_mov_b64 exec, -1
    s_mul_i32 s60, s29, 5120
    s_add_u32 s61, s60, 163840
    s_add_u32 s61, s61, s34
    s_add_u32 s60, s60, 102400
    s_mov_b32 m0, s60
    s_nop 0
    buffer_load_dwordx4 v3, s[4:7], s61 offen offset:3072 sc1 lds
    s_add_u32 s60, s60, 4096
    s_add_u32 s61, s61, 4096
    s_mov_b32 m0, s60
    s_nop 0
    buffer_load_dwordx4 v3, s[4:7], s61 offen sc1 lds
    s_waitcnt vmcnt(22)
    s_barrier
    s_mul_i32 s60, s29, 5120
    s_add_u32 s61, s60, 184320
    s_add_u32 s61, s61, s34
    s_add_u32 s60, s60, 122880
    s_mov_b32 m0, s60
    s_nop 0
    buffer_load_dwordx4 v3, s[4:7], s61 offen sc1 lds
    buffer_load_dwordx4 v3, s[4:7], s61 offen offset:1024 sc1 lds
    buffer_load_dwordx4 v3, s[4:7], s61 offen offset:2048 sc1 lds
    s_waitcnt vmcnt(20)
    s_barrier
    s_mul_i32 s60, s29, 5120
    s_add_u32 s61, s60, 184320
    s_add_u32 s61, s61, s34
    s_add_u32 s60, s60, 122880
    s_mov_b32 m0, s60
    s_nop 0
    buffer_load_dwordx4 v3, s[4:7], s61 offen offset:3072 sc1 lds
    s_add_u32 s60, s60, 4096
    s_add_u32 s61, s61, 4096
    s_mov_b32 m0, s60
    s_nop 0
    buffer_load_dwordx4 v3, s[4:7], s61 offen sc1 lds
    s_cmp_lg_u32 s29, 0
    s_cbranch_scc1 L_seen_hh2
    s_waitcnt vmcnt(7)
    v_cmp_ne_u32 vcc, 1, v13
    s_lshl_b32 s62, s25, 9
    s_add_u32 s62, s62, 393216
    s_nop 2
    s_cbranch_vccz L_seen_hh2
    s_mov_b32 exec_lo, 0xffffffff
    s_mov_b32 exec_hi, 0x0
    s_mov_b32 s60, 0
L_poll_13:
    buffer_load_dword v10, v11, s[4:7], s62 offen sc1
    s_add_u32 s60, s60, 1
    s_waitcnt vmcnt(0)
    v_cmp_ne_u32 vcc, 1, v10
    s_nop 4
    s_cbranch_vccz L_polled_14
    s_cmp_lt_u32 s60, 262144
    s_cbranch_scc1 L_poll_13
L_polled_14:
    s_mov_b64 exec, -1
L_seen_hh2:
    s_waitcnt vmcnt(17)
    s_barrier
    s_mul_i32 s60, s29, 5120
    s_add_u32 s61, s60, 204800
    s_add_u32 s61, s61, s34
    s_add_u32 s60, s60, 143360
    s_mov_b32 m0, s60
    s_nop 0
    buffer_load_dwordx4 v3, s[4:7], s61 offen sc1 lds
    buffer_load_dwordx4 v3, s[4:7], s61 offen offset:1024 sc1 lds
    buffer_load_dwordx4 v3, s[4:7], s61 offen offset:2048 sc1 lds
    s_waitcnt vmcnt(15)
    s_barrier
    s_mul_i32 s60, s29, 5120
    s_add_u32 s61, s60, 204800
    s_add_u32 s61, s61, s34
    s_add_u32 s60, s60, 143360
    s_mov_b32 m0, s60
    s_nop 0
    buffer_load_dwordx4 v3, s[4:7], s61 offen offset:3072 sc1 lds
    s_add_u32 s60, s60, 4096
    s_add_u32 s61, s61, 4096
    s_mov_b32 m0, s60
    s_nop 0
    buffer_load_dwordx4 v3, s[4:7], s61 offen sc1 lds
    s_waitcnt vmcnt(10)
    s_barrier
    s_mul_i32 s60, s29, 5120
    s_add_u32 s61, s60, 225280
    s_add_u32 s61, s61, s34
    s_add_u32 s60, s60, 0
    s_mov_b32 m0, s60
    s_nop 0
    buffer_load_dwordx4 v3, s[4:7], s61 offen sc1 lds
    buffer_load_dwordx4 v3, s[4:7], s61 offen offset:1024 sc1 lds
    buffer_load_dwordx4 v3, s[4:7], s61 offen offset:2048 sc1 lds
    s_waitcnt vmcnt(8)
    s_barrier
    s_mul_i32 s60, s29, 5120
    s_add_u32 s61, s60, 225280
    s_add_u32 s61, s61, s34
    s_add_u32 s60, s60, 0
    s_mov_b32 m0, s60
    s_nop 0
    buffer_load_dwordx4 v3, s[4:7], s61 offen offset:3072 sc1 lds
    s_add_u32 s60, s60, 4096
    s_add_u32 s61, s61, 4096
    s_mov_b32 m0, s60
    s_nop 0
    buffer_load_dwordx4 v3, s[4:7], s61 offen sc1 lds
    s_waitcnt vmcnt(5)
    s_barrier
    s_waitcnt vmcnt(0)
    s_barrier
    s_endpgm
L_kv_publish2:
    v_cmp_gt_u32 s[60:61], 8, v2
    s_waitcnt vmcnt(0)
    v_cmp_ne_u32 vcc, 1, v82
    s_mov_b32 s35, 1
    s_nop 3
    s_and_b64 s[60:61], vcc, s[60:61]
    s_cbranch_scc0 L_kv_clr2
    s_mov_b32 exec_lo, 0xff
    s_mov_b32 exec_hi, 0x0
    s_mov_b32 s60, 0
L_poll_100001:
    buffer_load_dword v82, v7, s[20:23], 0 offen sc1
    s_add_u32 s60, s60, 1
    s_waitcnt vmcnt(0)
    v_cmp_ne_u32 vcc, 1, v82
    s_nop 4
    s_cbranch_vccz L_polled_100002
    s_cmp_lt_u32 s60, 262144
    s_cbranch_scc1 L_poll_100001
L_polled_100002:
    s_mov_b64 exec, -1
L_kv_clr2:
    s_lshl_b32 s61, s25, 7
    s_add_u32 s61, s61, 327680
    v_mov_b32 v12, 0
    v_mov_b32 v13, 1
    s_mov_b64 exec, 1
    buffer_atomic_add v13, v12, s[4:7], s61 offen sc1
    s_mov_b64 exec, -1
    s_branch L_kv_published2
L_kv_publish4:
    v_cmp_gt_u32 s[60:61], 8, v2
    s_waitcnt vmcnt(0)
    v_cmp_ne_u32 vcc, 1, v82
    s_mov_b32 s35, 1
    s_nop 3
    s_and_b64 s[60:61], vcc, s[60:61]
    s_cbranch_scc0 L_kv_clr4
    s_mov_b32 exec_lo, 0xff
    s_mov_b32 exec_hi, 0x0
    s_mov_b32 s60, 0
L_poll_100003:
    buffer_load_dword v82, v7, s[20:23], 0 offen sc1
    s_add_u32 s60, s60, 1
    s_waitcnt vmcnt(0)
    v_cmp_ne_u32 vcc, 1, v82
    s_nop 4
    s_cbranch_vccz L_polled_100004
    s_cmp_lt_u32 s60, 262144
    s_cbranch_scc1 L_poll_100003
L_polled_100004:
    s_mov_b64 exec, -1
L_kv_clr4:
    s_lshl_b32 s61, s25, 7
    s_add_u32 s61, s61, 327680
    v_mov_b32 v12, 0
    v_mov_b32 v13, 1
    s_mov_b64 exec, 1
    buffer_atomic_add v13, v12, s[4:7], s61 offen sc1
    s_mov_b64 exec, -1
    s_branch L_kv_published4
L_kv_publish6:
    v_cmp_gt_u32 s[60:61], 8, v2
    s_waitcnt vmcnt(0)
    v_cmp_ne_u32 vcc, 1, v82
    s_mov_b32 s35, 1
    s_nop 3
    s_and_b64 s[60:61], vcc, s[60:61]
    s_cbranch_scc0 L_kv_clr6
    s_mov_b32 exec_lo, 0xff
    s_mov_b32 exec_hi, 0x0
    s_mov_b32 s60, 0
L_poll_100005:
    buffer_load_dword v82, v7, s[20:23], 0 offen sc1
    s_add_u32 s60, s60, 1
    s_waitcnt vmcnt(0)
    v_cmp_ne_u32 vcc, 1, v82
    s_nop 4
    s_cbranch_vccz L_polled_100006
    s_cmp_lt_u32 s60, 262144
    s_cbranch_scc1 L_poll_100005
L_polled_100006:
    s_mov_b64 exec, -1
L_kv_clr6:
    s_lshl_b32 s61, s25, 7
    s_add_u32 s61, s61, 327680
    v_mov_b32 v12, 0
    v_mov_b32 v13, 1
    s_mov_b64 exec, 1
    buffer_atomic_add v13, v12, s[4:7], s61 offen sc1
    s_mov_b64 exec, -1
    s_branch L_kv_published6
L_kv_publish8:
    v_cmp_gt_u32 s[60:61], 8, v2
    s_waitcnt vmcnt(0)
    v_cmp_ne_u32 vcc, 1, v82
    s_mov_b32 s35, 1
    s_nop 3
    s_and_b64 s[60:61], vcc, s[60:61]
    s_cbranch_scc0 L_kv_clr8
    s_mov_b32 exec_lo, 0xff
    s_mov_b32 exec_hi, 0x0
    s_mov_b32 s60, 0
L_poll_100007:
    buffer_load_dword v82, v7, s[20:23], 0 offen sc1
    s_add_u32 s60, s60, 1
    s_waitcnt vmcnt(0)
    v_cmp_ne_u32 vcc, 1, v82
    s_nop 4
    s_cbranch_vccz L_polled_100008
    s_cmp_lt_u32 s60, 262144
    s_cbranch_scc1 L_poll_100007
L_polled_100008:
    s_mov_b64 exec, -1
L_kv_clr8:
    s_lshl_b32 s61, s25, 7
    s_add_u32 s61, s61, 327680
    v_mov_b32 v12, 0
    v_mov_b32 v13, 1
    s_mov_b64 exec, 1
    buffer_atomic_add v13, v12, s[4:7], s61 offen sc1
    s_mov_b64 exec, -1
    s_branch L_kv_published8
L_kv_publish10:
    v_cmp_gt_u32 s[60:61], 8, v2
    s_waitcnt vmcnt(0)
    v_cmp_ne_u32 vcc, 1, v82
    s_mov_b32 s35, 1
    s_nop 3
    s_and_b64 s[60:61], vcc, s[60:61]
    s_cbranch_scc0 L_kv_clr10
    s_mov_b32 exec_lo, 0xff
    s_mov_b32 exec_hi, 0x0
    s_mov_b32 s60, 0
L_poll_100009:
    buffer_load_dword v82, v7, s[20:23], 0 offen sc1
    s_add_u32 s60, s60, 1
    s_waitcnt vmcnt(0)
    v_cmp_ne_u32 vcc, 1, v82
    s_nop 4
    s_cbranch_vccz L_polled_100010
    s_cmp_lt_u32 s60, 262144
    s_cbranch_scc1 L_poll_100009
L_polled_100010:
    s_mov_b64 exec, -1
L_kv_clr10:
    s_lshl_b32 s61, s25, 7
    s_add_u32 s61, s61, 327680
    v_mov_b32 v12, 0
    v_mov_b32 v13, 1
    s_mov_b64 exec, 1
    buffer_atomic_add v13, v12, s[4:7], s61 offen sc1
    s_mov_b64 exec, -1
    s_branch L_kv_published10
L_kv_publish12:
    v_cmp_gt_u32 s[60:61], 8, v2
    s_waitcnt vmcnt(0)
    v_cmp_ne_u32 vcc, 1, v82
    s_mov_b32 s35, 1
    s_nop 3
    s_and_b64 s[60:61], vcc, s[60:61]
    s_cbranch_scc0 L_kv_clr12
    s_mov_b32 exec_lo, 0xff
    s_mov_b32 exec_hi, 0x0
    s_mov_b32 s60, 0
L_poll_100011:
    buffer_load_dword v82, v7, s[20:23], 0 offen sc1
    s_add_u32 s60, s60, 1
    s_waitcnt vmcnt(0)
    v_cmp_ne_u32 vcc, 1, v82
    s_nop 4
    s_cbranch_vccz L_polled_100012
    s_cmp_lt_u32 s60, 262144
    s_cbranch_scc1 L_poll_100011
L_polled_100012:
    s_mov_b64 exec, -1
L_kv_clr12:
    s_lshl_b32 s61, s25, 7
    s_add_u32 s61, s61, 327680
    v_mov_b32 v12, 0
    v_mov_b32 v13, 1
    s_mov_b64 exec, 1
    buffer_atomic_add v13, v12, s[4:7], s61 offen sc1
    s_mov_b64 exec, -1
    s_branch L_kv_published12
L_kv_publish14:
    v_cmp_gt_u32 s[60:61], 8, v2
    s_waitcnt vmcnt(0)
    v_cmp_ne_u32 vcc, 1, v82
    s_mov_b32 s35, 1
    s_nop 3
    s_and_b64 s[60:61], vcc, s[60:61]
    s_cbranch_scc0 L_kv_clr14
    s_mov_b32 exec_lo, 0xff
    s_mov_b32 exec_hi, 0x0
    s_mov_b32 s60, 0
L_poll_100013:
    buffer_load_dword v82, v7, s[20:23], 0 offen sc1
    s_add_u32 s60, s60, 1
    s_waitcnt vmcnt(0)
    v_cmp_ne_u32 vcc, 1, v82
    s_nop 4
    s_cbranch_vccz L_polled_100014
    s_cmp_lt_u32 s60, 262144
    s_cbranch_scc1 L_poll_100013
L_polled_100014:
    s_mov_b64 exec, -1
L_kv_clr14:
    s_lshl_b32 s61, s25, 7
    s_add_u32 s61, s61, 327680
    v_mov_b32 v12, 0
    v_mov_b32 v13, 1
    s_mov_b64 exec, 1
    buffer_atomic_add v13, v12, s[4:7], s61 offen sc1
    s_mov_b64 exec, -1
    s_branch L_kv_published14
L_kv_publish16:
    v_cmp_gt_u32 s[60:61], 8, v2
    s_waitcnt vmcnt(0)
    v_cmp_ne_u32 vcc, 1, v82
    s_mov_b32 s35, 1
    s_nop 3
    s_and_b64 s[60:61], vcc, s[60:61]
    s_cbranch_scc0 L_kv_clr16
    s_mov_b32 exec_lo, 0xff
    s_mov_b32 exec_hi, 0x0
    s_mov_b32 s60, 0
L_poll_100015:
    buffer_load_dword v82, v7, s[20:23], 0 offen sc1
    s_add_u32 s60, s60, 1
    s_waitcnt vmcnt(0)
    v_cmp_ne_u32 vcc, 1, v82
    s_nop 4
    s_cbranch_vccz L_polled_100016
    s_cmp_lt_u32 s60, 262144
    s_cbranch_scc1 L_poll_100015
L_polled_100016:
    s_mov_b64 exec, -1
L_kv_clr16:
    s_lshl_b32 s61, s25, 7
    s_add_u32 s61, s61, 327680
    v_mov_b32 v12, 0
    v_mov_b32 v13, 1
    s_mov_b64 exec, 1
    buffer_atomic_add v13, v12, s[4:7], s61 offen sc1
    s_mov_b64 exec, -1
    s_branch L_kv_published16
L_kv_publish18:
    v_cmp_gt_u32 s[60:61], 8, v2
    s_waitcnt vmcnt(0)
    v_cmp_ne_u32 vcc, 1, v82
    s_mov_b32 s35, 1
    s_nop 3
    s_and_b64 s[60:61], vcc, s[60:61]
    s_cbranch_scc0 L_kv_clr18
    s_mov_b32 exec_lo, 0xff
    s_mov_b32 exec_hi, 0x0
    s_mov_b32 s60, 0
L_poll_100017:
    buffer_load_dword v82, v7, s[20:23], 0 offen sc1
    s_add_u32 s60, s60, 1
    s_waitcnt vmcnt(0)
    v_cmp_ne_u32 vcc, 1, v82
    s_nop 4
    s_cbranch_vccz L_polled_100018
    s_cmp_lt_u32 s60, 262144
    s_cbranch_scc1 L_poll_100017
L_polled_100018:
    s_mov_b64 exec, -1
L_kv_clr18:
    s_lshl_b32 s61, s25, 7
    s_add_u32 s61, s61, 327680
    v_mov_b32 v12, 0
    v_mov_b32 v13, 1
    s_mov_b64 exec, 1
    buffer_atomic_add v13, v12, s[4:7], s61 offen sc1
    s_mov_b64 exec, -1
    s_branch L_kv_published18
L_kv_publish20:
    v_cmp_gt_u32 s[60:61], 8, v2
    s_waitcnt vmcnt(0)
    v_cmp_ne_u32 vcc, 1, v82
    s_mov_b32 s35, 1
    s_nop 3
    s_and_b64 s[60:61], vcc, s[60:61]
    s_cbranch_scc0 L_kv_clr20
    s_mov_b32 exec_lo, 0xff
    s_mov_b32 exec_hi, 0x0
    s_mov_b32 s60, 0
L_poll_100019:
    buffer_load_dword v82, v7, s[20:23], 0 offen sc1
    s_add_u32 s60, s60, 1
    s_waitcnt vmcnt(0)
    v_cmp_ne_u32 vcc, 1, v82
    s_nop 4
    s_cbranch_vccz L_polled_100020
    s_cmp_lt_u32 s60, 262144
    s_cbranch_scc1 L_poll_100019
L_polled_100020:
    s_mov_b64 exec, -1
L_kv_clr20:
    s_lshl_b32 s61, s25, 7
    s_add_u32 s61, s61, 327680
    v_mov_b32 v12, 0
    v_mov_b32 v13, 1
    s_mov_b64 exec, 1
    buffer_atomic_add v13, v12, s[4:7], s61 offen sc1
    s_mov_b64 exec, -1
    s_branch L_kv_published20
L_kv_publish22:
    v_cmp_gt_u32 s[60:61], 8, v2
    s_waitcnt vmcnt(0)
    v_cmp_ne_u32 vcc, 1, v82
    s_mov_b32 s35, 1
    s_nop 3
    s_and_b64 s[60:61], vcc, s[60:61]
    s_cbranch_scc0 L_kv_clr22
    s_mov_b32 exec_lo, 0xff
    s_mov_b32 exec_hi, 0x0
    s_mov_b32 s60, 0
L_poll_100021:
    buffer_load_dword v82, v7, s[20:23], 0 offen sc1
    s_add_u32 s60, s60, 1
    s_waitcnt vmcnt(0)
    v_cmp_ne_u32 vcc, 1, v82
    s_nop 4
    s_cbranch_vccz L_polled_100022
    s_cmp_lt_u32 s60, 262144
    s_cbranch_scc1 L_poll_100021
L_polled_100022:
    s_mov_b64 exec, -1
L_kv_clr22:
    s_lshl_b32 s61, s25, 7
    s_add_u32 s61, s61, 327680
    v_mov_b32 v12, 0
    v_mov_b32 v13, 1
    s_mov_b64 exec, 1
    buffer_atomic_add v13, v12, s[4:7], s61 offen sc1
    s_mov_b64 exec, -1
    s_branch L_kv_published22
L_kv_publish24:
    v_cmp_gt_u32 s[60:61], 8, v2
    s_waitcnt vmcnt(0)
    v_cmp_ne_u32 vcc, 1, v82
    s_mov_b32 s35, 1
    s_nop 3
    s_and_b64 s[60:61], vcc, s[60:61]
    s_cbranch_scc0 L_kv_clr24
    s_mov_b32 exec_lo, 0xff
    s_mov_b32 exec_hi, 0x0
    s_mov_b32 s60, 0
L_poll_100023:
    buffer_load_dword v82, v7, s[20:23], 0 offen sc1
    s_add_u32 s60, s60, 1
    s_waitcnt vmcnt(0)
    v_cmp_ne_u32 vcc, 1, v82
    s_nop 4
    s_cbranch_vccz L_polled_100024
    s_cmp_lt_u32 s60, 262144
    s_cbranch_scc1 L_poll_100023
L_polled_100024:
    s_mov_b64 exec, -1
L_kv_clr24:
    s_lshl_b32 s61, s25, 7
    s_add_u32 s61, s61, 327680
    v_mov_b32 v12, 0
    v_mov_b32 v13, 1
    s_mov_b64 exec, 1
    buffer_atomic_add v13, v12, s[4:7], s61 offen sc1
    s_mov_b64 exec, -1
    s_branch L_kv_published24
L_ps_wait:
    s_mov_b32 s60, 0
L_ps_spin:
    buffer_load_dwordx4 v[164:167], v3, s[4:7], s62 offen sc1
    s_add_u32 s60, s60, 1
    s_waitcnt vmcnt(0)
    v_and_b32 v164, v164, v165
    v_and_b32 v166, v166, v167
    v_and_b32 v164, v164, v166
    v_cmp_ne_u32 vcc, 1, v164
    s_nop 4
    s_cbranch_vccz L_ps_ready
    s_cmp_lt_u32 s60, 262144
    s_cbranch_scc1 L_ps_spin
    s_branch L_ps_ready
L_truemax:
    v_mov_b32 v188, 0xff800000
    v_mov_b32 v189, 0xff800000
    s_mul_i32 s60, s28, 12288
    v_subrev_u32 v10, s60, v6
    s_mov_b32 s60, 0
    s_mov_b32 s61, 0
    buffer_load_dwordx4 v[164:167], v3, s[4:7], s61 offen sc1
    buffer_load_dwordx2 v[168:169], v10, s[4:7], s61 offen sc1
    s_add_u32 s61, s61, 3072
    buffer_load_dwordx4 v[170:173], v3, s[4:7], s61 offen sc1
    buffer_load_dwordx2 v[174:175], v10, s[4:7], s61 offen sc1
    s_add_u32 s61, s61, 3072
    buffer_load_dwordx4 v[176:179], v3, s[4:7], s61 offen sc1
    buffer_load_dwordx2 v[180:181], v10, s[4:7], s61 offen sc1
    s_add_u32 s61, s61, 3072
    buffer_load_dwordx4 v[182:185], v3, s[4:7], s61 offen sc1
    buffer_load_dwordx2 v[186:187], v10, s[4:7], s61 offen sc1
    s_add_u32 s61, s61, 3072
L_tm_loop:
    s_waitcnt vmcnt(6)
    v_mfma_f32_32x32x16_bf16 v[32:47], v[164:167], v[16:19], 0
    v_mfma_f32_32x32x16_bf16 v[48:63], v[164:167], v[22:25], 0
    v_mfma_f32_32x32x8_bf16 v[32:47], v[168:169], v[20:21], v[32:47]
    v_mfma_f32_32x32x8_bf16 v[48:63], v[168:169], v[26:27], v[48:63]
    s_cmp_ge_u32 s61, 196608
    s_cselect_b32 s61, 1073741824, s61
    buffer_load_dwordx4 v[164:167], v3, s[4:7], s61 offen sc1
    buffer_load_dwordx2 v[168:169], v10, s[4:7], s61 offen sc1
    s_add_u32 s61, s61, 3072
    s_nop 5
    v_max3_f32 v188, v32, v33, v188
    v_max3_f32 v188, v34, v35, v188
    v_max3_f32 v188, v36, v37, v188
    v_max3_f32 v188, v38, v39, v188
    v_max3_f32 v188, v40, v41, v188
    v_max3_f32 v188, v42, v43, v188
    v_max3_f32 v188, v44, v45, v188
    v_max3_f32 v188, v46, v47, v188
    v_max3_f32 v189, v48, v49, v189
    v_max3_f32 v189, v50, v51, v189
    v_max3_f32 v189, v52, v53, v189
    v_max3_f32 v189, v54, v55, v189
    v_max3_f32 v189, v56, v57, v189
    v_max3_f32 v189, v58, v59, v189
    v_max3_f32 v189, v60, v61, v189
    v_max3_f32 v189, v62, v63, v189
    s_waitcnt vmcnt(6)
    v_mfma_f32_32x32x16_bf16 v[32:47], v[170:173], v[16:19], 0
    v_mfma_f32_32x32x16_bf16 v[48:63], v[170:173], v[22:25], 0
    v_mfma_f32_32x32x8_bf16 v[32:47], v[174:175], v[20:21], v[32:47]
    v_mfma_f32_32x32x8_bf16 v[48:63], v[174:175], v[26:27], v[48:63]
    s_cmp_ge_u32 s61, 196608
    s_cselect_b32 s61, 1073741824, s61
    buffer_load_dwordx4 v[170:173], v3, s[4:7], s61 offen sc1
    buffer_load_dwordx2 v[174:175], v10, s[4:7], s61 offen sc1
    s_add_u32 s61, s61, 3072
    s_nop 5
    v_max3_f32 v188, v32, v33, v188
    v_max3_f32 v188, v34, v35, v188
    v_max3_f32 v188, v36, v37, v188
    v_max3_f32 v188, v38, v39, v188
    v_max3_f32 v188, v40, v41, v188
    v_max3_f32 v188, v42, v43, v188
    v_max3_f32 v188, v44, v45, v188
    v_max3_f32 v188, v46, v47, v188
    v_max3_f32 v189, v48, v49, v189
    v_max3_f32 v189, v50, v51, v189
    v_max3_f32 v189, v52, v53, v189
    v_max3_f32 v189, v54, v55, v189
    v_max3_f32 v189, v56, v57, v189
    v_max3_f32 v189, v58, v59, v189
    v_max3_f32 v189, v60, v61, v189
    v_max3_f32 v189, v62, v63, v189
    s_waitcnt vmcnt(6)
    v_mfma_f32_32x32x16_bf16 v[32:47], v[176:179], v[16:19], 0
    v_mfma_f32_32x32x16_bf16 v[48:63], v[176:179], v[22:25], 0
    v_mfma_f32_32x32x8_bf16 v[32:47], v[180:181], v[20:21], v[32:47]
    v_mfma_f32_32x32x8_bf16 v[48:63], v[180:181], v[26:27], v[48:63]
    s_cmp_ge_u32 s61, 196608
    s_cselect_b32 s61, 1073741824, s61
    buffer_load_dwordx4 v[176:179], v3, s[4:7], s61 offen sc1
    buffer_load_dwordx2 v[180:181], v10, s[4:7], s61 offen sc1
    s_add_u32 s61, s61, 3072
    s_nop 5
    v_max3_f32 v188, v32, v33, v188
    v_max3_f32 v188, v34, v35, v188
    v_max3_f32 v188, v36, v37, v188
    v_max3_f32 v188, v38, v39, v188
    v_max3_f32 v188, v40, v41, v188
    v_max3_f32 v188, v42, v43, v188
    v_max3_f32 v188, v44, v45, v188
    v_max3_f32 v188, v46, v47, v188
    v_max3_f32 v189, v48, v49, v189
    v_max3_f32 v189, v50, v51, v189
    v_max3_f32 v189, v52, v53, v189
    v_max3_f32 v189, v54, v55, v189
    v_max3_f32 v189, v56, v57, v189
    v_max3_f32 v189, v58, v59, v189
    v_max3_f32 v189, v60, v61, v189
    v_max3_f32 v189, v62, v63, v189
    s_waitcnt vmcnt(6)
    v_mfma_f32_32x32x16_bf16 v[32:47], v[182:185], v[16:19], 0
    v_mfma_f32_32x32x16_bf16 v[48:63], v[182:185], v[22:25], 0
    v_mfma_f32_32x32x8_bf16 v[32:47], v[186:187], v[20:21], v[32:47]
    v_mfma_f32_32x32x8_bf16 v[48:63], v[186:187], v[26:27], v[48:63]
    s_cmp_ge_u32 s61, 196608
    s_cselect_b32 s61, 1073741824, s61
    buffer_load_dwordx4 v[182:185], v3, s[4:7], s61 offen sc1
    buffer_load_dwordx2 v[186:187], v10, s[4:7], s61 offen sc1
    s_add_u32 s61, s61, 3072
    s_nop 5
    v_max3_f32 v188, v32, v33, v188
    v_max3_f32 v188, v34, v35, v188
    v_max3_f32 v188, v36, v37, v188
    v_max3_f32 v188, v38, v39, v188
    v_max3_f32 v188, v40, v41, v188
    v_max3_f32 v188, v42, v43, v188
    v_max3_f32 v188, v44, v45, v188
    v_max3_f32 v188, v46, v47, v188
    v_max3_f32 v189, v48, v49, v189
    v_max3_f32 v189, v50, v51, v189
    v_max3_f32 v189, v52, v53, v189
    v_max3_f32 v189, v54, v55, v189
    v_max3_f32 v189, v56, v57, v189
    v_max3_f32 v189, v58, v59, v189
    v_max3_f32 v189, v60, v61, v189
    v_max3_f32 v189, v62, v63, v189
    s_add_u32 s60, s60, 4
    s_cmp_lt_u32 s60, 64
    s_cbranch_scc1 L_tm_loop
    s_waitcnt vmcnt(0)
    v_mov_b32 v164, v188
    s_nop 1
    v_permlane32_swap_b32 v188, v164
    s_nop 1
    v_max_f32 v188, v188, v164
    v_mov_b32 v164, v189
    s_nop 1
    v_permlane32_swap_b32 v189, v164
    s_nop 1
    v_max_f32 v189, v189, v164
    v_sub_f32 v104, 0, v188
    v_sub_f32 v120, 0, v189
    v_sub_f32 v105, 0, v188
    v_sub_f32 v121, 0, v189
    v_sub_f32 v106, 0, v188
    v_sub_f32 v122, 0, v189
    v_sub_f32 v107, 0, v188
    v_sub_f32 v123, 0, v189
    v_sub_f32 v108, 0, v188
    v_sub_f32 v124, 0, v189
    v_sub_f32 v109, 0, v188
    v_sub_f32 v125, 0, v189
    v_sub_f32 v110, 0, v188
    v_sub_f32 v126, 0, v189
    v_sub_f32 v111, 0, v188
    v_sub_f32 v127, 0, v189
    v_sub_f32 v112, 0, v188
    v_sub_f32 v128, 0, v189
    v_sub_f32 v113, 0, v188
    v_sub_f32 v129, 0, v189
    v_sub_f32 v114, 0, v188
    v_sub_f32 v130, 0, v189
    v_sub_f32 v115, 0, v188
    v_sub_f32 v131, 0, v189
    v_sub_f32 v116, 0, v188
    v_sub_f32 v132, 0, v189
    v_sub_f32 v117, 0, v188
    v_sub_f32 v133, 0, v189
    v_sub_f32 v118, 0, v188
    v_sub_f32 v134, 0, v189
    v_sub_f32 v119, 0, v188
    v_sub_f32 v135, 0, v189
    s_nop 1
    s_branch L_att_start
L_code_end:
.section .rodata,"a"
.p2align 6
.amdhsa_kernel sequential_preLN__grouped_kv_mqa__glu_gated_swiglu__prompt_kernel
  .amdhsa_next_free_vgpr 256
  .amdhsa_next_free_sgpr 102
  .amdhsa_accum_offset 256
  .amdhsa_group_segment_fixed_size 0
  .amdhsa_kernarg_size 96
  .amdhsa_user_sgpr_count 2
  .amdhsa_user_sgpr_kernarg_segment_ptr 1
  .amdhsa_system_sgpr_workgroup_id_x 1
  .amdhsa_float_denorm_mode_32 3
.end_amdhsa_kernel
```
